```python
import torch

def _softmax(x, axis=-1):
    return torch.softmax(x, dim=axis)
def _gelu(x):
    return torch.nn.functional.gelu(x, approximate="tanh")
def _silu(x):
    return torch.nn.functional.silu(x)
def _sigmoid(x):
    return torch.sigmoid(x)
def _layernorm(x, axis=-1, eps=1e-5):
    m = x.mean(dim=axis, keepdim=True)
    v = x.var(dim=axis, keepdim=True, unbiased=False)
    return (x - m) / torch.sqrt(v + eps)
def _scatter_add(tgt, idx, src, axis=0):
    return tgt.clone().index_add_(axis, idx, src)
def _segment_sum(src, seg, n):
    out = torch.zeros((n,) + src.shape[1:], dtype=src.dtype)
    return out.index_add_(0, seg, src)
def _pad(x, pw):
    flat = tuple(v for pair in reversed(pw) for v in pair)
    return torch.nn.functional.pad(x, flat)

kernel_name = 'parallel_sum__ssm_conv_s4__geglu_ffn__prompt'

def setup_inputs():

    _w = (lambda a: (lambda t: t.to(torch.bfloat16) if t.is_floating_point() else t)(torch.as_tensor(a)))
    def _A_setup():
        B, L, D, N = 1, 2048, 512, 128
        A_re = -(lambda _x: torch.exp(torch.as_tensor(_x)))((lambda *s: torch.randn(*s, dtype=torch.bfloat16) * 3.2)(D, N))
        A_im = torch.pi * (lambda *s: torch.randn(*s, dtype=torch.bfloat16) * 0.2)(D, N)
        B_re = (lambda *s: torch.randn(*s, dtype=torch.bfloat16) * 0.4)(D, N)
        B_im = (lambda *s: torch.randn(*s, dtype=torch.bfloat16) * 0.4)(D, N)
        C_re = (lambda *s: torch.randn(*s, dtype=torch.bfloat16) * 0.4)(D, N)
        C_im = (lambda *s: torch.randn(*s, dtype=torch.bfloat16) * 0.4)(D, N)
        log_dt = (lambda *s: torch.randn(*s, dtype=torch.bfloat16) * 0.2)(D) * 0.5 - 4.0
        Dskip = (lambda *s: torch.randn(*s, dtype=torch.bfloat16) * 0.4)(D)
        return {
            "u": _w((lambda *s: torch.randn(*s, dtype=torch.bfloat16) * 0.05)(B, L, D)),
            "A_re": _w(A_re),
            "A_im": _w(A_im),
            "B_re": _w(B_re),
            "B_im": _w(B_im),
            "C_re": _w(C_re),
            "C_im": _w(C_im),
            "log_dt": _w(log_dt),
            "Dskip": _w(Dskip),
        }
    _A_in = _A_setup()

    def _B_setup():
        B, S, D, F = 1, 2048, 512, 1792
        return {
            "x": _w((lambda *s: torch.randn(*s, dtype=torch.bfloat16) * 0.05)(B, S, D)),
            "w_gate": _w((lambda *s: torch.randn(*s, dtype=torch.bfloat16) * 0.05)(D, F)),
            "w_up": _w((lambda *s: torch.randn(*s, dtype=torch.bfloat16) * 0.05)(D, F)),
            "w_down": _w((lambda *s: torch.randn(*s, dtype=torch.bfloat16) * 0.05)(F, D)),
        }
    _B_in = _B_setup()

    return {
        "A_u": _A_in["u"],
        "A_A_re": _A_in["A_re"],
        "A_A_im": _A_in["A_im"],
        "A_B_re": _A_in["B_re"],
        "A_B_im": _A_in["B_im"],
        "A_C_re": _A_in["C_re"],
        "A_C_im": _A_in["C_im"],
        "A_log_dt": _A_in["log_dt"],
        "A_Dskip": _A_in["Dskip"],
        "B_x": _B_in["x"],
        "B_w_gate": _B_in["w_gate"],
        "B_w_up": _B_in["w_up"],
        "B_w_down": _B_in["w_down"],
    }

def reference(A_u, A_A_re, A_A_im, A_B_re, A_B_im, A_C_re, A_C_im, A_log_dt, A_Dskip, B_x, B_w_gate, B_w_up, B_w_down):
    def _A_ref(u, A_re, A_im, B_re, B_im, C_re, C_im, log_dt, Dskip):
        Bsz, L, D = u.shape
        dt = torch.exp(log_dt)[:, None]
        A = A_re + 1j * A_im
        Bc = B_re + 1j * B_im
        Cc = C_re + 1j * C_im
        logdA = dt * A
        dB = dt * Bc
        l = (lambda x, dt: x.to(dt))(torch.arange(L), A_re.dtype)
        P = torch.exp(logdA[:, :, None] * l[None, None, :])
        K = torch.einsum("dn,dnl,dn->dl", Cc, P, dB).real
        L2 = 2 * L
        Kp = _pad(K, ((0, 0), (0, L)))
        up = (lambda x, *d: x.permute(*d))(u, 0, 2, 1)
        up = _pad(up, ((0, 0), (0, 0), (0, L)))
        Kf = (lambda x, axes=(-2,-1): torch.fft.rfft2(x.float(), dim=axes))(Kp[:, None, :], axes=(-2, -1))
        Uf = (lambda x, axes=(-2,-1): torch.fft.rfft2(x.float(), dim=axes))(up[:, :, None, :], axes=(-2, -1))
        Yf = Uf * Kf[None, :, :, :]
        y = (lambda x, s, axes=(-2,-1): torch.fft.irfft2(x, s=s, dim=axes).to(torch.bfloat16))(Yf, (1, L2), axes=(-2, -1))[:, :, 0, :L]
        y = (lambda x, *d: x.permute(*d))(y, 0, 2, 1) + u * Dskip[None, None, :]
        return y

    def _B_ref(x, w_gate, w_up, w_down):
        return (_gelu(x @ w_gate) * (x @ w_up)) @ w_down

    x = A_u
    xn = _layernorm(x, axis=-1)
    return x + _A_ref(xn, A_A_re, A_A_im, A_B_re, A_B_im, A_C_re, A_C_im, A_log_dt, A_Dskip) + _B_ref(xn, B_w_gate, B_w_up, B_w_down)
```

```asm
; @launch grid=(256,1,1) block=(512,1,1) lds=163840
.amdgcn_target "amdgcn-amd-amdhsa--gfx950"
.text
.globl parallel_sum__ssm_conv_s4__geglu_ffn__prompt_kernel
.p2align 12
    s_nop 0
    s_nop 0
    s_nop 0
    s_nop 0
    s_nop 0
    s_nop 0
    s_nop 0
    s_nop 0
    s_nop 0
    s_nop 0
    s_nop 0
    s_nop 0
    s_nop 0
    s_nop 0
    s_nop 0
    s_nop 0
    s_nop 0
    s_nop 0
    s_nop 0
    s_nop 0
    s_nop 0
    s_nop 0
    s_nop 0
    s_nop 0
    s_nop 0
    s_nop 0
    s_nop 0
    s_nop 0
    s_nop 0
    s_nop 0
    s_nop 0
    s_nop 0
    s_nop 0
    s_nop 0
    s_nop 0
    s_nop 0
    s_nop 0
    s_nop 0
    s_nop 0
    s_nop 0
    s_nop 0
    s_nop 0
    s_nop 0
    s_nop 0
    s_nop 0
    s_nop 0
    s_nop 0
    s_nop 0
    s_nop 0
    s_nop 0
    s_nop 0
    s_nop 0
    s_nop 0
    s_nop 0
    s_nop 0
    s_nop 0
    s_nop 0
    s_nop 0
    s_nop 0
    s_nop 0
    s_nop 0
    s_nop 0
    s_nop 0
    s_nop 0
    s_nop 0
    s_nop 0
    s_nop 0
    s_nop 0
    s_nop 0
    s_nop 0
    s_nop 0
    s_nop 0
    s_nop 0
    s_nop 0
    s_nop 0
    s_nop 0
    s_nop 0
    s_nop 0
    s_nop 0
    s_nop 0
    s_nop 0
    s_nop 0
    s_nop 0
    s_nop 0
    s_nop 0
    s_nop 0
    s_nop 0
    s_nop 0
    s_nop 0
    s_nop 0
    s_nop 0
    s_nop 0
    s_nop 0
    s_nop 0
    s_nop 0
    s_nop 0
    s_nop 0
    s_nop 0
    s_nop 0
    s_nop 0
    s_nop 0
    s_nop 0
    s_nop 0
    s_nop 0
    s_nop 0
    s_nop 0
    s_nop 0
    s_nop 0
    s_nop 0
    s_nop 0
    s_nop 0
    s_nop 0
    s_nop 0
    s_nop 0
    s_nop 0
    s_nop 0
    s_nop 0
    s_nop 0
    s_nop 0
    s_nop 0
    s_nop 0
    s_nop 0
    s_nop 0
    s_nop 0
    s_nop 0
    s_nop 0
    s_nop 0
    s_nop 0
    s_nop 0
    s_nop 0
    s_nop 0
    s_nop 0
    s_nop 0
    s_nop 0
    s_nop 0
    s_nop 0
    s_nop 0
    s_nop 0
    s_nop 0
    s_nop 0
    s_nop 0
    s_nop 0
    s_nop 0
    s_nop 0
    s_nop 0
    s_nop 0
    s_nop 0
    s_nop 0
    s_nop 0
    s_nop 0
    s_nop 0
    s_nop 0
    s_nop 0
    s_nop 0
    s_nop 0
    s_nop 0
    s_nop 0
    s_nop 0
    s_nop 0
    s_nop 0
    s_nop 0
    s_nop 0
    s_nop 0
    s_nop 0
    s_nop 0
    s_nop 0
    s_nop 0
    s_nop 0
    s_nop 0
    s_nop 0
    s_nop 0
    s_nop 0
    s_nop 0
    s_nop 0
    s_nop 0
    s_nop 0
    s_nop 0
    s_nop 0
    s_nop 0
    s_nop 0
    s_nop 0
    s_nop 0
    s_nop 0
    s_nop 0
    s_nop 0
    s_nop 0
    s_nop 0
    s_nop 0
    s_nop 0
    s_nop 0
    s_nop 0
    s_nop 0
    s_nop 0
    s_nop 0
    s_nop 0
    s_nop 0
    s_nop 0
    s_nop 0
    s_nop 0
    s_nop 0
    s_nop 0
    s_nop 0
    s_nop 0
    s_nop 0
    s_nop 0
    s_nop 0
    s_nop 0
    s_nop 0
    s_nop 0
    s_nop 0
    s_nop 0
    s_nop 0
    s_nop 0
    s_nop 0
    s_nop 0
    s_nop 0
    s_nop 0
    s_nop 0
    s_nop 0
    s_nop 0
    s_nop 0
    s_nop 0
    s_nop 0
    s_nop 0
    s_nop 0
    s_nop 0
    s_nop 0
    s_nop 0
    s_nop 0
    s_nop 0
    s_nop 0
    s_nop 0
    s_nop 0
    s_nop 0
    s_nop 0
    s_nop 0
    s_nop 0
    s_nop 0
    s_nop 0
    s_nop 0
    s_nop 0
    s_nop 0
    s_nop 0
    s_nop 0
    s_nop 0
    s_nop 0
    s_nop 0
    s_nop 0
    s_nop 0
    s_nop 0
    s_nop 0
    s_nop 0
    s_nop 0
    s_nop 0
    s_nop 0
    s_nop 0
    s_nop 0
    s_nop 0
    s_nop 0
    s_nop 0
    s_nop 0
    s_nop 0
    s_nop 0
    s_nop 0
    s_nop 0
    s_nop 0
    s_nop 0
    s_nop 0
    s_nop 0
    s_nop 0
    s_nop 0
    s_nop 0
    s_nop 0
    s_nop 0
    s_nop 0
    s_nop 0
    s_nop 0
    s_nop 0
    s_nop 0
    s_nop 0
    s_nop 0
    s_nop 0
    s_nop 0
    s_nop 0
    s_nop 0
    s_nop 0
    s_nop 0
    s_nop 0
    s_nop 0
    s_nop 0
    s_nop 0
    s_nop 0
    s_nop 0
    s_nop 0
    s_nop 0
    s_nop 0
    s_nop 0
    s_nop 0
    s_nop 0
    s_nop 0
    s_nop 0
    s_nop 0
    s_nop 0
    s_nop 0
    s_nop 0
    s_nop 0
    s_nop 0
    s_nop 0
    s_nop 0
    s_nop 0
    s_nop 0
    s_nop 0
    s_nop 0
    s_nop 0
    s_nop 0
    s_nop 0
    s_nop 0
    s_nop 0
    s_nop 0
    s_nop 0
    s_nop 0
    s_nop 0
    s_nop 0
    s_nop 0
    s_nop 0
    s_nop 0
    s_nop 0
    s_nop 0
    s_nop 0
    s_nop 0
    s_nop 0
    s_nop 0
    s_nop 0
    s_nop 0
    s_nop 0
    s_nop 0
    s_nop 0
    s_nop 0
    s_nop 0
    s_nop 0
    s_nop 0
    s_nop 0
    s_nop 0
    s_nop 0
    s_nop 0
    s_nop 0
    s_nop 0
    s_nop 0
    s_nop 0
    s_nop 0
    s_nop 0
    s_nop 0
    s_nop 0
    s_nop 0
    s_nop 0
    s_nop 0
    s_nop 0
    s_nop 0
    s_nop 0
    s_nop 0
    s_nop 0
    s_nop 0
    s_nop 0
    s_nop 0
    s_nop 0
    s_nop 0
    s_nop 0
    s_nop 0
    s_nop 0
    s_nop 0
    s_nop 0
    s_nop 0
    s_nop 0
    s_nop 0
    s_nop 0
    s_nop 0
    s_nop 0
    s_nop 0
    s_nop 0
    s_nop 0
    s_nop 0
    s_nop 0
    s_nop 0
    s_nop 0
    s_nop 0
    s_nop 0
    s_nop 0
    s_nop 0
    s_nop 0
    s_nop 0
    s_nop 0
    s_nop 0
    s_nop 0
    s_nop 0
    s_nop 0
    s_nop 0
    s_nop 0
    s_nop 0
    s_nop 0
    s_nop 0
    s_nop 0
    s_nop 0
    s_nop 0
    s_nop 0
    s_nop 0
    s_nop 0
    s_nop 0
    s_nop 0
    s_nop 0
    s_nop 0
    s_nop 0
    s_nop 0
    s_nop 0
    s_nop 0
    s_nop 0
    s_nop 0
    s_nop 0
    s_nop 0
    s_nop 0
    s_nop 0
    s_nop 0
    s_nop 0
    s_nop 0
    s_nop 0
    s_nop 0
    s_nop 0
    s_nop 0
    s_nop 0
    s_nop 0
    s_nop 0
    s_nop 0
    s_nop 0
    s_nop 0
    s_nop 0
    s_nop 0
    s_nop 0
    s_nop 0
    s_nop 0
    s_nop 0
    s_nop 0
    s_nop 0
    s_nop 0
    s_nop 0
    s_nop 0
    s_nop 0
    s_nop 0
    s_nop 0
    s_nop 0
    s_nop 0
    s_nop 0
    s_nop 0
    s_nop 0
    s_nop 0
    s_nop 0
    s_nop 0
    s_nop 0
    s_nop 0
    s_nop 0
    s_nop 0
    s_nop 0
    s_nop 0
    s_nop 0
    s_nop 0
    s_nop 0
    s_nop 0
    s_nop 0
    s_nop 0
    s_nop 0
    s_nop 0
    s_nop 0
    s_nop 0
    s_nop 0
    s_nop 0
    s_nop 0
    s_nop 0
    s_nop 0
    s_nop 0
    s_nop 0
    s_nop 0
    s_nop 0
    s_nop 0
    s_nop 0
    s_nop 0
    s_nop 0
    s_nop 0
    s_nop 0
    s_nop 0
    s_nop 0
    s_nop 0
    s_nop 0
    s_nop 0
    s_nop 0
    s_nop 0
    s_nop 0
    s_nop 0
    s_nop 0
    s_nop 0
    s_nop 0
    s_nop 0
    s_nop 0
    s_nop 0
    s_nop 0
    s_nop 0
    s_nop 0
    s_nop 0
    s_nop 0
    s_nop 0
    s_nop 0
    s_nop 0
    s_nop 0
    s_nop 0
    s_nop 0
    s_nop 0
    s_nop 0
    s_nop 0
    s_nop 0
    s_nop 0
    s_nop 0
    s_nop 0
    s_nop 0
    s_nop 0
    s_nop 0
    s_nop 0
    s_nop 0
    s_nop 0
    s_nop 0
    s_nop 0
    s_nop 0
    s_nop 0
    s_nop 0
    s_nop 0
    s_nop 0
    s_nop 0
    s_nop 0
    s_nop 0
    s_nop 0
    s_nop 0
    s_nop 0
    s_nop 0
    s_nop 0
    s_nop 0
    s_nop 0
    s_nop 0
    s_nop 0
    s_nop 0
    s_nop 0
    s_nop 0
    s_nop 0
    s_nop 0
    s_nop 0
    s_nop 0
    s_nop 0
    s_nop 0
    s_nop 0
    s_nop 0
    s_nop 0
    s_nop 0
    s_nop 0
    s_nop 0
    s_nop 0
    s_nop 0
    s_nop 0
    s_nop 0
    s_nop 0
    s_nop 0
    s_nop 0
    s_nop 0
    s_nop 0
    s_nop 0
    s_nop 0
    s_nop 0
    s_nop 0
    s_nop 0
    s_nop 0
    s_nop 0
    s_nop 0
    s_nop 0
    s_nop 0
    s_nop 0
    s_nop 0
    s_nop 0
    s_nop 0
    s_nop 0
    s_nop 0
    s_nop 0
    s_nop 0
    s_nop 0
    s_nop 0
    s_nop 0
    s_nop 0
    s_nop 0
    s_nop 0
    s_nop 0
    s_nop 0
    s_nop 0
    s_nop 0
    s_nop 0
    s_nop 0
    s_nop 0
    s_nop 0
    s_nop 0
    s_nop 0
    s_nop 0
    s_nop 0
    s_nop 0
    s_nop 0
    s_nop 0
    s_nop 0
    s_nop 0
    s_nop 0
    s_nop 0
    s_nop 0
    s_nop 0
    s_nop 0
    s_nop 0
    s_nop 0
    s_nop 0
    s_nop 0
    s_nop 0
    s_nop 0
    s_nop 0
    s_nop 0
    s_nop 0
    s_nop 0
    s_nop 0
    s_nop 0
    s_nop 0
    s_nop 0
    s_nop 0
    s_nop 0
    s_nop 0
    s_nop 0
    s_nop 0
    s_nop 0
    s_nop 0
    s_nop 0
    s_nop 0
    s_nop 0
    s_nop 0
    s_nop 0
.p2align 8
.type parallel_sum__ssm_conv_s4__geglu_ffn__prompt_kernel,@function
parallel_sum__ssm_conv_s4__geglu_ffn__prompt_kernel:
KSTART:
    s_cmp_ge_u32 s2, 256
    s_cbranch_scc1 .L_end
    s_nop 0
    s_load_dwordx16 s[16:31], s[0:1], 0
    s_load_dwordx16 s[32:47], s[0:1], 64
    v_lshrrev_b32 v2, 6, v0
    v_and_b32_e64 v1, 63, v0
    v_readfirstlane_b32 s3, v2
    s_and_b32 s6, s2, 7
    s_lshr_b32 s7, s2, 3
    s_lshr_b32 s4, s6, 2
    s_lshl_b32 s4, s4, 2
    s_and_b32 s5, s7, 3
    s_add_u32 s4, s4, s5
    s_lshl_b32 s8, s6, 2
    s_add_u32 s8, s8, s5
    s_lshr_b32 s9, s7, 2
    s_and_b32 s5, s6, 3
    s_xor_b32 s6, s9, 4
    s_cmp_ge_u32 s7, 28
    s_cbranch_scc1 .L_ln
    s_cmp_lt_u32 s3, 4
    s_cbranch_scc0 .L_help
    s_getpc_b64 s[78:79]
.L_pc:
    s_sub_u32 s78, s78, .L_pc-KSTART
    s_subb_u32 s79, s79, 0
    s_lshl_b32 s10, s9, 2
    s_add_u32 s10, s10, s3
    s_lshl_b32 s10, s10, 11
    v_lshl_add_u32 v2, v1, 5, s10
    v_min_u32 v2, CODE_END-KSTART, v2
    global_load_dword v64, v2, s[78:79]
.L_w03e:
    s_lshl_b32 s10, s2, 2
    s_add_u32 s10, s10, s3
    s_and_b32 s11, s10, -2
    v_mov_b32_e64 v105, s11
    s_lshl_b32 s10, s10, 7
    v_lshl_add_u32 v104, v1, 1, s10
    v_mov_b32 v96, 0
    v_mov_b32 v97, 0
    v_mov_b32 v98, 0
    v_mov_b32 v99, 0
    v_mov_b32 v100, 0
    v_mov_b32 v101, 0
    v_mov_b32_e64 v102, 0
    s_mov_b32 s15, 15597568
    s_cmp_ge_u32 s7, 28
    s_waitcnt lgkmcnt(0)
    global_load_short_d16_hi v102, v105, s[30:31]
    global_load_short_d16_hi v96, v104, s[18:19]
    global_load_short_d16_hi v97, v104, s[20:21]
    global_load_short_d16_hi v98, v104, s[22:23]
    global_load_short_d16_hi v99, v104, s[24:25]
    global_load_short_d16_hi v100, v104, s[26:27]
    global_load_short_d16_hi v101, v104, s[28:29]
    s_branch .L_w03
.L_help:
    s_sub_u32 s10, s3, 4
    s_and_b32 s11, s10, 1
    s_lshr_b32 s12, s10, 1
    v_lshrrev_b32 v8, 3, v1
    v_and_b32 v9, 7, v1
    v_lshrrev_b32_e64 v10, 4, v1
    s_add_u32 s79, s4, s9
    s_mul_i32 s101, s5, 7
    s_add_u32 s101, s101, s9
    s_lshl_b32 s13, s12, 14
    s_add_u32 s13, s13, 131072
    s_lshl_b32 s100, s10, 13
    s_nop 0
    s_mov_b32 s50, 0x200000
    s_mov_b32 s51, 0x20000
    s_cmp_eq_u32 s11, 0
    s_cbranch_scc1 .L_dw
    s_setprio 1
    s_lshl_b32 s14, s2, 1
    s_add_u32 s14, s14, s12
    s_lshl_b32 s15, s14, 1
    v_mov_b32_e64 v35, s15
    s_lshl_b32 s14, s14, 8
    v_lshl_add_u32 v34, v1, 1, s14
    v_mov_b32 v36, 0
    v_mov_b32 v37, 0
    v_mov_b32 v38, 0
    v_mov_b32 v39, 0
    v_mov_b32_e64 v40, 0
    s_add_u32 s14, s13, 6656
    s_mov_b32 s15, 15597568
    s_waitcnt lgkmcnt(0)
    s_nop 0
    global_load_short_d16_hi v36, v35, s[30:31]
    global_load_short_d16_hi v37, v34, s[18:19]
    global_load_short_d16_hi v38, v34, s[20:21]
    global_load_short_d16_hi v39, v34, s[18:19] offset:128
    global_load_short_d16_hi v40, v34, s[20:21] offset:128
    s_branch .L_kw
.L_dw:
    v_xor_b32 v11, v9, v10
    v_lshlrev_b32 v11, 4, v11
    v_lshl_add_u32 v2, v8, 10, v11
    v_xor_b32_e64 v3, 64, v2
    v_add_u32 v3, 7168, v3
    v_add_u32 v4, 14336, v2
    v_add_u32 v5, 14336, v3
    s_lshl_b32 s78, s4, 2
    s_add_u32 s78, s78, s10
    s_lshl_b32 s78, s78, 16
    v_and_b32 v10, 1, v10
    v_xor_b32 v11, v9, v10
    v_lshlrev_b32 v11, 4, v11
    v_lshl_add_u32 v12, s10, 3, v8
    v_mul_u32_u24 v12, 3584, v12
    v_add_u32 v6, v12, v11
    v_xor_b32 v7, 64, v6
    v_add_u32 v33, 27648, v7
    s_mov_b32 s54, 1835008
    s_mov_b32 s55, 0x20000
    s_mov_b32 s58, 1835008
    s_mov_b32 s59, 0x20000
    s_lshl_b32 s101, s101, 7
    s_nop 0
    s_mov_b32 s15, 15597568
    v_lshlrev_b32 v10, 2, v10
    v_xor_b32 v9, v9, v10
    v_lshlrev_b32_e64 v9, 4, v9
    v_lshl_add_u32 v8, v8, 10, v9
    v_add_u32 v9, 7168, v8
    s_lshr_b32 s14, s100, 2
    s_nop 0
    s_add_u32 s14, s14, 98304
    s_cmp_ge_u32 s7, 28
    s_waitcnt lgkmcnt(0)
    s_mov_b64 s[52:53], s[36:37]
    s_mov_b64 s[56:57], s[38:39]
    s_mov_b64 s[48:49], s[16:17]
    s_cbranch_scc1 .L_daux
    s_add_u32 s19, s79, 0
    s_and_b32 s19, s19, 7
    s_mul_i32 s19, s19, 229376
    s_add_u32 s19, s19, s101
    s_add_u32 m0, s14, 0
    s_nop 0
    s_nop 0
    buffer_load_dwordx4 v6, s[52:55], s19 offen lds
    buffer_load_dwordx4 v33, s[52:55], s19 offen offset:1024 lds
    s_add_u32 m0, s14, 2048
    s_nop 0
    s_nop 0
    buffer_load_dwordx4 v6, s[56:59], s19 offen lds
    buffer_load_dwordx4 v33, s[56:59], s19 offen offset:1024 lds
    s_add_u32 s18, s79, 0
    s_and_b32 s18, s18, 7
    s_lshl_b32 s18, s18, 7
    s_add_u32 s18, s18, s78
    s_add_u32 m0, s100, 0
    s_nop 0
    buffer_load_dwordx4 v2, s[48:51], s18 offen lds
    buffer_load_dwordx4 v3, s[48:51], s18 offen offset:1024 lds
    buffer_load_dwordx4 v4, s[48:51], s18 offen offset:2048 lds
    buffer_load_dwordx4 v5, s[48:51], s18 offen offset:3072 lds
    s_add_u32 s18, s18, 32768
    s_add_u32 m0, s100, 4096
    s_nop 0
    s_nop 0
    buffer_load_dwordx4 v2, s[48:51], s18 offen lds
    buffer_load_dwordx4 v3, s[48:51], s18 offen offset:1024 lds
    buffer_load_dwordx4 v4, s[48:51], s18 offen offset:2048 lds
    buffer_load_dwordx4 v5, s[48:51], s18 offen offset:3072 lds
    s_add_u32 s18, s18, 32768
    s_add_u32 m0, s100, 8192
    s_nop 0
    s_nop 0
    buffer_load_dwordx4 v2, s[48:51], s18 offen lds
    buffer_load_dwordx4 v3, s[48:51], s18 offen offset:1024 lds
    buffer_load_dwordx4 v4, s[48:51], s18 offen offset:2048 lds
    buffer_load_dwordx4 v5, s[48:51], s18 offen offset:3072 lds
    s_add_u32 s18, s18, 32768
    s_add_u32 m0, s100, 12288
    s_nop 0
    s_nop 0
    buffer_load_dwordx4 v2, s[48:51], s18 offen lds
    buffer_load_dwordx4 v3, s[48:51], s18 offen offset:1024 lds
    buffer_load_dwordx4 v4, s[48:51], s18 offen offset:2048 lds
    buffer_load_dwordx4 v5, s[48:51], s18 offen offset:3072 lds
    s_add_u32 s19, s19, 114688
    s_add_u32 m0, s14, 8192
    s_nop 0
    s_nop 0
    buffer_load_dwordx4 v6, s[52:55], s19 offen lds
    buffer_load_dwordx4 v33, s[52:55], s19 offen offset:1024 lds
    s_add_u32 m0, s14, 10240
    s_nop 0
    s_nop 0
    buffer_load_dwordx4 v6, s[56:59], s19 offen lds
    buffer_load_dwordx4 v33, s[56:59], s19 offen offset:1024 lds
    s_load_dword s34, s[46:47], s15
    s_mov_b64 s[60:61], s[40:41]
    s_nop 0
    s_mov_b32 s62, 1835008
    s_mov_b32 s63, 0x20000
    s_mov_b64 s[64:65], s[42:43]
    s_nop 0
    s_mov_b32 s66, 0x200000
    s_mov_b32 s67, 0x20000
    s_mov_b64 s[68:69], s[46:47]
    s_nop 0
    s_mov_b32 s70, 18874368
    s_mov_b32 s71, 0x20000
    s_mov_b64 s[72:73], s[44:45]
    s_nop 0
    s_mov_b32 s74, 256
    s_mov_b32 s75, 0x20000
    s_mul_i32 s46, s10, 28
    s_lshl_b32 s46, s46, 14
    s_lshl_b32 s47, s6, 7
    s_add_u32 s46, s46, s47
    v_add_u32 v8, s46, v8
    v_add_u32_e64 v9, s46, v9
    s_lshl_b32 s46, s7, 1
    s_add_u32 s46, s46, s9
    s_and_b32 s46, s46, 7
    s_mul_i32 s46, s46, 7
    s_lshr_b32 s46, s46, 1
    s_lshl_b32 s46, s46, 14
    s_lshl_b32 s15, s2, 2
    s_load_dword s17, s[32:33], s15
    s_lshl_b32 s15, s2, 1
    s_add_u32 s12, s12, s15
    s_waitcnt vmcnt(4)
    s_barrier
    s_add_u32 s18, s79, 1
    s_and_b32 s18, s18, 7
    s_lshl_b32 s18, s18, 7
    s_add_u32 s18, s18, s78
    s_add_u32 m0, s100, 32768
    s_nop 0
    s_nop 0
    buffer_load_dwordx4 v2, s[48:51], s18 offen lds
    buffer_load_dwordx4 v3, s[48:51], s18 offen offset:1024 lds
    buffer_load_dwordx4 v4, s[48:51], s18 offen offset:2048 lds
    buffer_load_dwordx4 v5, s[48:51], s18 offen offset:3072 lds
    s_add_u32 s18, s18, 32768
    s_add_u32 m0, s100, 36864
    s_nop 0
    s_nop 0
    buffer_load_dwordx4 v2, s[48:51], s18 offen lds
    buffer_load_dwordx4 v3, s[48:51], s18 offen offset:1024 lds
    buffer_load_dwordx4 v4, s[48:51], s18 offen offset:2048 lds
    buffer_load_dwordx4 v5, s[48:51], s18 offen offset:3072 lds
    s_add_u32 s18, s18, 32768
    s_add_u32 m0, s100, 40960
    s_nop 0
    s_nop 0
    buffer_load_dwordx4 v2, s[48:51], s18 offen lds
    buffer_load_dwordx4 v3, s[48:51], s18 offen offset:1024 lds
    buffer_load_dwordx4 v4, s[48:51], s18 offen offset:2048 lds
    buffer_load_dwordx4 v5, s[48:51], s18 offen offset:3072 lds
    s_add_u32 s18, s18, 32768
    s_add_u32 m0, s100, 45056
    s_nop 0
    s_nop 0
    buffer_load_dwordx4 v2, s[48:51], s18 offen lds
    buffer_load_dwordx4 v3, s[48:51], s18 offen offset:1024 lds
    buffer_load_dwordx4 v4, s[48:51], s18 offen offset:2048 lds
    buffer_load_dwordx4 v5, s[48:51], s18 offen offset:3072 lds
    v_lshrrev_b32 v16, 5, v1
    v_lshlrev_b32 v10, 6, v16
    v_and_b32_e64 v17, 1, v1
    v_lshl_add_u32 v10, v17, 5, v10
    v_bfe_u32 v17, v1, 4, 1
    v_lshl_add_u32 v10, v17, 4, v10
    v_bfe_u32 v18, v1, 1, 1
    v_lshl_add_u32 v10, v18, 3, v10
    v_bfe_u32 v18, v1, 2, 2
    v_lshlrev_b32 v19, 3, v18
    v_sub_u32_e64 v10, v10, v19
    s_add_u32 s15, s13, 32
    s_waitcnt vmcnt(16)
    s_barrier
    s_add_u32 s19, s79, 1
    s_and_b32 s19, s19, 7
    s_mul_i32 s19, s19, 229376
    s_add_u32 s19, s19, s101
    s_nop 0
    s_add_u32 m0, s14, 16384
    s_nop 0
    s_nop 0
    buffer_load_dwordx4 v6, s[52:55], s19 offen lds
    buffer_load_dwordx4 v33, s[52:55], s19 offen offset:1024 lds
    s_add_u32 m0, s14, 18432
    s_nop 0
    s_nop 0
    buffer_load_dwordx4 v6, s[56:59], s19 offen lds
    buffer_load_dwordx4 v33, s[56:59], s19 offen offset:1024 lds
    s_add_u32 s19, s19, 114688
    s_add_u32 m0, s14, 24576
    s_nop 0
    s_nop 0
    buffer_load_dwordx4 v6, s[52:55], s19 offen lds
    buffer_load_dwordx4 v33, s[52:55], s19 offen offset:1024 lds
    s_add_u32 m0, s14, 26624
    s_nop 0
    s_nop 0
    buffer_load_dwordx4 v6, s[56:59], s19 offen lds
    buffer_load_dwordx4 v33, s[56:59], s19 offen offset:1024 lds
    s_add_u32 s18, s79, 2
    s_and_b32 s18, s18, 7
    s_lshl_b32 s18, s18, 7
    s_add_u32 s18, s18, s78
    s_add_u32 m0, s100, 65536
    s_nop 0
    s_nop 0
    buffer_load_dwordx4 v2, s[48:51], s18 offen lds
    buffer_load_dwordx4 v3, s[48:51], s18 offen offset:1024 lds
    buffer_load_dwordx4 v4, s[48:51], s18 offen offset:2048 lds
    buffer_load_dwordx4 v5, s[48:51], s18 offen offset:3072 lds
    s_add_u32 s18, s18, 32768
    s_add_u32 m0, s100, 69632
    s_nop 0
    s_nop 0
    buffer_load_dwordx4 v2, s[48:51], s18 offen lds
    buffer_load_dwordx4 v3, s[48:51], s18 offen offset:1024 lds
    buffer_load_dwordx4 v4, s[48:51], s18 offen offset:2048 lds
    buffer_load_dwordx4 v5, s[48:51], s18 offen offset:3072 lds
    v_add_u32 v10, s15, v10
    v_and_b32 v19, 3, v1
    v_lshl_add_u32 v19, v17, 2, v19
    v_sub_u32 v20, v19, v16
    v_add_u32 v20, 2, v20
    v_lshrrev_b32 v21, 1, v20
    v_lshlrev_b32 v11, 7, v21
    v_and_b32_e64 v20, 1, v20
    v_lshl_add_u32 v11, v20, 4, v11
    v_lshl_add_u32 v11, v18, 5, v11
    s_add_u32 s15, s13, 4160
    v_add_u32 v11, s15, v11
    s_waitcnt lgkmcnt(0)
    s_add_u32 s34, s34, 2
    s_or_b32 s34, s34, 1
    s_waitcnt vmcnt(12)
    s_barrier
    s_add_u32 s18, s18, 32768
    s_add_u32 m0, s100, 73728
    s_nop 0
    s_nop 0
    buffer_load_dwordx4 v2, s[48:51], s18 offen lds
    buffer_load_dwordx4 v3, s[48:51], s18 offen offset:1024 lds
    buffer_load_dwordx4 v4, s[48:51], s18 offen offset:2048 lds
    buffer_load_dwordx4 v5, s[48:51], s18 offen offset:3072 lds
    s_add_u32 s18, s18, 32768
    s_add_u32 m0, s100, 77824
    s_nop 0
    s_nop 0
    buffer_load_dwordx4 v2, s[48:51], s18 offen lds
    buffer_load_dwordx4 v3, s[48:51], s18 offen offset:1024 lds
    buffer_load_dwordx4 v4, s[48:51], s18 offen offset:2048 lds
    buffer_load_dwordx4 v5, s[48:51], s18 offen offset:3072 lds
    s_add_u32 s19, s79, 2
    s_and_b32 s19, s19, 7
    s_mul_i32 s19, s19, 229376
    s_add_u32 s19, s19, s101
    s_add_u32 m0, s14, 0
    s_nop 0
    s_nop 0
    buffer_load_dwordx4 v6, s[52:55], s19 offen lds
    buffer_load_dwordx4 v33, s[52:55], s19 offen offset:1024 lds
    s_add_u32 m0, s14, 2048
    s_nop 0
    s_nop 0
    buffer_load_dwordx4 v6, s[56:59], s19 offen lds
    buffer_load_dwordx4 v33, s[56:59], s19 offen offset:1024 lds
    s_add_u32 s19, s19, 114688
    s_add_u32 m0, s14, 8192
    s_nop 0
    s_nop 0
    buffer_load_dwordx4 v6, s[52:55], s19 offen lds
    buffer_load_dwordx4 v33, s[52:55], s19 offen offset:1024 lds
    s_add_u32 m0, s14, 10240
    s_nop 0
    s_nop 0
    buffer_load_dwordx4 v6, s[56:59], s19 offen lds
    buffer_load_dwordx4 v33, s[56:59], s19 offen offset:1024 lds
    v_mul_u32_u24 v12, 129, v18
    v_lshl_add_u32 v12, v19, 1, v12
    v_add_u32_e64 v12, v12, v16
    s_add_u32 s15, s13, 6704
    v_lshl_add_u32 v12, v12, 4, s15
    v_and_b32 v20, 1, v18
    v_mul_u32_u24 v20, 3, v20
    v_xor_b32 v20, s11, v20
    v_lshrrev_b32 v21, 1, v18
    v_lshlrev_b32 v13, 9, v20
    v_lshrrev_b32 v22, 1, v19
    v_lshl_add_u32 v13, v22, 7, v13
    s_waitcnt vmcnt(24)
    s_barrier
    s_add_u32 s18, s79, 3
    s_and_b32 s18, s18, 7
    s_lshl_b32 s18, s18, 7
    s_add_u32 s18, s18, s78
    s_add_u32 m0, s100, 0
    s_nop 0
    buffer_load_dwordx4 v2, s[48:51], s18 offen lds
    buffer_load_dwordx4 v3, s[48:51], s18 offen offset:1024 lds
    buffer_load_dwordx4 v4, s[48:51], s18 offen offset:2048 lds
    buffer_load_dwordx4 v5, s[48:51], s18 offen offset:3072 lds
    s_add_u32 s18, s18, 32768
    s_add_u32 m0, s100, 4096
    s_nop 0
    s_nop 0
    buffer_load_dwordx4 v2, s[48:51], s18 offen lds
    buffer_load_dwordx4 v3, s[48:51], s18 offen offset:1024 lds
    buffer_load_dwordx4 v4, s[48:51], s18 offen offset:2048 lds
    buffer_load_dwordx4 v5, s[48:51], s18 offen offset:3072 lds
    s_add_u32 s18, s18, 32768
    s_add_u32 m0, s100, 8192
    s_nop 0
    s_nop 0
    buffer_load_dwordx4 v2, s[48:51], s18 offen lds
    buffer_load_dwordx4 v3, s[48:51], s18 offen offset:1024 lds
    buffer_load_dwordx4 v4, s[48:51], s18 offen offset:2048 lds
    buffer_load_dwordx4 v5, s[48:51], s18 offen offset:3072 lds
    s_add_u32 s18, s18, 32768
    s_add_u32 m0, s100, 12288
    s_nop 0
    s_nop 0
    buffer_load_dwordx4 v2, s[48:51], s18 offen lds
    buffer_load_dwordx4 v3, s[48:51], s18 offen offset:1024 lds
    buffer_load_dwordx4 v4, s[48:51], s18 offen offset:2048 lds
    buffer_load_dwordx4 v5, s[48:51], s18 offen offset:3072 lds
    v_and_b32_e64 v22, 1, v19
    v_lshl_add_u32 v13, v22, 4, v13
    v_lshl_add_u32 v13, v16, 3, v13
    v_lshl_add_u32 v13, v21, 2, v13
    s_add_u32 s15, s13, 4672
    v_add_u32 v13, s15, v13
    v_lshlrev_b32 v14, 9, v20
    v_lshl_add_u32 v14, v19, 6, v14
    v_lshl_add_u32 v14, v16, 5, v14
    v_lshl_add_u32 v14, v21, 4, v14
    v_and_b32 v16, 15, v1
    v_lshrrev_b32 v17, 4, v1
    s_waitcnt vmcnt(20)
    s_barrier
    s_add_u32 s19, s79, 3
    s_and_b32 s19, s19, 7
    s_mul_i32 s19, s19, 229376
    s_add_u32 s19, s19, s101
    s_nop 0
    s_add_u32 m0, s14, 16384
    s_nop 0
    s_nop 0
    buffer_load_dwordx4 v6, s[52:55], s19 offen lds
    buffer_load_dwordx4 v33, s[52:55], s19 offen offset:1024 lds
    s_add_u32 m0, s14, 18432
    s_nop 0
    s_nop 0
    buffer_load_dwordx4 v6, s[56:59], s19 offen lds
    buffer_load_dwordx4 v33, s[56:59], s19 offen offset:1024 lds
    s_add_u32 s19, s19, 114688
    s_add_u32 m0, s14, 24576
    s_nop 0
    s_nop 0
    buffer_load_dwordx4 v6, s[52:55], s19 offen lds
    buffer_load_dwordx4 v33, s[52:55], s19 offen offset:1024 lds
    s_add_u32 m0, s14, 26624
    s_nop 0
    s_nop 0
    buffer_load_dwordx4 v6, s[56:59], s19 offen lds
    buffer_load_dwordx4 v33, s[56:59], s19 offen offset:1024 lds
    s_add_u32 s18, s79, 4
    s_and_b32 s18, s18, 7
    s_lshl_b32 s18, s18, 7
    s_add_u32 s18, s18, s78
    s_add_u32 m0, s100, 32768
    s_nop 0
    s_nop 0
    buffer_load_dwordx4 v2, s[48:51], s18 offen lds
    buffer_load_dwordx4 v3, s[48:51], s18 offen offset:1024 lds
    buffer_load_dwordx4 v4, s[48:51], s18 offen offset:2048 lds
    buffer_load_dwordx4 v5, s[48:51], s18 offen offset:3072 lds
    s_add_u32 s18, s18, 32768
    s_add_u32 m0, s100, 36864
    s_nop 0
    s_nop 0
    buffer_load_dwordx4 v2, s[48:51], s18 offen lds
    buffer_load_dwordx4 v3, s[48:51], s18 offen offset:1024 lds
    buffer_load_dwordx4 v4, s[48:51], s18 offen offset:2048 lds
    buffer_load_dwordx4 v5, s[48:51], s18 offen offset:3072 lds
    v_and_b32 v16, 7, v1
    v_lshlrev_b32 v15, 10, v16
    v_lshl_add_u32 v15, v17, 4, v15
    v_bfe_u32 v16, v1, 3, 1
    v_lshl_add_u32 v15, v16, 6, v15
    s_lshl_b32 s24, s8, 3
    s_add_u32 s24, s24, s10
    s_lshl_b32 s24, s24, 13
    s_lshl_b32 s25, s6, 7
    s_add_u32 s24, s24, s25
    v_lshrrev_b32 v16, 1, v1
    v_lshlrev_b32_e64 v16, 14, v16
    s_waitcnt vmcnt(32)
    s_barrier
    s_add_u32 s18, s18, 32768
    s_add_u32 m0, s100, 40960
    s_nop 0
    s_nop 0
    buffer_load_dwordx4 v2, s[48:51], s18 offen lds
    buffer_load_dwordx4 v3, s[48:51], s18 offen offset:1024 lds
    buffer_load_dwordx4 v4, s[48:51], s18 offen offset:2048 lds
    buffer_load_dwordx4 v5, s[48:51], s18 offen offset:3072 lds
    s_add_u32 s18, s18, 32768
    s_add_u32 m0, s100, 45056
    s_nop 0
    s_nop 0
    buffer_load_dwordx4 v2, s[48:51], s18 offen lds
    buffer_load_dwordx4 v3, s[48:51], s18 offen offset:1024 lds
    buffer_load_dwordx4 v4, s[48:51], s18 offen offset:2048 lds
    buffer_load_dwordx4 v5, s[48:51], s18 offen offset:3072 lds
    s_add_u32 s19, s79, 4
    s_and_b32 s19, s19, 7
    s_mul_i32 s19, s19, 229376
    s_add_u32 s19, s19, s101
    s_add_u32 m0, s14, 0
    s_nop 0
    s_nop 0
    buffer_load_dwordx4 v6, s[52:55], s19 offen lds
    buffer_load_dwordx4 v33, s[52:55], s19 offen offset:1024 lds
    s_add_u32 m0, s14, 2048
    s_nop 0
    s_nop 0
    buffer_load_dwordx4 v6, s[56:59], s19 offen lds
    buffer_load_dwordx4 v33, s[56:59], s19 offen offset:1024 lds
    v_and_b32_e64 v17, 1, v1
    v_lshl_add_u32 v16, v17, 6, v16
    s_lshr_b32 s26, s12, 2
    s_lshl_b32 s26, s26, 7
    s_and_b32 s27, s12, 3
    s_lshl_b32 s27, s27, 4
    s_add_u32 s26, s26, s27
    s_nop 0
    s_add_u32 s26, s26, 8388608
    v_min_u32 v18, 31, v1
    v_lshlrev_b32 v18, 2, v18
    s_waitcnt vmcnt(24)
    s_barrier
    s_add_u32 s19, s19, 114688
    s_add_u32 m0, s14, 8192
    s_nop 0
    s_nop 0
    buffer_load_dwordx4 v6, s[52:55], s19 offen lds
    buffer_load_dwordx4 v33, s[52:55], s19 offen offset:1024 lds
    s_add_u32 m0, s14, 10240
    s_nop 0
    s_nop 0
    buffer_load_dwordx4 v6, s[56:59], s19 offen lds
    buffer_load_dwordx4 v33, s[56:59], s19 offen offset:1024 lds
    s_add_u32 s18, s79, 5
    s_and_b32 s18, s18, 7
    s_lshl_b32 s18, s18, 7
    s_add_u32 s18, s18, s78
    s_add_u32 m0, s100, 65536
    s_nop 0
    s_nop 0
    buffer_load_dwordx4 v2, s[48:51], s18 offen lds
    buffer_load_dwordx4 v3, s[48:51], s18 offen offset:1024 lds
    buffer_load_dwordx4 v4, s[48:51], s18 offen offset:2048 lds
    buffer_load_dwordx4 v5, s[48:51], s18 offen offset:3072 lds
    s_add_u32 s18, s18, 32768
    s_add_u32 m0, s100, 69632
    s_nop 0
    s_nop 0
    buffer_load_dwordx4 v2, s[48:51], s18 offen lds
    buffer_load_dwordx4 v3, s[48:51], s18 offen offset:1024 lds
    buffer_load_dwordx4 v4, s[48:51], s18 offen offset:2048 lds
    buffer_load_dwordx4 v5, s[48:51], s18 offen offset:3072 lds
    s_add_u32 s18, s18, 32768
    s_add_u32 m0, s100, 73728
    s_nop 0
    s_nop 0
    buffer_load_dwordx4 v2, s[48:51], s18 offen lds
    buffer_load_dwordx4 v3, s[48:51], s18 offen offset:1024 lds
    buffer_load_dwordx4 v4, s[48:51], s18 offen offset:2048 lds
    buffer_load_dwordx4 v5, s[48:51], s18 offen offset:3072 lds
    s_waitcnt vmcnt(36)
    s_barrier
    s_add_u32 s18, s18, 32768
    s_add_u32 m0, s100, 77824
    s_nop 0
    s_nop 0
    buffer_load_dwordx4 v2, s[48:51], s18 offen lds
    buffer_load_dwordx4 v3, s[48:51], s18 offen offset:1024 lds
    buffer_load_dwordx4 v4, s[48:51], s18 offen offset:2048 lds
    buffer_load_dwordx4 v5, s[48:51], s18 offen offset:3072 lds
    s_add_u32 s19, s79, 5
    s_and_b32 s19, s19, 7
    s_mul_i32 s19, s19, 229376
    s_add_u32 s19, s19, s101
    s_nop 0
    s_add_u32 m0, s14, 16384
    s_nop 0
    s_nop 0
    buffer_load_dwordx4 v6, s[52:55], s19 offen lds
    buffer_load_dwordx4 v33, s[52:55], s19 offen offset:1024 lds
    s_add_u32 m0, s14, 18432
    s_nop 0
    s_nop 0
    buffer_load_dwordx4 v6, s[56:59], s19 offen lds
    buffer_load_dwordx4 v33, s[56:59], s19 offen offset:1024 lds
    s_waitcnt vmcnt(24)
    s_barrier
    s_add_u32 s19, s19, 114688
    s_add_u32 m0, s14, 24576
    s_nop 0
    s_nop 0
    buffer_load_dwordx4 v6, s[52:55], s19 offen lds
    buffer_load_dwordx4 v33, s[52:55], s19 offen offset:1024 lds
    s_add_u32 m0, s14, 26624
    s_nop 0
    s_nop 0
    buffer_load_dwordx4 v6, s[56:59], s19 offen lds
    buffer_load_dwordx4 v33, s[56:59], s19 offen offset:1024 lds
    s_add_u32 s18, s79, 6
    s_and_b32 s18, s18, 7
    s_lshl_b32 s18, s18, 7
    s_add_u32 s18, s18, s78
    s_add_u32 m0, s100, 0
    s_nop 0
    buffer_load_dwordx4 v2, s[48:51], s18 offen lds
    buffer_load_dwordx4 v3, s[48:51], s18 offen offset:1024 lds
    buffer_load_dwordx4 v4, s[48:51], s18 offen offset:2048 lds
    buffer_load_dwordx4 v5, s[48:51], s18 offen offset:3072 lds
    s_add_u32 s18, s18, 32768
    s_add_u32 m0, s100, 4096
    s_nop 0
    s_nop 0
    buffer_load_dwordx4 v2, s[48:51], s18 offen lds
    buffer_load_dwordx4 v3, s[48:51], s18 offen offset:1024 lds
    buffer_load_dwordx4 v4, s[48:51], s18 offen offset:2048 lds
    buffer_load_dwordx4 v5, s[48:51], s18 offen offset:3072 lds
    s_add_u32 s18, s18, 32768
    s_add_u32 m0, s100, 8192
    s_nop 0
    s_nop 0
    buffer_load_dwordx4 v2, s[48:51], s18 offen lds
    buffer_load_dwordx4 v3, s[48:51], s18 offen offset:1024 lds
    buffer_load_dwordx4 v4, s[48:51], s18 offen offset:2048 lds
    buffer_load_dwordx4 v5, s[48:51], s18 offen offset:3072 lds
    s_waitcnt vmcnt(36)
    s_barrier
    s_add_u32 s18, s18, 32768
    s_add_u32 m0, s100, 12288
    s_nop 0
    s_nop 0
    buffer_load_dwordx4 v2, s[48:51], s18 offen lds
    buffer_load_dwordx4 v3, s[48:51], s18 offen offset:1024 lds
    buffer_load_dwordx4 v4, s[48:51], s18 offen offset:2048 lds
    buffer_load_dwordx4 v5, s[48:51], s18 offen offset:3072 lds
    s_add_u32 s19, s79, 6
    s_and_b32 s19, s19, 7
    s_mul_i32 s19, s19, 229376
    s_add_u32 s19, s19, s101
    s_add_u32 m0, s14, 0
    s_nop 0
    s_nop 0
    buffer_load_dwordx4 v6, s[52:55], s19 offen lds
    buffer_load_dwordx4 v33, s[52:55], s19 offen offset:1024 lds
    s_add_u32 m0, s14, 2048
    s_nop 0
    s_nop 0
    buffer_load_dwordx4 v6, s[56:59], s19 offen lds
    buffer_load_dwordx4 v33, s[56:59], s19 offen offset:1024 lds
    s_waitcnt vmcnt(24)
    s_barrier
    s_add_u32 s19, s19, 114688
    s_add_u32 m0, s14, 8192
    s_nop 0
    s_nop 0
    buffer_load_dwordx4 v6, s[52:55], s19 offen lds
    buffer_load_dwordx4 v33, s[52:55], s19 offen offset:1024 lds
    s_add_u32 m0, s14, 10240
    s_nop 0
    s_nop 0
    buffer_load_dwordx4 v6, s[56:59], s19 offen lds
    buffer_load_dwordx4 v33, s[56:59], s19 offen offset:1024 lds
    s_add_u32 s18, s79, 7
    s_and_b32 s18, s18, 7
    s_lshl_b32 s18, s18, 7
    s_add_u32 s18, s18, s78
    s_add_u32 m0, s100, 32768
    s_nop 0
    s_nop 0
    buffer_load_dwordx4 v2, s[48:51], s18 offen lds
    buffer_load_dwordx4 v3, s[48:51], s18 offen offset:1024 lds
    buffer_load_dwordx4 v4, s[48:51], s18 offen offset:2048 lds
    buffer_load_dwordx4 v5, s[48:51], s18 offen offset:3072 lds
    s_add_u32 s18, s18, 32768
    s_add_u32 m0, s100, 36864
    s_nop 0
    s_nop 0
    buffer_load_dwordx4 v2, s[48:51], s18 offen lds
    buffer_load_dwordx4 v3, s[48:51], s18 offen offset:1024 lds
    buffer_load_dwordx4 v4, s[48:51], s18 offen offset:2048 lds
    buffer_load_dwordx4 v5, s[48:51], s18 offen offset:3072 lds
    s_add_u32 s18, s18, 32768
    s_add_u32 m0, s100, 40960
    s_nop 0
    s_nop 0
    buffer_load_dwordx4 v2, s[48:51], s18 offen lds
    buffer_load_dwordx4 v3, s[48:51], s18 offen offset:1024 lds
    buffer_load_dwordx4 v4, s[48:51], s18 offen offset:2048 lds
    buffer_load_dwordx4 v5, s[48:51], s18 offen offset:3072 lds
    s_waitcnt vmcnt(36)
    s_barrier
    s_add_u32 s18, s18, 32768
    s_add_u32 m0, s100, 45056
    s_nop 0
    s_nop 0
    buffer_load_dwordx4 v2, s[48:51], s18 offen lds
    buffer_load_dwordx4 v3, s[48:51], s18 offen offset:1024 lds
    buffer_load_dwordx4 v4, s[48:51], s18 offen offset:2048 lds
    buffer_load_dwordx4 v5, s[48:51], s18 offen offset:3072 lds
    s_add_u32 s19, s79, 7
    s_and_b32 s19, s19, 7
    s_mul_i32 s19, s19, 229376
    s_add_u32 s19, s19, s101
    s_nop 0
    s_add_u32 m0, s14, 16384
    s_nop 0
    s_nop 0
    buffer_load_dwordx4 v6, s[52:55], s19 offen lds
    buffer_load_dwordx4 v33, s[52:55], s19 offen offset:1024 lds
    s_add_u32 m0, s14, 18432
    s_nop 0
    s_nop 0
    buffer_load_dwordx4 v6, s[56:59], s19 offen lds
    buffer_load_dwordx4 v33, s[56:59], s19 offen offset:1024 lds
    s_waitcnt vmcnt(24)
    s_barrier
    s_add_u32 s19, s19, 114688
    s_add_u32 m0, s14, 24576
    s_nop 0
    s_nop 0
    buffer_load_dwordx4 v6, s[52:55], s19 offen lds
    buffer_load_dwordx4 v33, s[52:55], s19 offen offset:1024 lds
    s_add_u32 m0, s14, 26624
    s_nop 0
    s_nop 0
    buffer_load_dwordx4 v6, s[56:59], s19 offen lds
    buffer_load_dwordx4 v33, s[56:59], s19 offen offset:1024 lds
    s_add_u32 s47, s46, 0
    s_nop 0
    s_sub_u32 s20, s46, 458752
    s_min_u32 s47, s47, s20
    s_nop 0
    s_add_u32 m0, s100, 65536
    s_nop 0
    s_nop 0
    buffer_load_dwordx4 v8, s[60:63], s47 offen lds
    buffer_load_dwordx4 v9, s[60:63], s47 offen offset:1024 lds
    s_add_u32 s47, s47, 458752
    s_add_u32 m0, s100, 73728
    s_nop 0
    s_nop 0
    buffer_load_dwordx4 v8, s[60:63], s47 offen lds
    buffer_load_dwordx4 v9, s[60:63], s47 offen offset:1024 lds
    s_add_u32 s47, s46, 16384
    s_sub_u32 s20, s46, 442368
    s_min_u32 s47, s47, s20
    s_nop 0
    s_add_u32 m0, s100, 67584
    s_nop 0
    s_nop 0
    buffer_load_dwordx4 v8, s[60:63], s47 offen lds
    buffer_load_dwordx4 v9, s[60:63], s47 offen offset:1024 lds
    s_add_u32 s47, s47, 458752
    s_add_u32 m0, s100, 75776
    s_nop 0
    s_nop 0
    buffer_load_dwordx4 v8, s[60:63], s47 offen lds
    buffer_load_dwordx4 v9, s[60:63], s47 offen offset:1024 lds
    s_add_u32 s47, s46, 32768
    s_sub_u32 s20, s46, 425984
    s_min_u32 s47, s47, s20
    s_nop 0
    s_add_u32 m0, s100, 69632
    s_nop 0
    s_nop 0
    buffer_load_dwordx4 v8, s[60:63], s47 offen lds
    buffer_load_dwordx4 v9, s[60:63], s47 offen offset:1024 lds
    s_add_u32 s47, s47, 458752
    s_add_u32 m0, s100, 77824
    s_nop 0
    s_nop 0
    buffer_load_dwordx4 v8, s[60:63], s47 offen lds
    buffer_load_dwordx4 v9, s[60:63], s47 offen offset:1024 lds
    s_waitcnt vmcnt(36)
    s_barrier
    s_add_u32 s47, s46, 49152
    s_sub_u32 s20, s46, 409600
    s_min_u32 s47, s47, s20
    s_nop 0
    s_add_u32 m0, s100, 71680
    s_nop 0
    s_nop 0
    buffer_load_dwordx4 v8, s[60:63], s47 offen lds
    buffer_load_dwordx4 v9, s[60:63], s47 offen offset:1024 lds
    s_add_u32 s47, s47, 458752
    s_add_u32 m0, s100, 79872
    s_nop 0
    s_nop 0
    buffer_load_dwordx4 v8, s[60:63], s47 offen lds
    buffer_load_dwordx4 v9, s[60:63], s47 offen offset:1024 lds
    s_waitcnt vmcnt(20)
    s_barrier
    s_waitcnt vmcnt(16)
    s_barrier
    s_barrier
    s_nop 0
    s_add_u32 s47, s46, 65536
    s_sub_u32 s20, s46, 393216
    s_min_u32 s47, s47, s20
    s_add_u32 m0, s100, 0
    s_nop 0
    s_nop 0
    buffer_load_dwordx4 v8, s[60:63], s47 offen lds
    buffer_load_dwordx4 v9, s[60:63], s47 offen offset:1024 lds
    s_add_u32 s47, s47, 458752
    s_add_u32 m0, s100, 8192
    s_nop 0
    s_nop 0
    buffer_load_dwordx4 v8, s[60:63], s47 offen lds
    buffer_load_dwordx4 v9, s[60:63], s47 offen offset:1024 lds
    s_add_u32 s47, s46, 81920
    s_sub_u32 s20, s46, 376832
    s_min_u32 s47, s47, s20
    s_nop 0
    s_add_u32 m0, s100, 2048
    s_nop 0
    s_nop 0
    buffer_load_dwordx4 v8, s[60:63], s47 offen lds
    buffer_load_dwordx4 v9, s[60:63], s47 offen offset:1024 lds
    s_add_u32 s47, s47, 458752
    s_add_u32 m0, s100, 10240
    s_nop 0
    s_nop 0
    buffer_load_dwordx4 v8, s[60:63], s47 offen lds
    buffer_load_dwordx4 v9, s[60:63], s47 offen offset:1024 lds
    s_add_u32 s47, s46, 98304
    s_sub_u32 s20, s46, 360448
    s_min_u32 s47, s47, s20
    s_nop 0
    s_add_u32 m0, s100, 4096
    s_nop 0
    s_nop 0
    buffer_load_dwordx4 v8, s[60:63], s47 offen lds
    buffer_load_dwordx4 v9, s[60:63], s47 offen offset:1024 lds
    s_add_u32 s47, s47, 458752
    s_add_u32 m0, s100, 12288
    s_nop 0
    s_nop 0
    buffer_load_dwordx4 v8, s[60:63], s47 offen lds
    buffer_load_dwordx4 v9, s[60:63], s47 offen offset:1024 lds
    s_add_u32 s47, s46, 114688
    s_sub_u32 s20, s46, 344064
    s_min_u32 s47, s47, s20
    s_nop 0
    s_add_u32 m0, s100, 6144
    s_nop 0
    s_nop 0
    buffer_load_dwordx4 v8, s[60:63], s47 offen lds
    buffer_load_dwordx4 v9, s[60:63], s47 offen offset:1024 lds
    s_add_u32 s47, s47, 458752
    s_add_u32 m0, s100, 14336
    s_nop 0
    s_nop 0
    buffer_load_dwordx4 v8, s[60:63], s47 offen lds
    buffer_load_dwordx4 v9, s[60:63], s47 offen offset:1024 lds
.L_dpost:
    s_add_u32 s47, s46, 131072
    s_sub_u32 s20, s46, 327680
    s_min_u32 s47, s47, s20
    s_nop 0
    s_add_u32 m0, s100, 98304
    s_nop 0
    s_nop 0
    buffer_load_dwordx4 v8, s[60:63], s47 offen lds
    buffer_load_dwordx4 v9, s[60:63], s47 offen offset:1024 lds
    s_add_u32 s47, s47, 458752
    s_add_u32 m0, s100, 106496
    s_nop 0
    s_nop 0
    buffer_load_dwordx4 v8, s[60:63], s47 offen lds
    buffer_load_dwordx4 v9, s[60:63], s47 offen offset:1024 lds
    s_add_u32 s47, s46, 147456
    s_sub_u32 s20, s46, 311296
    s_min_u32 s47, s47, s20
    s_nop 0
    s_add_u32 m0, s100, 100352
    s_nop 0
    s_nop 0
    buffer_load_dwordx4 v8, s[60:63], s47 offen lds
    buffer_load_dwordx4 v9, s[60:63], s47 offen offset:1024 lds
    s_add_u32 s47, s47, 458752
    s_add_u32 m0, s100, 108544
    s_nop 0
    s_nop 0
    buffer_load_dwordx4 v8, s[60:63], s47 offen lds
    buffer_load_dwordx4 v9, s[60:63], s47 offen offset:1024 lds
    s_add_u32 s47, s46, 163840
    s_sub_u32 s20, s46, 294912
    s_min_u32 s47, s47, s20
    s_nop 0
    s_add_u32 m0, s100, 102400
    s_nop 0
    s_nop 0
    buffer_load_dwordx4 v8, s[60:63], s47 offen lds
    buffer_load_dwordx4 v9, s[60:63], s47 offen offset:1024 lds
    s_add_u32 s47, s47, 458752
    s_add_u32 m0, s100, 110592
    s_nop 0
    s_nop 0
    buffer_load_dwordx4 v8, s[60:63], s47 offen lds
    buffer_load_dwordx4 v9, s[60:63], s47 offen offset:1024 lds
    s_add_u32 s47, s46, 180224
    s_sub_u32 s20, s46, 278528
    s_min_u32 s47, s47, s20
    s_nop 0
    s_add_u32 m0, s100, 104448
    s_nop 0
    s_nop 0
    buffer_load_dwordx4 v8, s[60:63], s47 offen lds
    buffer_load_dwordx4 v9, s[60:63], s47 offen offset:1024 lds
    s_add_u32 s47, s47, 458752
    s_add_u32 m0, s100, 112640
    s_nop 0
    s_nop 0
    buffer_load_dwordx4 v8, s[60:63], s47 offen lds
    buffer_load_dwordx4 v9, s[60:63], s47 offen offset:1024 lds
    s_add_u32 s47, s46, 196608
    s_sub_u32 s20, s46, 262144
    s_min_u32 s47, s47, s20
    s_nop 0
    s_add_u32 m0, s100, 32768
    s_nop 0
    s_nop 0
    buffer_load_dwordx4 v8, s[60:63], s47 offen lds
    buffer_load_dwordx4 v9, s[60:63], s47 offen offset:1024 lds
    s_add_u32 s47, s47, 458752
    s_add_u32 m0, s100, 40960
    s_nop 0
    s_nop 0
    buffer_load_dwordx4 v8, s[60:63], s47 offen lds
    buffer_load_dwordx4 v9, s[60:63], s47 offen offset:1024 lds
    s_add_u32 s47, s46, 212992
    s_sub_u32 s20, s46, 245760
    s_min_u32 s47, s47, s20
    s_nop 0
    s_add_u32 m0, s100, 34816
    s_nop 0
    s_nop 0
    buffer_load_dwordx4 v8, s[60:63], s47 offen lds
    buffer_load_dwordx4 v9, s[60:63], s47 offen offset:1024 lds
    s_add_u32 s47, s47, 458752
    s_add_u32 m0, s100, 43008
    s_nop 0
    s_nop 0
    buffer_load_dwordx4 v8, s[60:63], s47 offen lds
    buffer_load_dwordx4 v9, s[60:63], s47 offen offset:1024 lds
    s_add_u32 s47, s46, 229376
    s_sub_u32 s20, s46, 229376
    s_min_u32 s47, s47, s20
    s_nop 0
    s_add_u32 m0, s100, 36864
    s_nop 0
    s_nop 0
    buffer_load_dwordx4 v8, s[60:63], s47 offen lds
    buffer_load_dwordx4 v9, s[60:63], s47 offen offset:1024 lds
    s_add_u32 s47, s47, 458752
    s_add_u32 m0, s100, 45056
    s_nop 0
    s_nop 0
    buffer_load_dwordx4 v8, s[60:63], s47 offen lds
    buffer_load_dwordx4 v9, s[60:63], s47 offen offset:1024 lds
    s_add_u32 s47, s46, 245760
    s_sub_u32 s20, s46, 212992
    s_min_u32 s47, s47, s20
    s_nop 0
    s_add_u32 m0, s100, 38912
    s_nop 0
    s_nop 0
    buffer_load_dwordx4 v8, s[60:63], s47 offen lds
    buffer_load_dwordx4 v9, s[60:63], s47 offen offset:1024 lds
    s_add_u32 s47, s47, 458752
    s_add_u32 m0, s100, 47104
    s_nop 0
    s_nop 0
    buffer_load_dwordx4 v8, s[60:63], s47 offen lds
    buffer_load_dwordx4 v9, s[60:63], s47 offen offset:1024 lds
.L_dpx:
    s_lshl_b32 s15, s10, 1
    s_nop 0
    s_add_u32 s15, s15, 147240
    v_mov_b32_e64 v16, s15
    s_mov_b32 s28, 2097152
.L_kf:
    ds_read_b32 v17, v16
    s_sub_u32 s28, s28, 1
    s_cbranch_scc1 .L_conv
    s_waitcnt lgkmcnt(0)
    v_readfirstlane_b32 s15, v17
    s_cmp_eq_u32 s15, 0
    s_cbranch_scc0 .L_conv
    s_sleep 1
    s_branch .L_kf
.L_daux:
    s_mov_b64 s[60:61], s[40:41]
    s_nop 0
    s_mov_b32 s62, 1835008
    s_mov_b32 s63, 0x20000
    s_mov_b64 s[64:65], s[42:43]
    s_nop 0
    s_mov_b32 s66, 0x200000
    s_mov_b32 s67, 0x20000
    s_mov_b64 s[68:69], s[46:47]
    s_nop 0
    s_mov_b32 s70, 18874368
    s_mov_b32 s71, 0x20000
    s_mov_b64 s[72:73], s[44:45]
    s_nop 0
    s_mov_b32 s74, 256
    s_mov_b32 s75, 0x20000
    s_mul_i32 s46, s10, 28
    s_lshl_b32 s46, s46, 14
    s_lshl_b32 s47, s6, 7
    s_add_u32 s46, s46, s47
    v_add_u32 v8, s46, v8
    v_add_u32_e64 v9, s46, v9
    s_lshl_b32 s46, s7, 1
    s_add_u32 s46, s46, s9
    s_and_b32 s46, s46, 7
    s_mul_i32 s46, s46, 7
    s_lshr_b32 s46, s46, 1
    s_lshl_b32 s46, s46, 14
    s_lshl_b32 s15, s2, 2
    s_load_dword s17, s[32:33], s15
    s_lshl_b32 s15, s2, 1
    s_add_u32 s12, s12, s15
    v_lshrrev_b32 v16, 5, v1
    v_lshlrev_b32 v10, 6, v16
    v_and_b32_e64 v17, 1, v1
    v_lshl_add_u32 v10, v17, 5, v10
    v_bfe_u32 v17, v1, 4, 1
    v_lshl_add_u32 v10, v17, 4, v10
    v_bfe_u32 v18, v1, 1, 1
    v_lshl_add_u32 v10, v18, 3, v10
    v_bfe_u32 v18, v1, 2, 2
    v_lshlrev_b32 v19, 3, v18
    v_sub_u32 v10, v10, v19
    s_add_u32 s15, s13, 32
    v_add_u32 v10, s15, v10
    v_and_b32_e64 v19, 3, v1
    v_lshl_add_u32 v19, v17, 2, v19
    v_sub_u32 v20, v19, v16
    v_add_u32 v20, 2, v20
    v_lshrrev_b32 v21, 1, v20
    v_lshlrev_b32 v11, 7, v21
    v_and_b32_e64 v20, 1, v20
    v_lshl_add_u32 v11, v20, 4, v11
    v_lshl_add_u32 v11, v18, 5, v11
    s_add_u32 s15, s13, 4160
    v_add_u32_e64 v11, s15, v11
    v_mul_u32_u24 v12, 129, v18
    v_lshl_add_u32 v12, v19, 1, v12
    v_add_u32_e64 v12, v12, v16
    s_add_u32 s15, s13, 6704
    v_lshl_add_u32 v12, v12, 4, s15
    v_and_b32 v20, 1, v18
    v_mul_u32_u24 v20, 3, v20
    v_xor_b32 v20, s11, v20
    v_lshrrev_b32 v21, 1, v18
    v_lshlrev_b32 v13, 9, v20
    v_lshrrev_b32 v22, 1, v19
    v_lshl_add_u32 v13, v22, 7, v13
    v_and_b32_e64 v22, 1, v19
    v_lshl_add_u32 v13, v22, 4, v13
    v_lshl_add_u32 v13, v16, 3, v13
    v_lshl_add_u32 v13, v21, 2, v13
    s_add_u32 s15, s13, 4672
    v_add_u32 v13, s15, v13
    v_lshlrev_b32 v14, 9, v20
    v_lshl_add_u32 v14, v19, 6, v14
    v_lshl_add_u32 v14, v16, 5, v14
    v_lshl_add_u32 v14, v21, 4, v14
    v_and_b32 v16, 15, v1
    v_lshrrev_b32 v17, 4, v1
    v_and_b32 v16, 7, v1
    v_lshlrev_b32 v15, 10, v16
    v_lshl_add_u32 v15, v17, 4, v15
    v_bfe_u32 v16, v1, 3, 1
    v_lshl_add_u32 v15, v16, 6, v15
    s_lshl_b32 s24, s8, 3
    s_add_u32 s24, s24, s10
    s_lshl_b32 s24, s24, 13
    s_lshl_b32 s25, s6, 7
    s_add_u32 s24, s24, s25
    v_lshrrev_b32 v16, 1, v1
    v_lshlrev_b32 v16, 14, v16
    v_and_b32 v17, 1, v1
    v_lshl_add_u32 v16, v17, 6, v16
    s_lshr_b32 s26, s12, 2
    s_lshl_b32 s26, s26, 7
    s_and_b32 s27, s12, 3
    s_lshl_b32 s27, s27, 4
    s_add_u32 s26, s26, s27
    s_nop 0
    s_add_u32 s26, s26, 8388608
    v_min_u32 v18, 31, v1
    v_lshlrev_b32 v18, 2, v18
    s_mul_i32 s18, s8, 57344
    s_mul_i32 s19, s10, 14336
    s_add_u32 s18, s18, s19
    v_lshlrev_b32 v40, 7, v1
    buffer_load_dword v41, v40, s[60:63], s18 offen
    s_add_u32 s18, s18, 8192
    buffer_load_dword v41, v40, s[60:63], s18 offen
    s_add_u32 s18, s18, 8192
    buffer_load_dword v41, v40, s[60:63], s18 offen
    s_add_u32 s18, s18, 8192
    v_min_u32 v40, 3968, v40
    buffer_load_dword v41, v40, s[60:63], s18 offen
    s_add_u32 s18, s18, 8192
    s_add_u32 s47, s46, 65536
    s_sub_u32 s20, s46, 393216
    s_min_u32 s47, s47, s20
    s_add_u32 m0, s100, 0
    s_nop 0
    s_nop 0
    buffer_load_dwordx4 v8, s[60:63], s47 offen lds
    buffer_load_dwordx4 v9, s[60:63], s47 offen offset:1024 lds
    s_add_u32 s47, s47, 458752
    s_add_u32 m0, s100, 8192
    s_nop 0
    s_nop 0
    buffer_load_dwordx4 v8, s[60:63], s47 offen lds
    buffer_load_dwordx4 v9, s[60:63], s47 offen offset:1024 lds
    s_add_u32 s47, s46, 81920
    s_sub_u32 s20, s46, 376832
    s_min_u32 s47, s47, s20
    s_nop 0
    s_add_u32 m0, s100, 2048
    s_nop 0
    s_nop 0
    buffer_load_dwordx4 v8, s[60:63], s47 offen lds
    buffer_load_dwordx4 v9, s[60:63], s47 offen offset:1024 lds
    s_add_u32 s47, s47, 458752
    s_add_u32 m0, s100, 10240
    s_nop 0
    s_nop 0
    buffer_load_dwordx4 v8, s[60:63], s47 offen lds
    buffer_load_dwordx4 v9, s[60:63], s47 offen offset:1024 lds
    s_barrier
    s_barrier
    s_barrier
    s_branch .L_dpx
.L_ln:
    v_lshrrev_b32 v8, 3, v1
    v_and_b32 v9, 7, v1
    v_lshlrev_b32_e64 v10, 12, v8
    v_lshl_add_u32 v10, v9, 4, v10
    s_and_b32 s12, s3, 3
    s_lshr_b32 s13, s3, 2
    s_lshl_b32 s10, s8, 16
    s_lshl_b32 s11, s12, 10
    s_add_u32 s10, s10, s11
    s_lshl_b32 s11, s13, 15
    s_add_u32 s10, s10, s11
    s_nop 0
    s_mov_b32 s50, 0x200000
    s_mov_b32 s51, 0x20000
    s_mov_b32 s15, 15597568
    s_waitcnt lgkmcnt(0)
    s_mov_b64 s[48:49], s[16:17]
    buffer_load_dwordx4 v[128:131], v10, s[48:51], s10 offen offset:0
    buffer_load_dwordx4 v[132:135], v10, s[48:51], s10 offen offset:128
    buffer_load_dwordx4 v[136:139], v10, s[48:51], s10 offen offset:256
    buffer_load_dwordx4 v[140:143], v10, s[48:51], s10 offen offset:384
    buffer_load_dwordx4 v[144:147], v10, s[48:51], s10 offen offset:512
    buffer_load_dwordx4 v[148:151], v10, s[48:51], s10 offen offset:640
    buffer_load_dwordx4 v[152:155], v10, s[48:51], s10 offen offset:768
    buffer_load_dwordx4 v[156:159], v10, s[48:51], s10 offen offset:896
    s_load_dword s34, s[46:47], s15
    s_mov_b64 s[60:61], s[40:41]
    s_nop 0
    s_mov_b32 s62, 1835008
    s_mov_b32 s63, 0x20000
    s_mov_b64 s[64:65], s[42:43]
    s_nop 0
    s_mov_b32 s66, 0x200000
    s_mov_b32 s67, 0x20000
    s_mov_b64 s[68:69], s[46:47]
    s_nop 0
    s_mov_b32 s70, 18874368
    s_mov_b32 s71, 0x20000
    s_mov_b64 s[72:73], s[44:45]
    s_nop 0
    s_mov_b32 s74, 256
    s_mov_b32 s75, 0x20000
    s_mul_i32 s10, s12, 16896
    s_mul_i32 s11, s13, 1056
    s_add_u32 s11, s11, s10
    s_nop 0
    v_mul_u32_u24 v11, 2112, v8
    v_lshl_add_u32 v11, v9, 4, v11
    v_add_u32_e64 v11, s11, v11
    v_bfe_u32 v12, v1, 2, 2
    v_and_b32_e64 v13, 1, v1
    v_lshl_add_u32 v12, v12, 1, v13
    v_mul_u32_u24 v12, 1056, v12
    v_lshrrev_b32_e64 v13, 4, v1
    v_lshl_add_u32 v12, v13, 4, v12
    v_bfe_u32 v13, v1, 1, 1
    v_lshl_add_u32 v12, v13, 3, v12
    s_lshl_b32 s11, s13, 9
    s_add_u32 s10, s10, s11
    v_add_u32 v12, s10, v12
    v_lshlrev_b32_e64 v13, 5, v8
    s_lshl_b32 s10, s8, 9
    s_lshl_b32 s11, s13, 8
    s_add_u32 s10, s10, s11
    s_lshl_b32 s11, s12, 3
    s_add_u32 s10, s10, s11
    s_add_u32 s10, s10, 10485760
    s_lshl_b32 s11, s8, 16
    s_lshl_b32 s12, s12, 14
    s_add_u32 s11, s11, s12
    s_lshl_b32 s13, s13, 13
    s_add_u32 s11, s11, s13
    s_nop 0
    s_add_u32 s11, s11, 8388608
    s_mov_b32 s14, 0x3f803f80
    v_mov_b32 v16, 0
    v_mov_b32 v17, 0
    v_mov_b32 v18, 0
    v_mov_b32 v19, 0
    v_mov_b32 v20, 0
    v_mov_b32 v21, 0
    s_waitcnt vmcnt(7)
    v_dot2c_f32_bf16 v16, s14, v128
    v_lshlrev_b32_e64 v64, 16, v128
    v_and_b32 v65, 0xffff0000, v128
    v_dot2c_f32_bf16 v17, s14, v129
    v_lshlrev_b32 v66, 16, v129
    v_and_b32 v67, 0xffff0000, v129
    v_dot2c_f32_bf16 v16, s14, v130
    v_lshlrev_b32 v68, 16, v130
    v_and_b32 v69, 0xffff0000, v130
    v_dot2c_f32_bf16 v17, s14, v131
    v_lshlrev_b32 v70, 16, v131
    v_and_b32 v71, 0xffff0000, v131
    s_waitcnt vmcnt(6)
    v_dot2c_f32_bf16 v16, s14, v132
    v_lshlrev_b32_e64 v72, 16, v132
    v_and_b32 v73, 0xffff0000, v132
    v_dot2c_f32_bf16 v17, s14, v133
    v_lshlrev_b32 v74, 16, v133
    v_and_b32 v75, 0xffff0000, v133
    v_dot2c_f32_bf16 v16, s14, v134
    v_lshlrev_b32 v76, 16, v134
    v_and_b32 v77, 0xffff0000, v134
    v_dot2c_f32_bf16 v17, s14, v135
    v_lshlrev_b32 v78, 16, v135
    v_and_b32 v79, 0xffff0000, v135
    s_waitcnt vmcnt(5)
    v_dot2c_f32_bf16 v16, s14, v136
    v_lshlrev_b32_e64 v80, 16, v136
    v_and_b32 v81, 0xffff0000, v136
    v_dot2c_f32_bf16 v17, s14, v137
    v_lshlrev_b32 v82, 16, v137
    v_and_b32 v83, 0xffff0000, v137
    v_dot2c_f32_bf16 v16, s14, v138
    v_lshlrev_b32 v84, 16, v138
    v_and_b32 v85, 0xffff0000, v138
    v_dot2c_f32_bf16 v17, s14, v139
    v_lshlrev_b32 v86, 16, v139
    v_and_b32 v87, 0xffff0000, v139
    s_waitcnt vmcnt(4)
    v_dot2c_f32_bf16 v16, s14, v140
    v_lshlrev_b32_e64 v88, 16, v140
    v_and_b32 v89, 0xffff0000, v140
    v_dot2c_f32_bf16 v17, s14, v141
    v_lshlrev_b32 v90, 16, v141
    v_and_b32 v91, 0xffff0000, v141
    v_dot2c_f32_bf16 v16, s14, v142
    v_lshlrev_b32 v92, 16, v142
    v_and_b32 v93, 0xffff0000, v142
    v_dot2c_f32_bf16 v17, s14, v143
    v_lshlrev_b32 v94, 16, v143
    v_and_b32 v95, 0xffff0000, v143
    s_waitcnt vmcnt(3)
    v_dot2c_f32_bf16 v16, s14, v144
    v_lshlrev_b32_e64 v96, 16, v144
    v_and_b32 v97, 0xffff0000, v144
    v_dot2c_f32_bf16 v17, s14, v145
    v_lshlrev_b32 v98, 16, v145
    v_and_b32 v99, 0xffff0000, v145
    v_dot2c_f32_bf16 v16, s14, v146
    v_lshlrev_b32 v100, 16, v146
    v_and_b32 v101, 0xffff0000, v146
    v_dot2c_f32_bf16 v17, s14, v147
    v_lshlrev_b32 v102, 16, v147
    v_and_b32 v103, 0xffff0000, v147
    s_waitcnt vmcnt(2)
    v_dot2c_f32_bf16 v16, s14, v148
    v_lshlrev_b32_e64 v104, 16, v148
    v_and_b32 v105, 0xffff0000, v148
    v_dot2c_f32_bf16 v17, s14, v149
    v_lshlrev_b32 v106, 16, v149
    v_and_b32 v107, 0xffff0000, v149
    v_dot2c_f32_bf16 v16, s14, v150
    v_lshlrev_b32 v108, 16, v150
    v_and_b32 v109, 0xffff0000, v150
    v_dot2c_f32_bf16 v17, s14, v151
    v_lshlrev_b32 v110, 16, v151
    v_and_b32 v111, 0xffff0000, v151
    s_waitcnt vmcnt(1)
    v_dot2c_f32_bf16 v16, s14, v152
    v_lshlrev_b32_e64 v112, 16, v152
    v_and_b32 v113, 0xffff0000, v152
    v_dot2c_f32_bf16 v17, s14, v153
    v_lshlrev_b32 v114, 16, v153
    v_and_b32 v115, 0xffff0000, v153
    v_dot2c_f32_bf16 v16, s14, v154
    v_lshlrev_b32 v116, 16, v154
    v_and_b32 v117, 0xffff0000, v154
    v_dot2c_f32_bf16 v17, s14, v155
    v_lshlrev_b32 v118, 16, v155
    v_and_b32 v119, 0xffff0000, v155
    s_waitcnt vmcnt(0)
    v_dot2c_f32_bf16 v16, s14, v156
    v_lshlrev_b32_e64 v120, 16, v156
    v_and_b32 v121, 0xffff0000, v156
    v_dot2c_f32_bf16 v17, s14, v157
    v_lshlrev_b32 v122, 16, v157
    v_and_b32 v123, 0xffff0000, v157
    v_dot2c_f32_bf16 v16, s14, v158
    v_lshlrev_b32 v124, 16, v158
    v_and_b32 v125, 0xffff0000, v158
    v_dot2c_f32_bf16 v17, s14, v159
    v_lshlrev_b32 v126, 16, v159
    v_and_b32 v127, 0xffff0000, v159
    s_cmp_lg_u32 s3, 7
    s_cbranch_scc1 .L_npw
    s_lshl_b32 s15, s2, 9
    v_and_b32 v24, 3, v1
    v_lshl_add_u32 v24, v24, 7, s15
    global_load_dword v200, v24, s[18:19]
    global_load_dword v201, v24, s[20:21]
    global_load_dword v202, v24, s[22:23]
    global_load_dword v203, v24, s[24:25]
    global_load_dword v204, v24, s[26:27]
    global_load_dword v205, v24, s[28:29]
    s_lshl_b32 s15, s2, 2
    v_mov_b32 v24, s15
    global_load_dword v206, v24, s[30:31]
.L_npw:
    v_add_f32 v16, v16, v17
    s_nop 1
    v_add_f32_dpp v16, v16, v16 quad_perm:[1,0,3,2] row_mask:0xf bank_mask:0xf
    s_nop 1
    s_nop 0
    v_add_f32_dpp v16, v16, v16 quad_perm:[2,3,0,1] row_mask:0xf bank_mask:0xf
    s_nop 1
    s_nop 0
    v_add_f32_dpp v16, v16, v16 row_half_mirror row_mask:0xf bank_mask:0xf
    v_mul_f32 v16, 0xbb000000, v16
    v_pk_add_f32 v[64:65], v[64:65], v[16:17] op_sel_hi:[1,0]
    v_pk_add_f32 v[66:67], v[66:67], v[16:17] op_sel_hi:[1,0]
    v_pk_add_f32 v[68:69], v[68:69], v[16:17] op_sel_hi:[1,0]
    v_pk_add_f32 v[70:71], v[70:71], v[16:17] op_sel_hi:[1,0]
    v_pk_add_f32 v[72:73], v[72:73], v[16:17] op_sel_hi:[1,0]
    v_pk_add_f32 v[74:75], v[74:75], v[16:17] op_sel_hi:[1,0]
    v_pk_add_f32 v[76:77], v[76:77], v[16:17] op_sel_hi:[1,0]
    v_pk_add_f32 v[78:79], v[78:79], v[16:17] op_sel_hi:[1,0]
    v_pk_add_f32 v[80:81], v[80:81], v[16:17] op_sel_hi:[1,0]
    v_pk_add_f32 v[82:83], v[82:83], v[16:17] op_sel_hi:[1,0]
    v_pk_add_f32 v[84:85], v[84:85], v[16:17] op_sel_hi:[1,0]
    v_pk_add_f32 v[86:87], v[86:87], v[16:17] op_sel_hi:[1,0]
    v_pk_add_f32 v[88:89], v[88:89], v[16:17] op_sel_hi:[1,0]
    v_pk_add_f32 v[90:91], v[90:91], v[16:17] op_sel_hi:[1,0]
    v_pk_add_f32 v[92:93], v[92:93], v[16:17] op_sel_hi:[1,0]
    v_pk_add_f32 v[94:95], v[94:95], v[16:17] op_sel_hi:[1,0]
    v_pk_add_f32 v[96:97], v[96:97], v[16:17] op_sel_hi:[1,0]
    v_pk_add_f32 v[98:99], v[98:99], v[16:17] op_sel_hi:[1,0]
    v_pk_add_f32 v[100:101], v[100:101], v[16:17] op_sel_hi:[1,0]
    v_pk_add_f32 v[102:103], v[102:103], v[16:17] op_sel_hi:[1,0]
    v_pk_add_f32 v[104:105], v[104:105], v[16:17] op_sel_hi:[1,0]
    v_pk_add_f32 v[106:107], v[106:107], v[16:17] op_sel_hi:[1,0]
    v_pk_add_f32 v[108:109], v[108:109], v[16:17] op_sel_hi:[1,0]
    v_pk_add_f32 v[110:111], v[110:111], v[16:17] op_sel_hi:[1,0]
    v_pk_add_f32 v[112:113], v[112:113], v[16:17] op_sel_hi:[1,0]
    v_pk_add_f32 v[114:115], v[114:115], v[16:17] op_sel_hi:[1,0]
    v_pk_add_f32 v[116:117], v[116:117], v[16:17] op_sel_hi:[1,0]
    v_pk_add_f32 v[118:119], v[118:119], v[16:17] op_sel_hi:[1,0]
    v_pk_add_f32 v[120:121], v[120:121], v[16:17] op_sel_hi:[1,0]
    v_pk_add_f32 v[122:123], v[122:123], v[16:17] op_sel_hi:[1,0]
    v_pk_add_f32 v[124:125], v[124:125], v[16:17] op_sel_hi:[1,0]
    v_pk_add_f32 v[126:127], v[126:127], v[16:17] op_sel_hi:[1,0]
    v_pk_fma_f32 v[18:19], v[64:65], v[64:65], v[18:19]
    v_pk_fma_f32 v[20:21], v[66:67], v[66:67], v[20:21]
    v_pk_fma_f32 v[18:19], v[68:69], v[68:69], v[18:19]
    v_pk_fma_f32 v[20:21], v[70:71], v[70:71], v[20:21]
    v_pk_fma_f32 v[18:19], v[72:73], v[72:73], v[18:19]
    v_pk_fma_f32 v[20:21], v[74:75], v[74:75], v[20:21]
    v_pk_fma_f32 v[18:19], v[76:77], v[76:77], v[18:19]
    v_pk_fma_f32 v[20:21], v[78:79], v[78:79], v[20:21]
    v_pk_fma_f32 v[18:19], v[80:81], v[80:81], v[18:19]
    v_pk_fma_f32 v[20:21], v[82:83], v[82:83], v[20:21]
    v_pk_fma_f32 v[18:19], v[84:85], v[84:85], v[18:19]
    v_pk_fma_f32 v[20:21], v[86:87], v[86:87], v[20:21]
    v_pk_fma_f32 v[18:19], v[88:89], v[88:89], v[18:19]
    v_pk_fma_f32 v[20:21], v[90:91], v[90:91], v[20:21]
    v_pk_fma_f32 v[18:19], v[92:93], v[92:93], v[18:19]
    v_pk_fma_f32 v[20:21], v[94:95], v[94:95], v[20:21]
    v_pk_fma_f32 v[18:19], v[96:97], v[96:97], v[18:19]
    v_pk_fma_f32 v[20:21], v[98:99], v[98:99], v[20:21]
    v_pk_fma_f32 v[18:19], v[100:101], v[100:101], v[18:19]
    v_pk_fma_f32 v[20:21], v[102:103], v[102:103], v[20:21]
    v_pk_fma_f32 v[18:19], v[104:105], v[104:105], v[18:19]
    v_pk_fma_f32 v[20:21], v[106:107], v[106:107], v[20:21]
    v_pk_fma_f32 v[18:19], v[108:109], v[108:109], v[18:19]
    v_pk_fma_f32 v[20:21], v[110:111], v[110:111], v[20:21]
    v_pk_fma_f32 v[18:19], v[112:113], v[112:113], v[18:19]
    v_pk_fma_f32 v[20:21], v[114:115], v[114:115], v[20:21]
    v_pk_fma_f32 v[18:19], v[116:117], v[116:117], v[18:19]
    v_pk_fma_f32 v[20:21], v[118:119], v[118:119], v[20:21]
    v_pk_fma_f32 v[18:19], v[120:121], v[120:121], v[18:19]
    v_pk_fma_f32 v[20:21], v[122:123], v[122:123], v[20:21]
    v_pk_fma_f32 v[18:19], v[124:125], v[124:125], v[18:19]
    v_pk_fma_f32 v[20:21], v[126:127], v[126:127], v[20:21]
    v_pk_add_f32 v[18:19], v[18:19], v[20:21]
    v_cvt_pk_bf16_f32 v17, v16, v16
    v_add_f32 v18, v18, v19
    s_nop 1
    v_add_f32_dpp v18, v18, v18 quad_perm:[1,0,3,2] row_mask:0xf bank_mask:0xf
    s_nop 1
    s_nop 0
    v_add_f32_dpp v18, v18, v18 quad_perm:[2,3,0,1] row_mask:0xf bank_mask:0xf
    s_nop 1
    s_nop 0
    v_add_f32_dpp v18, v18, v18 row_half_mirror row_mask:0xf bank_mask:0xf
    s_waitcnt lgkmcnt(0)
    s_add_u32 s34, s34, 2
    s_or_b32 s34, s34, 1
    s_nop 0
    v_mul_f32 v18, 0x3b000000, v18
    v_cvt_pk_bf16_f32 v18, v18, v18
    v_and_b32 v18, 0xffff0000, v18
    v_add_f32 v18, 0x3727c5ac, v18
    v_cvt_pk_bf16_f32 v18, v18, v18
    v_and_b32 v18, 0xffff0000, v18
    v_sqrt_f32_e64 v18, v18
    v_and_b32 v19, 0xffff0000, v17
    v_mov_b32_e64 v23, s34
    v_cvt_pk_bf16_f32 v22, v19, v18
    v_sub_f32_e64 v19, v19, v16
    v_and_b32 v20, 0xffff0000, v22
    v_rcp_f32_e64 v20, v20
    s_mov_b32 exec_lo, 0x01010101
    s_mov_b32 exec_hi, 0x01010101
    buffer_store_dwordx2 v[22:23], v13, s[68:71], s10 offen sc1
    s_mov_b64 exec, -1
    v_mul_f32 v21, v19, v20
    v_pk_fma_f32 v[64:65], v[64:65], v[20:21], v[20:21] op_sel:[0,0,1] op_sel_hi:[1,0,1]
    v_pk_fma_f32 v[66:67], v[66:67], v[20:21], v[20:21] op_sel:[0,0,1] op_sel_hi:[1,0,1]
    v_pk_fma_f32 v[68:69], v[68:69], v[20:21], v[20:21] op_sel:[0,0,1] op_sel_hi:[1,0,1]
    v_pk_fma_f32 v[70:71], v[70:71], v[20:21], v[20:21] op_sel:[0,0,1] op_sel_hi:[1,0,1]
    v_pk_fma_f32 v[72:73], v[72:73], v[20:21], v[20:21] op_sel:[0,0,1] op_sel_hi:[1,0,1]
    v_pk_fma_f32 v[74:75], v[74:75], v[20:21], v[20:21] op_sel:[0,0,1] op_sel_hi:[1,0,1]
    v_pk_fma_f32 v[76:77], v[76:77], v[20:21], v[20:21] op_sel:[0,0,1] op_sel_hi:[1,0,1]
    v_pk_fma_f32 v[78:79], v[78:79], v[20:21], v[20:21] op_sel:[0,0,1] op_sel_hi:[1,0,1]
    v_pk_fma_f32 v[80:81], v[80:81], v[20:21], v[20:21] op_sel:[0,0,1] op_sel_hi:[1,0,1]
    v_pk_fma_f32 v[82:83], v[82:83], v[20:21], v[20:21] op_sel:[0,0,1] op_sel_hi:[1,0,1]
    v_pk_fma_f32 v[84:85], v[84:85], v[20:21], v[20:21] op_sel:[0,0,1] op_sel_hi:[1,0,1]
    v_pk_fma_f32 v[86:87], v[86:87], v[20:21], v[20:21] op_sel:[0,0,1] op_sel_hi:[1,0,1]
    v_pk_fma_f32 v[88:89], v[88:89], v[20:21], v[20:21] op_sel:[0,0,1] op_sel_hi:[1,0,1]
    v_pk_fma_f32 v[90:91], v[90:91], v[20:21], v[20:21] op_sel:[0,0,1] op_sel_hi:[1,0,1]
    v_pk_fma_f32 v[92:93], v[92:93], v[20:21], v[20:21] op_sel:[0,0,1] op_sel_hi:[1,0,1]
    v_pk_fma_f32 v[94:95], v[94:95], v[20:21], v[20:21] op_sel:[0,0,1] op_sel_hi:[1,0,1]
    v_pk_fma_f32 v[96:97], v[96:97], v[20:21], v[20:21] op_sel:[0,0,1] op_sel_hi:[1,0,1]
    v_pk_fma_f32 v[98:99], v[98:99], v[20:21], v[20:21] op_sel:[0,0,1] op_sel_hi:[1,0,1]
    v_pk_fma_f32 v[100:101], v[100:101], v[20:21], v[20:21] op_sel:[0,0,1] op_sel_hi:[1,0,1]
    v_pk_fma_f32 v[102:103], v[102:103], v[20:21], v[20:21] op_sel:[0,0,1] op_sel_hi:[1,0,1]
    v_pk_fma_f32 v[104:105], v[104:105], v[20:21], v[20:21] op_sel:[0,0,1] op_sel_hi:[1,0,1]
    v_pk_fma_f32 v[106:107], v[106:107], v[20:21], v[20:21] op_sel:[0,0,1] op_sel_hi:[1,0,1]
    v_pk_fma_f32 v[108:109], v[108:109], v[20:21], v[20:21] op_sel:[0,0,1] op_sel_hi:[1,0,1]
    v_pk_fma_f32 v[110:111], v[110:111], v[20:21], v[20:21] op_sel:[0,0,1] op_sel_hi:[1,0,1]
    v_pk_fma_f32 v[112:113], v[112:113], v[20:21], v[20:21] op_sel:[0,0,1] op_sel_hi:[1,0,1]
    v_pk_fma_f32 v[114:115], v[114:115], v[20:21], v[20:21] op_sel:[0,0,1] op_sel_hi:[1,0,1]
    v_pk_fma_f32 v[116:117], v[116:117], v[20:21], v[20:21] op_sel:[0,0,1] op_sel_hi:[1,0,1]
    v_pk_fma_f32 v[118:119], v[118:119], v[20:21], v[20:21] op_sel:[0,0,1] op_sel_hi:[1,0,1]
    v_pk_fma_f32 v[120:121], v[120:121], v[20:21], v[20:21] op_sel:[0,0,1] op_sel_hi:[1,0,1]
    v_pk_fma_f32 v[122:123], v[122:123], v[20:21], v[20:21] op_sel:[0,0,1] op_sel_hi:[1,0,1]
    v_pk_fma_f32 v[124:125], v[124:125], v[20:21], v[20:21] op_sel:[0,0,1] op_sel_hi:[1,0,1]
    v_pk_fma_f32 v[126:127], v[126:127], v[20:21], v[20:21] op_sel:[0,0,1] op_sel_hi:[1,0,1]
    v_cvt_pk_bf16_f32 v128, v64, v65
    v_cvt_pk_bf16_f32 v129, v66, v67
    v_cvt_pk_bf16_f32 v130, v68, v69
    v_cvt_pk_bf16_f32 v131, v70, v71
    ds_write_b128 v11, v[128:131] offset:0
    v_cvt_pk_bf16_f32 v132, v72, v73
    v_cvt_pk_bf16_f32 v133, v74, v75
    v_cvt_pk_bf16_f32 v134, v76, v77
    v_cvt_pk_bf16_f32 v135, v78, v79
    ds_write_b128 v11, v[132:135] offset:128
    v_cvt_pk_bf16_f32 v136, v80, v81
    v_cvt_pk_bf16_f32 v137, v82, v83
    v_cvt_pk_bf16_f32 v138, v84, v85
    v_cvt_pk_bf16_f32 v139, v86, v87
    ds_write_b128 v11, v[136:139] offset:256
    v_cvt_pk_bf16_f32 v140, v88, v89
    v_cvt_pk_bf16_f32 v141, v90, v91
    v_cvt_pk_bf16_f32 v142, v92, v93
    v_cvt_pk_bf16_f32 v143, v94, v95
    ds_write_b128 v11, v[140:143] offset:384
    v_cvt_pk_bf16_f32 v144, v96, v97
    v_cvt_pk_bf16_f32 v145, v98, v99
    v_cvt_pk_bf16_f32 v146, v100, v101
    v_cvt_pk_bf16_f32 v147, v102, v103
    ds_write_b128 v11, v[144:147] offset:512
    v_cvt_pk_bf16_f32 v148, v104, v105
    v_cvt_pk_bf16_f32 v149, v106, v107
    v_cvt_pk_bf16_f32 v150, v108, v109
    v_cvt_pk_bf16_f32 v151, v110, v111
    ds_write_b128 v11, v[148:151] offset:640
    v_cvt_pk_bf16_f32 v152, v112, v113
    v_cvt_pk_bf16_f32 v153, v114, v115
    v_cvt_pk_bf16_f32 v154, v116, v117
    v_cvt_pk_bf16_f32 v155, v118, v119
    ds_write_b128 v11, v[152:155] offset:768
    v_cvt_pk_bf16_f32 v156, v120, v121
    v_cvt_pk_bf16_f32 v157, v122, v123
    v_cvt_pk_bf16_f32 v158, v124, v125
    v_cvt_pk_bf16_f32 v159, v126, v127
    ds_write_b128 v11, v[156:159] offset:896
    v_lshlrev_b32_e64 v13, 4, v1
    s_waitcnt lgkmcnt(0)
    s_barrier
    ds_read_b64_tr_b16 v[64:65], v12 offset:0
    ds_read_b64_tr_b16 v[66:67], v12 offset:8448
    ds_read_b64_tr_b16 v[68:69], v12 offset:64
    ds_read_b64_tr_b16 v[70:71], v12 offset:8512
    ds_read_b64_tr_b16 v[72:73], v12 offset:128
    ds_read_b64_tr_b16 v[74:75], v12 offset:8576
    ds_read_b64_tr_b16 v[76:77], v12 offset:192
    ds_read_b64_tr_b16 v[78:79], v12 offset:8640
    ds_read_b64_tr_b16 v[80:81], v12 offset:256
    ds_read_b64_tr_b16 v[82:83], v12 offset:8704
    ds_read_b64_tr_b16 v[84:85], v12 offset:320
    ds_read_b64_tr_b16 v[86:87], v12 offset:8768
    ds_read_b64_tr_b16 v[88:89], v12 offset:384
    ds_read_b64_tr_b16 v[90:91], v12 offset:8832
    s_waitcnt lgkmcnt(12)
    s_nop 0
    ds_read_b64_tr_b16 v[92:93], v12 offset:448
    ds_read_b64_tr_b16 v[94:95], v12 offset:8896
    s_waitcnt lgkmcnt(14)
    s_nop 0
    buffer_store_dwordx4 v[64:67], v13, s[68:71], s11 offen offset:0 sc1
    s_waitcnt lgkmcnt(12)
    s_nop 0
    buffer_store_dwordx4 v[68:71], v13, s[68:71], s11 offen offset:1024 sc1
    s_waitcnt lgkmcnt(10)
    s_nop 0
    buffer_store_dwordx4 v[72:75], v13, s[68:71], s11 offen offset:2048 sc1
    s_waitcnt lgkmcnt(8)
    s_nop 0
    buffer_store_dwordx4 v[76:79], v13, s[68:71], s11 offen offset:3072 sc1
    s_add_u32 s11, s11, 4096
    s_waitcnt lgkmcnt(6)
    s_nop 0
    buffer_store_dwordx4 v[80:83], v13, s[68:71], s11 offen offset:0 sc1
    s_waitcnt lgkmcnt(4)
    s_nop 0
    buffer_store_dwordx4 v[84:87], v13, s[68:71], s11 offen offset:1024 sc1
    s_waitcnt lgkmcnt(2)
    s_nop 0
    buffer_store_dwordx4 v[88:91], v13, s[68:71], s11 offen offset:2048 sc1
    s_waitcnt lgkmcnt(0)
    s_nop 0
    buffer_store_dwordx4 v[92:95], v13, s[68:71], s11 offen offset:3072 sc1
    s_waitcnt vmcnt(0)
    s_barrier
    s_cmp_lt_u32 s3, 4
    s_cbranch_scc0 .L_help
    s_cmp_lg_u32 s3, 0
    s_cbranch_scc1 .L_w03e
    s_lshl_b32 s13, s8, 2
    v_mov_b32 v13, 0
    v_mov_b32 v16, 1
    s_mov_b64 exec, 1
    buffer_store_dword v16, v13, s[72:75], s13 offen sc1
    s_mov_b64 exec, -1
    s_branch .L_w03e
.L_auxbar:
    s_barrier
    s_barrier
    s_barrier
    s_waitcnt vmcnt(0)
    s_branch .L_g2
    s_nop 0
.L_kw:
    s_mov_b64 s[48:49], s[16:17]
    s_cmp_ge_u32 s7, 28
    s_cbranch_scc1 .L_ktag
    s_nop 0
    s_load_dword s34, s[46:47], s15
.L_ktag:
    v_lshrrev_b32 v4, 5, v1
    v_lshlrev_b32 v2, 12, v4
    v_bfe_u32 v4, v1, 4, 1
    v_mul_u32_u24 v4, 1088, v4
    v_add_u32_e64 v2, v2, v4
    v_bfe_u32 v4, v1, 2, 2
    v_lshl_add_u32 v2, v4, 7, v2
    v_bfe_u32 v4, v1, 3, 1
    v_lshl_add_u32 v2, v4, 4, v2
    v_bfe_u32 v4, v1, 1, 1
    v_lshl_add_u32 v2, v4, 5, v2
    v_and_b32_e64 v4, 1, v1
    v_lshl_add_u32 v2, v4, 3, v2
    v_add_u32 v2, 98304, v2
    s_lshl_b32 s15, s12, 11
    v_add_u32 v2, s15, v2
    v_xor_b32 v3, 16, v2
    v_xor_b32 v24, 64, v2
    v_xor_b32 v25, 80, v2
    v_mov_b32 v56, 0x3f803f80
    v_mov_b32 v57, 0x3f803f80
    v_mov_b32 v58, 0x3f803f80
    v_mov_b32 v59, 0x3f803f80
    s_lshl_b32 s35, s101, 13
    s_lshl_b32 s15, s12, 9
    s_add_u32 s35, s35, s15
    s_nop 0
    s_add_u32 s35, s35, 10551296
    s_lshl_b32 s78, s4, 11
    s_lshl_b32 s15, s12, 10
    s_add_u32 s78, s78, s15
    s_nop 0
    s_add_u32 s78, s78, 10485760
    v_lshlrev_b32 v4, 3, v1
    v_lshlrev_b32_e64 v5, 4, v1
    s_lshl_b32 s15, s12, 9
    s_add_u32 s15, s15, 146048
    v_add_u32 v6, s15, v4
    s_lshl_b32 s15, s12, 8
    s_add_u32 s15, s15, 162432
    v_lshl_add_u32 v7, v1, 2, s15
    s_lshl_b32 s15, s12, 14
    s_nop 0
    s_add_u32 s15, s15, 65536
    v_and_b32 v60, 7, v1
    v_lshlrev_b32 v60, 4, v60
    v_lshl_add_u32 v60, v1, 7, v60
    v_add_u32 v44, s14, v60
    v_xor_b32 v45, 16, v44
    v_xor_b32 v46, 32, v44
    v_xor_b32 v47, 48, v44
    v_xor_b32_e64 v48, 64, v44
    v_xor_b32 v49, 80, v44
    v_xor_b32 v50, 96, v44
    v_xor_b32 v51, 112, v44
    v_lshrrev_b32_e64 v60, 5, v1
    v_bfe_u32 v61, v1, 3, 1
    v_lshl_add_u32 v60, v60, 2, v61
    v_bfe_u32 v61, v1, 2, 1
    v_bfe_u32 v62, v1, 4, 1
    v_lshl_add_u32 v61, v61, 1, v62
    v_bfe_u32 v62, v1, 1, 1
    v_lshl_add_u32 v61, v61, 1, v62
    v_xor_b32 v61, v61, v60
    v_lshlrev_b32 v61, 4, v61
    v_lshl_add_u32 v61, v60, 7, v61
    v_and_b32_e64 v62, 1, v1
    v_lshl_add_u32 v61, v62, 3, v61
    v_add_u32 v52, s14, v61
    v_xor_b32 v53, 32, v52
    v_add_u32 v54, s15, v61
    v_xor_b32_e64 v55, 32, v54
    s_mov_b64 s[60:61], s[40:41]
    s_mov_b32 s62, 1835008
    s_mov_b32 s63, 0x20000
    s_mov_b64 s[64:65], s[42:43]
    s_nop 0
    s_mov_b32 s66, 0x200000
    s_mov_b32 s67, 0x20000
    s_mov_b64 s[68:69], s[46:47]
    s_nop 0
    s_mov_b32 s70, 18874368
    s_mov_b32 s71, 0x20000
    s_mov_b64 s[72:73], s[44:45]
    s_nop 0
    s_mov_b32 s74, 256
    s_mov_b32 s75, 0x20000
    s_lshl_b32 s15, s2, 2
    s_nop 0
    s_load_dword s17, s[32:33], s15
    s_lshl_b32 s15, s2, 1
    s_add_u32 s12, s12, s15
    v_lshrrev_b32 v16, 5, v1
    v_lshlrev_b32 v10, 6, v16
    v_and_b32_e64 v17, 1, v1
    v_lshl_add_u32 v10, v17, 5, v10
    v_bfe_u32 v17, v1, 4, 1
    v_lshl_add_u32 v10, v17, 4, v10
    v_bfe_u32 v18, v1, 1, 1
    v_lshl_add_u32 v10, v18, 3, v10
    v_bfe_u32 v18, v1, 2, 2
    v_lshlrev_b32 v19, 3, v18
    v_sub_u32 v10, v10, v19
    s_add_u32 s15, s13, 32
    v_add_u32 v10, s15, v10
    v_and_b32_e64 v19, 3, v1
    v_lshl_add_u32 v19, v17, 2, v19
    v_sub_u32 v20, v19, v16
    v_add_u32 v20, 2, v20
    v_lshrrev_b32 v21, 1, v20
    v_lshlrev_b32 v11, 7, v21
    v_and_b32_e64 v20, 1, v20
    v_lshl_add_u32 v11, v20, 4, v11
    v_lshl_add_u32 v11, v18, 5, v11
    s_add_u32 s15, s13, 4160
    v_add_u32_e64 v11, s15, v11
    v_mul_u32_u24 v12, 129, v18
    v_lshl_add_u32 v12, v19, 1, v12
    v_add_u32_e64 v12, v12, v16
    s_add_u32 s15, s13, 6704
    v_lshl_add_u32 v12, v12, 4, s15
    v_and_b32 v20, 1, v18
    v_mul_u32_u24 v20, 3, v20
    v_xor_b32 v20, s11, v20
    v_lshrrev_b32 v21, 1, v18
    v_lshlrev_b32 v13, 9, v20
    v_lshrrev_b32 v22, 1, v19
    v_lshl_add_u32 v13, v22, 7, v13
    v_and_b32_e64 v22, 1, v19
    v_lshl_add_u32 v13, v22, 4, v13
    v_lshl_add_u32 v13, v16, 3, v13
    v_lshl_add_u32 v13, v21, 2, v13
    s_add_u32 s15, s13, 4672
    v_add_u32 v13, s15, v13
    v_lshlrev_b32 v14, 9, v20
    v_lshl_add_u32 v14, v19, 6, v14
    v_lshl_add_u32 v14, v16, 5, v14
    v_lshl_add_u32 v14, v21, 4, v14
    v_and_b32 v16, 15, v1
    v_lshrrev_b32 v17, 4, v1
    v_and_b32 v16, 7, v1
    v_lshlrev_b32 v15, 10, v16
    v_lshl_add_u32 v15, v17, 4, v15
    v_bfe_u32 v16, v1, 3, 1
    v_lshl_add_u32 v15, v16, 6, v15
    s_lshl_b32 s24, s8, 3
    s_add_u32 s24, s24, s10
    s_lshl_b32 s24, s24, 13
    s_lshl_b32 s25, s6, 7
    s_add_u32 s24, s24, s25
    v_lshrrev_b32 v16, 1, v1
    v_lshlrev_b32 v16, 14, v16
    v_and_b32 v17, 1, v1
    v_lshl_add_u32 v16, v17, 6, v16
    s_lshr_b32 s26, s12, 2
    s_lshl_b32 s26, s26, 7
    s_and_b32 s27, s12, 3
    s_lshl_b32 s27, s27, 4
    s_add_u32 s26, s26, s27
    s_nop 0
    s_add_u32 s26, s26, 8388608
    v_min_u32 v18, 31, v1
    v_lshlrev_b32 v18, 2, v18
    v_and_b32_e64 v60, 56, v4
    v_add_u32 v60, 147200, v60
    v_mov_b32 v62, 0
    v_mov_b32 v63, 0
    ds_write_b64 v60, v[62:63]
    s_waitcnt vmcnt(2)
    s_nop 0
    v_mul_f32 v64, 0x3fb8aa00, v36
    v_rndne_f32 v65, v64
    v_sub_f32 v64, v64, v65
    v_fmac_f32 v64, 0x36eca570, v36
    v_exp_f32 v64, v64
    v_cvt_i32_f32 v65, v65
    v_ldexp_f32 v64, v64, v65
    v_cvt_pk_bf16_f32 v64, v64, v64
    v_lshlrev_b32 v64, 16, v64
    v_mul_f32 v37, v64, v37
    v_mul_f32_e64 v38, v64, v38
    v_mul_f32 v37, 0x3fb8aa3b, v37
    v_mul_f32 v38, 0x3e22f983, v38
    v_exp_f32 v124, v37
    v_fract_f32 v125, v38
    v_cos_f32 v66, v125
    v_sin_f32 v67, v125
    v_mul_f32 v66, v66, v124
    v_mul_f32_e64 v67, v67, v124
    v_mul_f32 v126, 0x43800000, v37
    v_mul_f32 v127, 0x43800000, v38
    v_exp_f32 v126, v126
    v_fract_f32 v127, v127
    v_cos_f32 v68, v127
    v_sin_f32 v69, v127
    v_mul_f32 v68, v68, v126
    v_mul_f32 v69, v69, v126
    v_mul_f32 v70, v66, v66
    v_mul_f32 v71, v66, v67
    v_fma_f32 v70, -v67, v67, v70
    v_fmac_f32_e64 v71, v67, v66
    v_cvt_pk_bf16_f32 v208, 1.0, v66
    v_cvt_pk_bf16_f32 v212, 0, -v67
    v_mul_f32 v72, v68, v68
    v_mul_f32 v73, v68, v69
    v_fma_f32 v72, -v69, v69, v72
    v_fmac_f32 v73, v69, v68
    v_mul_f32 v74, v70, v66
    v_mul_f32_e64 v75, v70, v67
    v_fma_f32 v74, -v71, v67, v74
    v_fmac_f32 v75, v71, v66
    v_mul_f32 v76, v70, v70
    v_mul_f32_e64 v77, v70, v71
    v_fma_f32 v76, -v71, v71, v76
    v_fmac_f32_e64 v77, v71, v70
    v_cvt_pk_bf16_f32 v209, v70, v74
    v_cvt_pk_bf16_f32 v213, -v71, -v75
    v_mul_f32 v78, v68, v70
    v_mul_f32 v79, v68, v71
    v_fma_f32 v78, -v69, v71, v78
    v_fmac_f32_e64 v79, v69, v70
    v_cvt_pk_bf16_f32 v210, v68, v68
    v_cvt_pk_bf16_f32 v214, -v69, -v69
    v_mul_f32 v80, v72, v68
    v_mul_f32 v81, v72, v69
    v_fma_f32 v80, -v73, v69, v80
    v_fmac_f32 v81, v73, v68
    v_mul_f32 v82, v68, v76
    v_mul_f32_e64 v83, v68, v77
    v_fma_f32 v82, -v69, v77, v82
    v_fmac_f32 v83, v69, v76
    v_mul_f32 v84, v76, v66
    v_mul_f32_e64 v85, v76, v67
    v_fma_f32 v84, -v77, v67, v84
    v_fmac_f32_e64 v85, v77, v66
    v_cvt_pk_bf16_f32 v211, v78, v82
    v_cvt_pk_bf16_f32 v215, -v79, -v83
    ds_write_b128 v44, v[208:211]
    ds_write_b128 v48, v[212:215]
    v_mul_f32 v86, v76, v70
    v_mul_f32 v87, v76, v71
    v_fma_f32 v86, -v77, v71, v86
    v_fmac_f32_e64 v87, v77, v70
    v_cvt_pk_bf16_f32 v216, v76, v84
    v_cvt_pk_bf16_f32 v220, -v77, -v85
    v_mul_f32 v88, v76, v76
    v_mul_f32 v89, v76, v77
    v_fma_f32 v88, -v77, v77, v88
    v_fmac_f32 v89, v77, v76
    v_mul_f32 v90, v76, v74
    v_mul_f32_e64 v91, v76, v75
    v_fma_f32 v90, -v77, v75, v90
    v_fmac_f32 v91, v77, v74
    v_mul_f32 v92, v72, v72
    v_mul_f32_e64 v93, v72, v73
    v_fma_f32 v92, -v73, v73, v92
    v_fmac_f32_e64 v93, v73, v72
    v_cvt_pk_bf16_f32 v217, v86, v90
    v_cvt_pk_bf16_f32 v221, -v87, -v91
    v_mul_f32 v94, v68, v86
    v_mul_f32 v95, v68, v87
    v_fma_f32 v94, -v69, v87, v94
    v_fmac_f32_e64 v95, v69, v86
    v_cvt_pk_bf16_f32 v218, v82, v82
    v_cvt_pk_bf16_f32 v222, -v83, -v83
    v_mul_f32 v96, v68, v88
    v_mul_f32 v97, v68, v89
    v_fma_f32 v96, -v69, v89, v96
    v_fmac_f32 v97, v69, v88
    v_mul_f32 v98, v72, v76
    v_mul_f32_e64 v99, v72, v77
    v_fma_f32 v98, -v73, v77, v98
    v_fmac_f32_e64 v99, v73, v76
    v_cvt_pk_bf16_f32 v219, v94, v96
    v_cvt_pk_bf16_f32 v223, -v95, -v97
    ds_write_b128 v45, v[216:219]
    ds_write_b128 v49, v[220:223]
    v_mul_f32 v100, v72, v88
    v_mul_f32 v101, v72, v89
    v_fma_f32 v100, -v73, v89, v100
    v_fmac_f32_e64 v101, v73, v88
    v_cvt_pk_bf16_f32 v208, v72, v98
    v_cvt_pk_bf16_f32 v212, -v73, -v99
    v_mul_f32 v102, v80, v76
    v_mul_f32 v103, v80, v77
    v_fma_f32 v102, -v81, v77, v102
    v_fmac_f32_e64 v103, v81, v76
    v_cvt_pk_bf16_f32 v209, v100, v92
    v_cvt_pk_bf16_f32 v213, -v101, -v93
    v_mul_f32 v104, v80, v88
    v_mul_f32 v105, v80, v89
    v_fma_f32 v104, -v81, v89, v104
    v_fmac_f32_e64 v105, v81, v88
    v_cvt_pk_bf16_f32 v210, v80, v102
    v_cvt_pk_bf16_f32 v214, -v81, -v103
    v_mul_f32 v106, v92, v68
    v_mul_f32 v107, v92, v69
    v_fma_f32 v106, -v93, v69, v106
    v_fmac_f32 v107, v93, v68
    v_mul_f32 v108, v92, v72
    v_mul_f32_e64 v109, v92, v73
    v_fma_f32 v108, -v93, v73, v108
    v_fmac_f32_e64 v109, v93, v72
    v_cvt_pk_bf16_f32 v211, v104, v106
    v_cvt_pk_bf16_f32 v215, -v105, -v107
    ds_write_b128 v46, v[208:211]
    ds_write_b128 v50, v[212:215]
    v_mul_f32 v110, v92, v88
    v_mul_f32 v111, v92, v89
    v_fma_f32 v110, -v93, v89, v110
    v_fmac_f32 v111, v93, v88
    v_mul_f32 v112, v92, v80
    v_mul_f32_e64 v113, v92, v81
    v_fma_f32 v112, -v93, v81, v112
    v_fmac_f32_e64 v113, v93, v80
    v_cvt_pk_bf16_f32 v216, v110, v108
    v_cvt_pk_bf16_f32 v220, -v111, -v109
    v_mul_f32 v114, v106, v88
    v_mul_f32 v115, v106, v89
    v_fma_f32 v114, -v107, v89, v114
    v_fmac_f32 v115, v107, v88
    v_mul_f32 v116, v108, v88
    v_mul_f32_e64 v117, v108, v89
    v_fma_f32 v116, -v109, v89, v116
    v_fmac_f32 v117, v109, v88
    v_mul_f32 v118, v112, v88
    v_mul_f32_e64 v119, v112, v89
    v_fma_f32 v118, -v113, v89, v118
    v_fmac_f32_e64 v119, v113, v88
    v_cvt_pk_bf16_f32 v217, v116, v116
    v_cvt_pk_bf16_f32 v221, -v117, -v117
    v_cvt_pk_bf16_f32 v218, v114, v112
    v_cvt_pk_bf16_f32 v222, -v115, -v113
    v_cvt_pk_bf16_f32 v219, v118, v118
    v_cvt_pk_bf16_f32 v223, -v119, -v119
    ds_write_b128 v47, v[216:219]
    ds_write_b128 v51, v[220:223]
    s_waitcnt vmcnt(0)
    s_nop 0
    ds_read_b64_tr_b16 v[160:161], v52 offset:0
    ds_read_b64_tr_b16 v[162:163], v53 offset:256
    ds_read_b64_tr_b16 v[164:165], v52 offset:1024
    ds_read_b64_tr_b16 v[166:167], v53 offset:1280
    ds_read_b64_tr_b16 v[168:169], v52 offset:2048
    ds_read_b64_tr_b16 v[170:171], v53 offset:2304
    ds_read_b64_tr_b16 v[172:173], v52 offset:3072
    ds_read_b64_tr_b16 v[174:175], v53 offset:3328
    ds_read_b64_tr_b16 v[176:177], v52 offset:4096
    ds_read_b64_tr_b16 v[178:179], v53 offset:4352
    ds_read_b64_tr_b16 v[180:181], v52 offset:5120
    ds_read_b64_tr_b16 v[182:183], v53 offset:5376
    ds_read_b64_tr_b16 v[184:185], v52 offset:6144
    ds_read_b64_tr_b16 v[186:187], v53 offset:6400
    ds_read_b64_tr_b16 v[188:189], v52 offset:7168
    ds_read_b64_tr_b16 v[190:191], v53 offset:7424
    v_mul_f32 v39, v64, v39
    v_mul_f32 v40, v64, v40
    v_mul_f32 v39, 0x3fb8aa3b, v39
    v_mul_f32 v40, 0x3e22f983, v40
    v_exp_f32 v124, v39
    v_fract_f32 v125, v40
    v_cos_f32 v66, v125
    v_sin_f32 v67, v125
    v_mul_f32 v66, v66, v124
    v_mul_f32_e64 v67, v67, v124
    v_mul_f32 v126, 0x43800000, v39
    v_mul_f32 v127, 0x43800000, v40
    v_exp_f32 v126, v126
    v_fract_f32 v127, v127
    v_cos_f32 v68, v127
    v_sin_f32 v69, v127
    v_mul_f32 v68, v68, v126
    v_mul_f32 v69, v69, v126
    v_mul_f32 v70, v66, v66
    v_mul_f32 v71, v66, v67
    v_fma_f32 v70, -v67, v67, v70
    v_fmac_f32_e64 v71, v67, v66
    v_cvt_pk_bf16_f32 v208, 1.0, v66
    v_cvt_pk_bf16_f32 v212, 0, -v67
    v_mul_f32 v72, v68, v68
    v_mul_f32 v73, v68, v69
    v_fma_f32 v72, -v69, v69, v72
    v_fmac_f32 v73, v69, v68
    v_mul_f32 v74, v70, v66
    v_mul_f32_e64 v75, v70, v67
    v_fma_f32 v74, -v71, v67, v74
    v_fmac_f32 v75, v71, v66
    v_mul_f32 v76, v70, v70
    v_mul_f32_e64 v77, v70, v71
    v_fma_f32 v76, -v71, v71, v76
    v_fmac_f32_e64 v77, v71, v70
    v_cvt_pk_bf16_f32 v209, v70, v74
    v_cvt_pk_bf16_f32 v213, -v71, -v75
    v_mul_f32 v78, v68, v70
    v_mul_f32 v79, v68, v71
    v_fma_f32 v78, -v69, v71, v78
    v_fmac_f32_e64 v79, v69, v70
    v_cvt_pk_bf16_f32 v210, v68, v68
    v_cvt_pk_bf16_f32 v214, -v69, -v69
    v_mul_f32 v80, v72, v68
    v_mul_f32 v81, v72, v69
    v_fma_f32 v80, -v73, v69, v80
    v_fmac_f32 v81, v73, v68
    v_mul_f32 v82, v68, v76
    v_mul_f32_e64 v83, v68, v77
    v_fma_f32 v82, -v69, v77, v82
    v_fmac_f32 v83, v69, v76
    v_mul_f32 v84, v76, v66
    v_mul_f32_e64 v85, v76, v67
    v_fma_f32 v84, -v77, v67, v84
    v_fmac_f32_e64 v85, v77, v66
    v_cvt_pk_bf16_f32 v211, v78, v82
    v_cvt_pk_bf16_f32 v215, -v79, -v83
    ds_write_b128 v44, v[208:211]
    ds_write_b128 v48, v[212:215]
    v_mul_f32 v86, v76, v70
    v_mul_f32 v87, v76, v71
    v_fma_f32 v86, -v77, v71, v86
    v_fmac_f32_e64 v87, v77, v70
    v_cvt_pk_bf16_f32 v216, v76, v84
    v_cvt_pk_bf16_f32 v220, -v77, -v85
    v_mul_f32 v88, v76, v76
    v_mul_f32 v89, v76, v77
    v_fma_f32 v88, -v77, v77, v88
    v_fmac_f32 v89, v77, v76
    v_mul_f32 v90, v76, v74
    v_mul_f32_e64 v91, v76, v75
    v_fma_f32 v90, -v77, v75, v90
    v_fmac_f32 v91, v77, v74
    v_mul_f32 v92, v72, v72
    v_mul_f32_e64 v93, v72, v73
    v_fma_f32 v92, -v73, v73, v92
    v_fmac_f32_e64 v93, v73, v72
    v_cvt_pk_bf16_f32 v217, v86, v90
    v_cvt_pk_bf16_f32 v221, -v87, -v91
    v_mul_f32 v94, v68, v86
    v_mul_f32 v95, v68, v87
    v_fma_f32 v94, -v69, v87, v94
    v_fmac_f32_e64 v95, v69, v86
    v_cvt_pk_bf16_f32 v218, v82, v82
    v_cvt_pk_bf16_f32 v222, -v83, -v83
    v_mul_f32 v96, v68, v88
    v_mul_f32 v97, v68, v89
    v_fma_f32 v96, -v69, v89, v96
    v_fmac_f32 v97, v69, v88
    v_mul_f32 v98, v72, v76
    v_mul_f32_e64 v99, v72, v77
    v_fma_f32 v98, -v73, v77, v98
    v_fmac_f32_e64 v99, v73, v76
    v_cvt_pk_bf16_f32 v219, v94, v96
    v_cvt_pk_bf16_f32 v223, -v95, -v97
    ds_write_b128 v45, v[216:219]
    ds_write_b128 v49, v[220:223]
    v_mul_f32 v100, v72, v88
    v_mul_f32 v101, v72, v89
    v_fma_f32 v100, -v73, v89, v100
    v_fmac_f32_e64 v101, v73, v88
    v_cvt_pk_bf16_f32 v208, v72, v98
    v_cvt_pk_bf16_f32 v212, -v73, -v99
    v_mul_f32 v102, v80, v76
    v_mul_f32 v103, v80, v77
    v_fma_f32 v102, -v81, v77, v102
    v_fmac_f32_e64 v103, v81, v76
    v_cvt_pk_bf16_f32 v209, v100, v92
    v_cvt_pk_bf16_f32 v213, -v101, -v93
    v_mul_f32 v104, v80, v88
    v_mul_f32 v105, v80, v89
    v_fma_f32 v104, -v81, v89, v104
    v_fmac_f32_e64 v105, v81, v88
    v_cvt_pk_bf16_f32 v210, v80, v102
    v_cvt_pk_bf16_f32 v214, -v81, -v103
    v_mul_f32 v106, v92, v68
    v_mul_f32 v107, v92, v69
    v_fma_f32 v106, -v93, v69, v106
    v_fmac_f32 v107, v93, v68
    v_mul_f32 v108, v92, v72
    v_mul_f32_e64 v109, v92, v73
    v_fma_f32 v108, -v93, v73, v108
    v_fmac_f32_e64 v109, v93, v72
    v_cvt_pk_bf16_f32 v211, v104, v106
    v_cvt_pk_bf16_f32 v215, -v105, -v107
    ds_write_b128 v46, v[208:211]
    ds_write_b128 v50, v[212:215]
    v_mul_f32 v110, v92, v88
    v_mul_f32 v111, v92, v89
    v_fma_f32 v110, -v93, v89, v110
    v_fmac_f32 v111, v93, v88
    v_mul_f32 v112, v92, v80
    v_mul_f32_e64 v113, v92, v81
    v_fma_f32 v112, -v93, v81, v112
    v_fmac_f32_e64 v113, v93, v80
    v_cvt_pk_bf16_f32 v216, v110, v108
    v_cvt_pk_bf16_f32 v220, -v111, -v109
    v_mul_f32 v114, v106, v88
    v_mul_f32 v115, v106, v89
    v_fma_f32 v114, -v107, v89, v114
    v_fmac_f32 v115, v107, v88
    v_mul_f32 v116, v108, v88
    v_mul_f32_e64 v117, v108, v89
    v_fma_f32 v116, -v109, v89, v116
    v_fmac_f32 v117, v109, v88
    v_mul_f32 v118, v112, v88
    v_mul_f32_e64 v119, v112, v89
    v_fma_f32 v118, -v113, v89, v118
    v_fmac_f32_e64 v119, v113, v88
    v_cvt_pk_bf16_f32 v217, v116, v116
    v_cvt_pk_bf16_f32 v221, -v117, -v117
    v_cvt_pk_bf16_f32 v218, v114, v112
    v_cvt_pk_bf16_f32 v222, -v115, -v113
    v_cvt_pk_bf16_f32 v219, v118, v118
    v_cvt_pk_bf16_f32 v223, -v119, -v119
    ds_write_b128 v47, v[216:219]
    ds_write_b128 v51, v[220:223]
    ds_read_b64_tr_b16 v[64:65], v52 offset:0
    ds_read_b64_tr_b16 v[66:67], v53 offset:256
    ds_read_b64_tr_b16 v[68:69], v52 offset:1024
    ds_read_b64_tr_b16 v[70:71], v53 offset:1280
    ds_read_b64_tr_b16 v[72:73], v52 offset:2048
    ds_read_b64_tr_b16 v[74:75], v53 offset:2304
    ds_read_b64_tr_b16 v[76:77], v52 offset:3072
    ds_read_b64_tr_b16 v[78:79], v53 offset:3328
    ds_read_b64_tr_b16 v[80:81], v52 offset:4096
    ds_read_b64_tr_b16 v[82:83], v53 offset:4352
    ds_read_b64_tr_b16 v[84:85], v52 offset:5120
    ds_read_b64_tr_b16 v[86:87], v53 offset:5376
    ds_read_b64_tr_b16 v[88:89], v52 offset:6144
    ds_read_b64_tr_b16 v[90:91], v53 offset:6400
    ds_read_b64_tr_b16 v[92:93], v52 offset:7168
    ds_read_b64_tr_b16 v[94:95], v53 offset:7424
    v_lshlrev_b32_e64 v60, 4, v1
    v_add_u32 v61, 4160, v60
    v_subrev_u32 v63, 512, v60
    v_cmp_gt_u32 vcc, 32, v1
    v_mov_b32 v208, 0
    v_mov_b32 v209, 0
    v_cndmask_b32 v61, v63, v61, vcc
    v_subrev_u32 v63, 36, v1
    v_min_u32 v63, 2, v63
    v_mul_u32_u24 v63, 2064, v63
    v_cmp_gt_u32_e64 vcc, 36, v1
    v_add_u32 v63, 8768, v63
    v_mov_b32 v210, 0
    v_cndmask_b32 v61, v63, v61, vcc
    v_add_u32 v61, s13, v61
    v_and_b32 v62, 1, v1
    v_cmp_eq_u32 vcc, 0, v62
    v_add_u32 v63, s13, v60
    v_mov_b32_e64 v211, 0
    ds_write_b128 v61, v[208:211]
    s_setprio 0
    s_barrier
    ds_read_b64_tr_b16 v[128:129], v54 offset:0
    ds_read_b64_tr_b16 v[130:131], v55 offset:256
    ds_read_b64_tr_b16 v[132:133], v54 offset:1024
    ds_read_b64_tr_b16 v[134:135], v55 offset:1280
    ds_read_b64_tr_b16 v[136:137], v54 offset:2048
    ds_read_b64_tr_b16 v[138:139], v55 offset:2304
    ds_read_b64_tr_b16 v[140:141], v54 offset:3072
    ds_read_b64_tr_b16 v[142:143], v55 offset:3328
    ds_read_b64_tr_b16 v[144:145], v54 offset:4096
    ds_read_b64_tr_b16 v[146:147], v55 offset:4352
    ds_read_b64_tr_b16 v[148:149], v54 offset:5120
    ds_read_b64_tr_b16 v[150:151], v55 offset:5376
    ds_read_b64_tr_b16 v[152:153], v54 offset:6144
    ds_read_b64_tr_b16 v[154:155], v55 offset:6400
    ds_read_b64_tr_b16 v[156:157], v54 offset:7168
    ds_read_b64_tr_b16 v[158:159], v55 offset:7424
    s_setprio 1
    s_waitcnt lgkmcnt(0)
    s_waitcnt lgkmcnt(0)
    s_setprio 0
    s_barrier
    s_nop 0
    ds_read_b64_tr_b16 v[224:225], v54 offset:8192
    ds_read_b64_tr_b16 v[226:227], v55 offset:8448
    ds_read_b64_tr_b16 v[228:229], v54 offset:9216
    ds_read_b64_tr_b16 v[230:231], v55 offset:9472
    ds_read_b64_tr_b16 v[232:233], v54 offset:10240
    ds_read_b64_tr_b16 v[234:235], v55 offset:10496
    ds_read_b64_tr_b16 v[236:237], v54 offset:11264
    ds_read_b64_tr_b16 v[238:239], v55 offset:11520
    ds_read_b64_tr_b16 v[240:241], v54 offset:12288
    ds_read_b64_tr_b16 v[242:243], v55 offset:12544
    ds_read_b64_tr_b16 v[244:245], v54 offset:13312
    ds_read_b64_tr_b16 v[246:247], v55 offset:13568
    ds_read_b64_tr_b16 v[248:249], v54 offset:14336
    ds_read_b64_tr_b16 v[250:251], v55 offset:14592
    ds_read_b64_tr_b16 v[252:253], v54 offset:15360
    ds_read_b64_tr_b16 v[254:255], v55 offset:15616
    s_setprio 1
    s_waitcnt lgkmcnt(0)
    s_waitcnt lgkmcnt(0)
    s_setprio 0
    s_cmp_ge_u32 s7, 28
    s_cbranch_scc1 .L_mo1
    s_barrier
.L_mo1:
    s_nop 0
    ds_read_b64_tr_b16 v[192:193], v2 offset:16384
    ds_read_b64_tr_b16 v[194:195], v2 offset:16896
    ds_read_b64_tr_b16 v[196:197], v3 offset:16384
    ds_read_b64_tr_b16 v[198:199], v3 offset:16896
    ds_read_b64_tr_b16 v[200:201], v24 offset:16384
    ds_read_b64_tr_b16 v[202:203], v24 offset:16896
    ds_read_b64_tr_b16 v[204:205], v25 offset:16384
    ds_read_b64_tr_b16 v[206:207], v25 offset:16896
    s_setprio 1
    s_waitcnt lgkmcnt(0)
    v_mfma_f32_16x16x32_bf16 v[96:99], v[56:59], v[192:195], 0
    v_mfma_f32_16x16x32_bf16 v[100:103], v[56:59], v[196:199], 0
    v_mfma_f32_16x16x32_bf16 v[104:107], v[56:59], v[200:203], 0
    v_mfma_f32_16x16x32_bf16 v[108:111], v[56:59], v[204:207], 0
    s_waitcnt lgkmcnt(0)
    s_setprio 0
    s_cmp_ge_u32 s7, 28
    s_cbranch_scc1 .L_mo2
    s_barrier
.L_mo2:
    s_nop 0
    ds_read_b64_tr_b16 v[192:193], v2 offset:24576
    ds_read_b64_tr_b16 v[194:195], v2 offset:25088
    ds_read_b64_tr_b16 v[196:197], v3 offset:24576
    ds_read_b64_tr_b16 v[198:199], v3 offset:25088
    ds_read_b64_tr_b16 v[200:201], v24 offset:24576
    ds_read_b64_tr_b16 v[202:203], v24 offset:25088
    ds_read_b64_tr_b16 v[204:205], v25 offset:24576
    ds_read_b64_tr_b16 v[206:207], v25 offset:25088
    s_setprio 1
    s_waitcnt lgkmcnt(0)
    v_mfma_f32_16x16x32_bf16 v[96:99], v[56:59], v[192:195], v[96:99]
    v_mfma_f32_16x16x32_bf16 v[100:103], v[56:59], v[196:199], v[100:103]
    v_mfma_f32_16x16x32_bf16 v[104:107], v[56:59], v[200:203], v[104:107]
    v_mfma_f32_16x16x32_bf16 v[108:111], v[56:59], v[204:207], v[108:111]
    s_waitcnt lgkmcnt(0)
    s_cmp_ge_u32 s7, 28
    s_cbranch_scc1 .L_mo3
    s_barrier
.L_mo3:
    s_cmp_ge_u32 s7, 28
    s_cbranch_scc1 .L_mo4
    s_add_u32 s34, s34, 2
    s_or_b32 s34, s34, 1
    s_mov_b32 s30, 0xffff
    s_mov_b32 s31, 0xffff
    v_cndmask_b32 v96, v100, v96, s[30:31]
    v_cndmask_b32 v112, v108, v104, s[30:31]
    s_add_u32 s15, s79, 1
    s_and_b32 s15, s15, 7
    s_lshl_b32 s15, s15, 10
    s_add_u32 s15, s15, s35
    s_mov_b32 s30, -1
    s_mov_b32 s31, 0
    v_mov_b32_e64 v55, s34
    v_cndmask_b32 v54, v112, v96, s[30:31]
    buffer_store_dwordx2 v[54:55], v4, s[68:71], s15 offen sc1
.L_mo4:
    s_cmp_ge_u32 s7, 28
    s_cbranch_scc1 .L_mo5
    s_barrier
.L_mo5:
    s_cmp_ge_u32 s7, 28
    s_cbranch_scc1 .L_mo6
    s_mov_b64 exec, 0
    s_branch .L_pp0
.L_pb0:
    s_mov_b64 exec, -1
.L_mo6:
    s_cmp_ge_u32 s7, 28
    s_cbranch_scc1 .L_mo7
    s_barrier
.L_mo7:
    s_cmp_ge_u32 s7, 28
    s_cbranch_scc1 .L_mo8
    s_mov_b64 exec, 0
    s_branch .L_pp1
.L_pb1:
    s_mov_b64 exec, -1
.L_mo8:
    s_cmp_ge_u32 s7, 28
    s_cbranch_scc1 .L_mo9
    s_barrier
.L_mo9:
    s_cmp_ge_u32 s7, 28
    s_cbranch_scc1 .L_mo10
    s_mov_b64 exec, 0
    s_branch .L_pp2
.L_pb2:
    s_mov_b64 exec, -1
.L_mo10:
    s_cmp_ge_u32 s7, 28
    s_cbranch_scc1 .L_mo11
    s_barrier
.L_mo11:
    s_cmp_ge_u32 s7, 28
    s_cbranch_scc1 .L_mo12
    s_mov_b64 exec, 0
    s_branch .L_pp3
.L_pb3:
    s_mov_b64 exec, -1
.L_mo12:
    s_cmp_ge_u32 s7, 28
    s_cbranch_scc1 .L_mo13
    s_barrier
.L_mo13:
    s_cmp_ge_u32 s7, 28
    s_cbranch_scc1 .L_mo14
    s_mov_b64 exec, 0
    s_branch .L_pp4
.L_pb4:
    s_mov_b64 exec, -1
.L_mo14:
    s_cmp_ge_u32 s7, 28
    s_cbranch_scc1 .L_mo15
    s_barrier
.L_mo15:
    s_cmp_ge_u32 s7, 28
    s_cbranch_scc1 .L_mo16
    s_mov_b64 exec, 0
    s_branch .L_pp5
.L_pb5:
    s_mov_b64 exec, -1
.L_mo16:
    s_cmp_ge_u32 s7, 28
    s_cbranch_scc1 .L_mo17
    s_barrier
.L_mo17:
    s_cmp_ge_u32 s7, 28
    s_cbranch_scc1 .L_gi
    s_nop 0
    buffer_load_dwordx2 v[20:21], v4, s[68:71], s35 offen sc1
    buffer_load_dwordx2 v[22:23], v4, s[68:71], s35 offen offset:1024 sc1
    buffer_load_dwordx2 v[24:25], v4, s[68:71], s35 offen offset:2048 sc1
    buffer_load_dwordx2 v[26:27], v4, s[68:71], s35 offen offset:3072 sc1
    s_add_u32 s35, s35, 4096
    buffer_load_dwordx2 v[28:29], v4, s[68:71], s35 offen sc1
    buffer_load_dwordx2 v[30:31], v4, s[68:71], s35 offen offset:1024 sc1
    buffer_load_dwordx2 v[32:33], v4, s[68:71], s35 offen offset:2048 sc1
    buffer_load_dwordx2 v[34:35], v4, s[68:71], s35 offen offset:3072 sc1
    s_sub_u32 s35, s35, 4096
    buffer_load_dwordx4 v[100:103], v5, s[68:71], s78 offen sc1
.L_gi:
    buffer_load_dword v19, v18, s[72:75], 0 offen sc1
    s_cmp_ge_u32 s7, 28
    s_cbranch_scc1 .L_mo18
    s_barrier
.L_mo18:
    s_cmp_ge_u32 s7, 28
    s_cbranch_scc1 .L_mo19
    s_barrier
.L_mo19:
    s_waitcnt vmcnt(0)
    s_cmp_ge_u32 s7, 28
    s_cbranch_scc1 .L_gdone
    s_nop 0
    s_mov_b32 s28, 262144
.L_gt:
    v_xor_b32 v54, s34, v21
    v_xor_b32 v55, s34, v23
    v_or_b32 v54, v54, v55
    v_xor_b32 v55, s34, v25
    v_or_b32 v54, v54, v55
    v_xor_b32 v55, s34, v27
    v_or_b32 v54, v54, v55
    v_xor_b32 v55, s34, v29
    v_or_b32 v54, v54, v55
    v_xor_b32 v55, s34, v31
    v_or_b32 v54, v54, v55
    v_xor_b32 v55, s34, v33
    v_or_b32 v54, v54, v55
    v_xor_b32 v55, s34, v35
    v_or_b32 v54, v54, v55
    v_xor_b32 v55, s34, v101
    v_or_b32 v54, v54, v55
    v_xor_b32 v55, s34, v103
    v_or_b32_e64 v54, v54, v55
    v_cmp_ne_u32 s[30:31], 0, v54
    s_cmp_eq_u64 s[30:31], 0
    s_cbranch_scc1 .L_gok
    s_sub_u32 s28, s28, 1
    s_cbranch_scc1 .L_gok
    s_sleep 2
    s_nop 0
    buffer_load_dwordx2 v[20:21], v4, s[68:71], s35 offen sc1
    buffer_load_dwordx2 v[22:23], v4, s[68:71], s35 offen offset:1024 sc1
    buffer_load_dwordx2 v[24:25], v4, s[68:71], s35 offen offset:2048 sc1
    buffer_load_dwordx2 v[26:27], v4, s[68:71], s35 offen offset:3072 sc1
    s_add_u32 s35, s35, 4096
    buffer_load_dwordx2 v[28:29], v4, s[68:71], s35 offen sc1
    buffer_load_dwordx2 v[30:31], v4, s[68:71], s35 offen offset:1024 sc1
    buffer_load_dwordx2 v[32:33], v4, s[68:71], s35 offen offset:2048 sc1
    buffer_load_dwordx2 v[34:35], v4, s[68:71], s35 offen offset:3072 sc1
    s_sub_u32 s35, s35, 4096
    buffer_load_dwordx4 v[100:103], v5, s[68:71], s78 offen sc1
    s_waitcnt vmcnt(0)
    s_branch .L_gt
.L_gok:
    v_add_f32 v20, v20, v22
    v_add_f32 v24, v24, v26
    v_add_f32 v28, v28, v30
    v_add_f32 v32, v32, v34
    v_add_f32 v20, v20, v24
    v_add_f32 v28, v28, v32
    v_add_f32 v20, v20, v28
    v_mov_b32 v101, v102
    ds_write_b64 v6, v[100:101]
    ds_write_b32 v7, v20
.L_gdone:
    s_mov_b32 s28, 262144
.L_pt:
    v_cmp_eq_u32 s[30:31], 0, v19
    s_cmp_eq_u64 s[30:31], 0
    s_cbranch_scc1 .L_pok
    s_sub_u32 s28, s28, 1
    s_cbranch_scc1 .L_pok
    s_sleep 2
    s_nop 0
    buffer_load_dword v19, v18, s[72:75], 0 offen sc1
    s_waitcnt vmcnt(0)
    s_branch .L_pt
.L_pok:
    s_add_u32 m0, s13, 4672
    s_nop 0
    s_nop 0
    buffer_load_dwordx4 v16, s[68:71], s26 offen sc1 lds
    s_add_u32 s26, s26, 0x80000
    s_add_u32 m0, s13, 5696
    s_nop 0
    s_nop 0
    buffer_load_dwordx4 v16, s[68:71], s26 offen sc1 lds
    s_add_u32 s26, s26, 0x80000
    s_add_u32 m0, s13, 6720
    s_nop 0
    s_nop 0
    buffer_load_dwordx4 v16, s[68:71], s26 offen sc1 lds
    s_add_u32 s26, s26, 0x80000
    s_add_u32 m0, s13, 7744
    s_nop 0
    s_nop 0
    buffer_load_dwordx4 v16, s[68:71], s26 offen sc1 lds
    s_barrier
    s_waitcnt lgkmcnt(0)
    s_cmp_ge_u32 s7, 28
    s_cbranch_scc1 .L_mo20
    s_barrier
.L_mo20:
    s_cmp_ge_u32 s7, 28
    s_cbranch_scc1 .L_mo21
    s_barrier
.L_mo21:
    v_mfma_f32_32x32x16_bf16 v[192:207], v[160:163], v[128:131], 0
    v_mfma_f32_32x32x16_bf16 v[192:207], v[164:167], v[132:135], v[192:207]
    v_mfma_f32_32x32x16_bf16 v[192:207], v[168:171], v[136:139], v[192:207]
    v_mfma_f32_32x32x16_bf16 v[192:207], v[172:175], v[140:143], v[192:207]
    v_mfma_f32_32x32x16_bf16 v[192:207], v[176:179], v[144:147], v[192:207]
    v_mfma_f32_32x32x16_bf16 v[192:207], v[180:183], v[148:151], v[192:207]
    v_mfma_f32_32x32x16_bf16 v[192:207], v[184:187], v[152:155], v[192:207]
    v_mfma_f32_32x32x16_bf16 v[192:207], v[188:191], v[156:159], v[192:207]
    v_mfma_f32_32x32x16_bf16 v[192:207], v[64:67], v[224:227], v[192:207]
    v_mfma_f32_32x32x16_bf16 v[192:207], v[68:71], v[228:231], v[192:207]
    v_mfma_f32_32x32x16_bf16 v[192:207], v[72:75], v[232:235], v[192:207]
    v_mfma_f32_32x32x16_bf16 v[192:207], v[76:79], v[236:239], v[192:207]
    v_mfma_f32_32x32x16_bf16 v[192:207], v[80:83], v[240:243], v[192:207]
    v_mfma_f32_32x32x16_bf16 v[192:207], v[84:87], v[244:247], v[192:207]
    v_mfma_f32_32x32x16_bf16 v[192:207], v[88:91], v[248:251], v[192:207]
    v_mfma_f32_32x32x16_bf16 v[192:207], v[92:95], v[252:255], v[192:207]
    s_lshl_b32 s15, s10, 1
    s_nop 0
    s_add_u32 s15, s15, 147238
    v_mov_b32 v16, s15
    s_nop 8
    v_cvt_pk_bf16_f32 v104, v192, v193
    v_cvt_pk_bf16_f32 v105, v194, v195
    v_cvt_pk_bf16_f32 v106, v196, v197
    v_cvt_pk_bf16_f32 v107, v198, v199
    ds_write_b128 v63, v[104:107] offset:64
    v_cvt_pk_bf16_f32 v108, v200, v200
    v_cvt_pk_bf16_f32 v109, v200, v201
    v_cvt_pk_bf16_f32 v110, v201, v201
    v_cvt_pk_bf16_f32 v111, v202, v202
    ds_write_b128 v63, v[108:111] offset:1088
    v_cndmask_b32_e64 v62, v204, v203, vcc
    v_cvt_pk_bf16_f32 v112, v203, v203
    v_mov_b32_e64 v113, v112
    v_cvt_pk_bf16_f32 v114, v62, v204
    v_cvt_pk_bf16_f32 v115, v204, v204
    ds_write_b128 v63, v[112:115] offset:2112
    v_cndmask_b32_e64 v62, v206, v205, vcc
    v_cvt_pk_bf16_f32 v116, v205, v205
    v_mov_b32_e64 v117, v116
    v_cvt_pk_bf16_f32 v118, v62, v206
    v_cvt_pk_bf16_f32 v119, v206, v206
    ds_write_b128 v63, v[116:119] offset:3136
    s_waitcnt vmcnt(0) lgkmcnt(0)
    s_nop 0
    ds_write_b32 v16, v16
.L_conv:
    s_cmp_eq_u32 s11, 0
    s_cbranch_scc0 .L_nwf0
    v_mov_b32 v18, 147200
    v_mov_b32_e64 v19, 1
    s_waitcnt vmcnt(0)
    s_mov_b64 exec, 1
    ds_add_u32 v18, v19
    s_mov_b64 exec, -1
.L_nwf0:
    s_cmp_ge_u32 s7, 28
    s_cbranch_scc1 .L_cdx
    s_nop 0
    s_add_u32 s15, s10, 147208
    v_mov_b32_e64 v16, s15
    s_mov_b32 s28, 2097152
.L_cd:
    ds_read_u8 v17, v16
    s_sub_u32 s28, s28, 1
    s_cbranch_scc1 .L_cdx
    s_waitcnt lgkmcnt(0)
    v_readfirstlane_b32 s15, v17
    s_cmp_eq_u32 s15, 0
    s_cbranch_scc0 .L_cdx
    s_sleep 1
    s_branch .L_cd
.L_cdx:
    s_setprio 0
    s_nop 0
    buffer_load_dwordx4 v[24:27], v15, s[48:51], s24 offen
    s_add_u32 s25, s24, 32768
    buffer_load_dwordx4 v[28:31], v15, s[48:51], s25 offen
    s_waitcnt lgkmcnt(0)
    s_cmp_eq_u32 s11, 0
    s_cbranch_scc0 .L_t1
    s_nop 0
    ds_read_b64_tr_b16 v[128:129], v10 offset:32
    ds_read_b64_tr_b16 v[130:131], v10 offset:0
    ds_read_b128 v[160:163], v11 offset:384
    ds_read_b64_tr_b16 v[132:133], v10 offset:544
    ds_read_b64_tr_b16 v[134:135], v10 offset:512
    ds_read_b128 v[164:167], v11 offset:896
    ds_read_b64_tr_b16 v[136:137], v10 offset:1056
    ds_read_b64_tr_b16 v[138:139], v10 offset:1024
    ds_read_b128 v[168:171], v11 offset:1408
    ds_read_b64_tr_b16 v[140:141], v10 offset:1568
    ds_read_b64_tr_b16 v[142:143], v10 offset:1536
    ds_read_b128 v[172:175], v11 offset:1920
    s_waitcnt lgkmcnt(9)
    s_nop 0
    v_mfma_f32_32x32x16_bf16 v[64:79], v[128:131], v[160:163], 0
    ds_read_b64_tr_b16 v[144:145], v10 offset:2080
    ds_read_b64_tr_b16 v[146:147], v10 offset:2048
    ds_read_b128 v[176:179], v11 offset:2432
    s_waitcnt lgkmcnt(6)
    s_nop 0
    v_mfma_f32_32x32x16_bf16 v[80:95], v[132:135], v[168:171], 0
    ds_read_b64_tr_b16 v[148:149], v10 offset:2592
    ds_read_b64_tr_b16 v[150:151], v10 offset:2560
    ds_read_b128 v[180:183], v11 offset:2944
    v_mfma_f32_32x32x16_bf16 v[96:111], v[136:139], v[168:171], 0
    ds_read_b64_tr_b16 v[152:153], v10 offset:3104
    ds_read_b64_tr_b16 v[154:155], v10 offset:3072
    ds_read_b128 v[184:187], v11 offset:3456
    v_mfma_f32_32x32x16_bf16 v[80:95], v[136:139], v[164:167], v[80:95]
    ds_read_b64_tr_b16 v[156:157], v10 offset:3616
    ds_read_b64_tr_b16 v[158:159], v10 offset:3584
    ds_read_b128 v[188:191], v11 offset:3968
    s_waitcnt lgkmcnt(12)
    s_nop 0
    v_mfma_f32_32x32x16_bf16 v[96:111], v[132:135], v[172:175], v[96:111]
    ds_read_b64_tr_b16 v[192:193], v10 offset:160
    ds_read_b64_tr_b16 v[194:195], v10 offset:128
    ds_read_b128 v[224:227], v11 offset:256
    v_mfma_f32_32x32x16_bf16 v[80:95], v[128:131], v[172:175], v[80:95]
    ds_read_b64_tr_b16 v[196:197], v10 offset:672
    ds_read_b64_tr_b16 v[198:199], v10 offset:640
    ds_read_b128 v[228:231], v11 offset:768
    v_mfma_f32_32x32x16_bf16 v[96:111], v[140:143], v[164:167], v[96:111]
    ds_read_b64_tr_b16 v[200:201], v10 offset:1184
    ds_read_b64_tr_b16 v[202:203], v10 offset:1152
    ds_read_b128 v[232:235], v11 offset:1280
    v_mfma_f32_32x32x16_bf16 v[80:95], v[140:143], v[160:163], v[80:95]
    ds_read_b64_tr_b16 v[204:205], v10 offset:1696
    ds_read_b64_tr_b16 v[206:207], v10 offset:1664
    ds_read_b128 v[236:239], v11 offset:1792
    s_waitcnt lgkmcnt(15)
    s_nop 0
    v_mfma_f32_32x32x16_bf16 v[96:111], v[128:131], v[176:179], v[96:111]
    ds_read_b64_tr_b16 v[208:209], v10 offset:2208
    ds_read_b64_tr_b16 v[210:211], v10 offset:2176
    ds_read_b128 v[240:243], v11 offset:2304
    v_mfma_f32_32x32x16_bf16 v[112:127], v[140:143], v[176:179], 0
    ds_read_b64_tr_b16 v[212:213], v10 offset:2720
    ds_read_b64_tr_b16 v[214:215], v10 offset:2688
    ds_read_b128 v[244:247], v11 offset:2816
    v_mfma_f32_32x32x16_bf16 v[96:111], v[144:147], v[160:163], v[96:111]
    ds_read_b64_tr_b16 v[216:217], v10 offset:3232
    ds_read_b64_tr_b16 v[218:219], v10 offset:3200
    ds_read_b128 v[248:251], v11 offset:3328
    v_mfma_f32_32x32x16_bf16 v[112:127], v[144:147], v[172:175], v[112:127]
    ds_read_b64_tr_b16 v[220:221], v10 offset:3744
    ds_read_b64_tr_b16 v[222:223], v10 offset:3712
    ds_read_b128 v[252:255], v11 offset:3840
    s_waitcnt lgkmcnt(15)
    s_nop 0
    v_mfma_f32_32x32x16_bf16 v[112:127], v[136:139], v[180:183], v[112:127]
    v_mfma_f32_32x32x16_bf16 v[112:127], v[148:151], v[168:171], v[112:127]
    s_waitcnt lgkmcnt(15)
    s_nop 0
    v_mfma_f32_32x32x16_bf16 v[112:127], v[132:135], v[184:187], v[112:127]
    v_mfma_f32_32x32x16_bf16 v[112:127], v[152:155], v[164:167], v[112:127]
    s_waitcnt lgkmcnt(15)
    s_nop 0
    v_mfma_f32_32x32x16_bf16 v[112:127], v[128:131], v[188:191], v[112:127]
    v_mfma_f32_32x32x16_bf16 v[112:127], v[156:159], v[160:163], v[112:127]
    s_waitcnt lgkmcnt(0)
    s_nop 0
    v_mfma_f32_32x32x16_bf16 v[64:79], v[192:195], v[224:227], v[64:79]
    ds_read_b64_tr_b16 v[128:129], v10 offset:288
    ds_read_b64_tr_b16 v[130:131], v10 offset:256
    v_mfma_f32_32x32x16_bf16 v[80:95], v[196:199], v[232:235], v[80:95]
    ds_read_b128 v[160:163], v11 offset:128
    ds_read_b64_tr_b16 v[132:133], v10 offset:800
    v_mfma_f32_32x32x16_bf16 v[96:111], v[200:203], v[232:235], v[96:111]
    ds_read_b64_tr_b16 v[134:135], v10 offset:768
    ds_read_b128 v[164:167], v11 offset:640
    v_mfma_f32_32x32x16_bf16 v[80:95], v[200:203], v[228:231], v[80:95]
    ds_read_b64_tr_b16 v[136:137], v10 offset:1312
    ds_read_b64_tr_b16 v[138:139], v10 offset:1280
    v_mfma_f32_32x32x16_bf16 v[96:111], v[196:199], v[236:239], v[96:111]
    ds_read_b128 v[168:171], v11 offset:1152
    ds_read_b64_tr_b16 v[140:141], v10 offset:1824
    v_mfma_f32_32x32x16_bf16 v[80:95], v[192:195], v[236:239], v[80:95]
    ds_read_b64_tr_b16 v[142:143], v10 offset:1792
    ds_read_b128 v[172:175], v11 offset:1664
    v_mfma_f32_32x32x16_bf16 v[96:111], v[204:207], v[228:231], v[96:111]
    ds_read_b64_tr_b16 v[144:145], v10 offset:2336
    ds_read_b64_tr_b16 v[146:147], v10 offset:2304
    v_mfma_f32_32x32x16_bf16 v[80:95], v[204:207], v[224:227], v[80:95]
    ds_read_b128 v[176:179], v11 offset:2176
    ds_read_b64_tr_b16 v[148:149], v10 offset:2848
    v_mfma_f32_32x32x16_bf16 v[96:111], v[192:195], v[240:243], v[96:111]
    ds_read_b64_tr_b16 v[150:151], v10 offset:2816
    ds_read_b128 v[180:183], v11 offset:2688
    v_mfma_f32_32x32x16_bf16 v[112:127], v[204:207], v[240:243], v[112:127]
    ds_read_b64_tr_b16 v[152:153], v10 offset:3360
    ds_read_b64_tr_b16 v[154:155], v10 offset:3328
    v_mfma_f32_32x32x16_bf16 v[96:111], v[208:211], v[224:227], v[96:111]
    ds_read_b128 v[184:187], v11 offset:3200
    ds_read_b64_tr_b16 v[156:157], v10 offset:3872
    v_mfma_f32_32x32x16_bf16 v[112:127], v[208:211], v[236:239], v[112:127]
    ds_read_b64_tr_b16 v[158:159], v10 offset:3840
    ds_read_b128 v[188:191], v11 offset:3712
    v_mfma_f32_32x32x16_bf16 v[112:127], v[200:203], v[244:247], v[112:127]
    v_mfma_f32_32x32x16_bf16 v[112:127], v[212:215], v[232:235], v[112:127]
    v_mfma_f32_32x32x16_bf16 v[112:127], v[196:199], v[248:251], v[112:127]
    v_mfma_f32_32x32x16_bf16 v[112:127], v[216:219], v[228:231], v[112:127]
    v_mfma_f32_32x32x16_bf16 v[112:127], v[192:195], v[252:255], v[112:127]
    v_mfma_f32_32x32x16_bf16 v[112:127], v[220:223], v[224:227], v[112:127]
    s_waitcnt lgkmcnt(0)
    s_nop 0
    v_mfma_f32_32x32x16_bf16 v[64:79], v[128:131], v[160:163], v[64:79]
    ds_read_b64_tr_b16 v[192:193], v10 offset:416
    ds_read_b64_tr_b16 v[194:195], v10 offset:384
    v_mfma_f32_32x32x16_bf16 v[80:95], v[132:135], v[168:171], v[80:95]
    ds_read_b128 v[224:227], v11 offset:0
    ds_read_b64_tr_b16 v[196:197], v10 offset:928
    v_mfma_f32_32x32x16_bf16 v[96:111], v[136:139], v[168:171], v[96:111]
    ds_read_b64_tr_b16 v[198:199], v10 offset:896
    ds_read_b128 v[228:231], v11 offset:512
    v_mfma_f32_32x32x16_bf16 v[80:95], v[136:139], v[164:167], v[80:95]
    ds_read_b64_tr_b16 v[200:201], v10 offset:1440
    ds_read_b64_tr_b16 v[202:203], v10 offset:1408
    v_mfma_f32_32x32x16_bf16 v[96:111], v[132:135], v[172:175], v[96:111]
    ds_read_b128 v[232:235], v11 offset:1024
    ds_read_b64_tr_b16 v[204:205], v10 offset:1952
    v_mfma_f32_32x32x16_bf16 v[80:95], v[128:131], v[172:175], v[80:95]
    ds_read_b64_tr_b16 v[206:207], v10 offset:1920
    ds_read_b128 v[236:239], v11 offset:1536
    v_mfma_f32_32x32x16_bf16 v[96:111], v[140:143], v[164:167], v[96:111]
    ds_read_b64_tr_b16 v[208:209], v10 offset:2464
    ds_read_b64_tr_b16 v[210:211], v10 offset:2432
    v_mfma_f32_32x32x16_bf16 v[80:95], v[140:143], v[160:163], v[80:95]
    ds_read_b128 v[240:243], v11 offset:2048
    ds_read_b64_tr_b16 v[212:213], v10 offset:2976
    v_mfma_f32_32x32x16_bf16 v[96:111], v[128:131], v[176:179], v[96:111]
    ds_read_b64_tr_b16 v[214:215], v10 offset:2944
    ds_read_b128 v[244:247], v11 offset:2560
    v_mfma_f32_32x32x16_bf16 v[112:127], v[140:143], v[176:179], v[112:127]
    ds_read_b64_tr_b16 v[216:217], v10 offset:3488
    ds_read_b64_tr_b16 v[218:219], v10 offset:3456
    v_mfma_f32_32x32x16_bf16 v[96:111], v[144:147], v[160:163], v[96:111]
    ds_read_b128 v[248:251], v11 offset:3072
    ds_read_b64_tr_b16 v[220:221], v10 offset:4000
    v_mfma_f32_32x32x16_bf16 v[112:127], v[144:147], v[172:175], v[112:127]
    ds_read_b64_tr_b16 v[222:223], v10 offset:3968
    ds_read_b128 v[252:255], v11 offset:3584
    v_mfma_f32_32x32x16_bf16 v[112:127], v[136:139], v[180:183], v[112:127]
    v_mfma_f32_32x32x16_bf16 v[112:127], v[148:151], v[168:171], v[112:127]
    v_mfma_f32_32x32x16_bf16 v[112:127], v[132:135], v[184:187], v[112:127]
    v_mfma_f32_32x32x16_bf16 v[112:127], v[152:155], v[164:167], v[112:127]
    v_mfma_f32_32x32x16_bf16 v[112:127], v[128:131], v[188:191], v[112:127]
    v_mfma_f32_32x32x16_bf16 v[112:127], v[156:159], v[160:163], v[112:127]
    s_waitcnt lgkmcnt(0)
    s_lshl_b32 s15, s10, 2
    s_add_u32 s15, s15, 147200
    v_mov_b32 v16, s15
    v_mov_b32 v17, s34
    v_add_u32 v16, 16, v16
    v_xor_b32 v18, 4, v16
    v_mfma_f32_32x32x16_bf16 v[80:95], v[196:199], v[232:235], v[80:95]
    ds_read_b32 v32, v13 offset:0
    ds_read_b32 v33, v13 offset:32
    s_mov_b32 s30, 0xfff0fff0
    s_mov_b32 s31, s30
    s_lshl_b32 s14, s17, 16
    v_mfma_f32_32x32x16_bf16 v[64:79], v[192:195], v[224:227], v[64:79]
    ds_read_b32 v34, v13 offset:64
    ds_read_b32 v35, v13 offset:96
    s_and_b32 s15, s17, 0xffff0000
    s_bitcmp0_b32 s12, 0
    s_cselect_b32 s14, s14, s15
    v_mfma_f32_32x32x16_bf16 v[80:95], v[200:203], v[228:231], v[80:95]
    ds_read_b32 v36, v13 offset:2048
    ds_read_b32 v37, v13 offset:2080
    s_lshl_b32 s12, s12, 12
    s_nop 0
    s_add_u32 s12, s12, 12582912
    v_mfma_f32_32x32x16_bf16 v[112:127], v[204:207], v[240:243], v[112:127]
    ds_read_b32 v38, v13 offset:2112
    ds_read_b32 v39, v13 offset:2144
    v_add_f32_dpp v147, v64, v66 row_ror:8 row_mask:0xf bank_mask:0x3
    v_add_f32_dpp v148, v65, v67 row_ror:8 row_mask:0xf bank_mask:0x3
    v_add_f32_dpp v149, v66, v68 row_ror:8 row_mask:0xf bank_mask:0x3
    v_mfma_f32_32x32x16_bf16 v[80:95], v[192:195], v[236:239], v[80:95]
    v_add_f32_dpp v150, v67, v69 row_ror:8 row_mask:0xf bank_mask:0x3
    v_add_f32_dpp v151, v68, v70 row_ror:8 row_mask:0xf bank_mask:0x3
    v_add_f32_dpp v152, v69, v71 row_ror:8 row_mask:0xf bank_mask:0x3
    v_add_f32_dpp v147, v74, v72 row_ror:8 row_mask:0xf bank_mask:0xc
    v_add_f32_dpp v148, v75, v73 row_ror:8 row_mask:0xf bank_mask:0xc
    v_mfma_f32_32x32x16_bf16 v[112:127], v[208:211], v[236:239], v[112:127]
    v_add_f32_dpp v149, v76, v74 row_ror:8 row_mask:0xf bank_mask:0xc
    v_add_f32_dpp v150, v77, v75 row_ror:8 row_mask:0xf bank_mask:0xc
    v_add_f32_dpp v151, v78, v76 row_ror:8 row_mask:0xf bank_mask:0xc
    v_add_f32_dpp v152, v79, v77 row_ror:8 row_mask:0xf bank_mask:0xc
    v_add_f32_dpp v144, v71, v69 row_ror:8 row_mask:0xf bank_mask:0xc
    v_mfma_f32_32x32x16_bf16 v[80:95], v[204:207], v[224:227], v[80:95]
    v_add_f32_dpp v145, v72, v70 row_ror:8 row_mask:0xf bank_mask:0xc
    v_add_f32_dpp v146, v73, v71 row_ror:8 row_mask:0xf bank_mask:0xc
    v_add_f32_dpp v43, v147, v148 row_shl:4 row_mask:0xf bank_mask:0x5
    v_add_f32_dpp v44, v148, v149 row_shl:4 row_mask:0xf bank_mask:0x5
    v_add_f32_dpp v45, v149, v150 row_shl:4 row_mask:0xf bank_mask:0x5
    v_mfma_f32_32x32x16_bf16 v[112:127], v[200:203], v[244:247], v[112:127]
    v_add_f32_dpp v46, v150, v151 row_shl:4 row_mask:0xf bank_mask:0x5
    v_add_f32_dpp v47, v151, v152 row_shl:4 row_mask:0xf bank_mask:0x5
    s_waitcnt lgkmcnt(0)
    s_mov_b64 exec, s[30:31]
    ds_write_b128 v12, v[76:79] offset:16
    s_mov_b64 exec, -1
    s_nop 0
    v_mfma_f32_32x32x16_bf16 v[96:111], v[200:203], v[232:235], v[96:111]
    v_lshlrev_b32_e64 v56, 16, v32
    v_and_b32 v60, 0xffff0000, v32
    v_lshlrev_b32_e64 v57, 16, v33
    v_and_b32 v61, 0xffff0000, v33
    v_lshlrev_b32_e64 v58, 16, v34
    v_mfma_f32_32x32x16_bf16 v[112:127], v[212:215], v[232:235], v[112:127]
    v_and_b32 v62, 0xffff0000, v34
    v_lshlrev_b32_e64 v59, 16, v35
    v_and_b32 v63, 0xffff0000, v35
    s_mov_b64 exec, s[30:31]
.L_pp4:
    s_cbranch_execz .L_pb4
    ds_write_b128 v12, v[92:95] offset:784
    s_mov_b64 exec, -1
    s_nop 0
    v_mfma_f32_32x32x16_bf16 v[96:111], v[196:199], v[236:239], v[96:111]
    v_add_f32_dpp v159, v80, v82 row_ror:8 row_mask:0xf bank_mask:0x3
    v_add_f32_dpp v160, v81, v83 row_ror:8 row_mask:0xf bank_mask:0x3
    v_add_f32_dpp v161, v82, v84 row_ror:8 row_mask:0xf bank_mask:0x3
    v_add_f32_dpp v162, v83, v85 row_ror:8 row_mask:0xf bank_mask:0x3
    v_add_f32_dpp v163, v84, v86 row_ror:8 row_mask:0xf bank_mask:0x3
    v_mfma_f32_32x32x16_bf16 v[112:127], v[196:199], v[248:251], v[112:127]
    v_add_f32_dpp v164, v85, v87 row_ror:8 row_mask:0xf bank_mask:0x3
    v_add_f32_dpp v159, v90, v88 row_ror:8 row_mask:0xf bank_mask:0xc
    v_add_f32_dpp v160, v91, v89 row_ror:8 row_mask:0xf bank_mask:0xc
    v_add_f32_dpp v161, v92, v90 row_ror:8 row_mask:0xf bank_mask:0xc
    v_add_f32_dpp v162, v93, v91 row_ror:8 row_mask:0xf bank_mask:0xc
    v_mfma_f32_32x32x16_bf16 v[96:111], v[204:207], v[228:231], v[96:111]
    v_add_f32_dpp v163, v94, v92 row_ror:8 row_mask:0xf bank_mask:0xc
    v_add_f32_dpp v164, v95, v93 row_ror:8 row_mask:0xf bank_mask:0xc
    v_add_f32_dpp v156, v87, v85 row_ror:8 row_mask:0xf bank_mask:0xc
    v_add_f32_dpp v157, v88, v86 row_ror:8 row_mask:0xf bank_mask:0xc
    v_add_f32_dpp v158, v89, v87 row_ror:8 row_mask:0xf bank_mask:0xc
    v_mfma_f32_32x32x16_bf16 v[112:127], v[216:219], v[228:231], v[112:127]
    v_add_f32_dpp v43, v160, v159 row_shr:4 row_mask:0xf bank_mask:0xa
    v_add_f32_dpp v44, v161, v160 row_shr:4 row_mask:0xf bank_mask:0xa
    v_add_f32_dpp v45, v162, v161 row_shr:4 row_mask:0xf bank_mask:0xa
    v_add_f32_dpp v46, v163, v162 row_shr:4 row_mask:0xf bank_mask:0xa
    v_add_f32_dpp v47, v164, v163 row_shr:4 row_mask:0xf bank_mask:0xa
    v_mfma_f32_32x32x16_bf16 v[96:111], v[192:195], v[240:243], v[96:111]
    v_lshlrev_b32_e64 v153, 16, v36
    v_and_b32 v166, 0xffff0000, v36
    v_lshlrev_b32_e64 v154, 16, v37
    v_and_b32 v167, 0xffff0000, v37
    v_lshlrev_b32_e64 v155, 16, v38
    v_mfma_f32_32x32x16_bf16 v[112:127], v[192:195], v[252:255], v[112:127]
    v_and_b32 v177, 0xffff0000, v38
    v_mfma_f32_32x32x16_bf16 v[96:111], v[208:211], v[224:227], v[96:111]
    v_mfma_f32_32x32x16_bf16 v[112:127], v[220:223], v[224:227], v[112:127]
    v_lshlrev_b32_e64 v165, 16, v39
    v_and_b32 v178, 0xffff0000, v39
    v_fmac_f32 v43, s14, v59
    v_fmac_f32 v44, s14, v60
    v_fmac_f32 v45, s14, v61
    v_fmac_f32 v46, s14, v62
    v_fmac_f32_e64 v47, s14, v63
    v_cvt_pk_bf16_f32 v82, v44, v45
    v_cvt_pk_bf16_f32 v83, v46, v47
    s_mov_b64 exec, s[30:31]
    s_nop 0
    ds_write_b128 v12, v[108:111] offset:1040
    ds_write_b128 v12, v[124:127] offset:1808
    s_mov_b64 exec, -1
    s_nop 0
    ds_write_b32 v16, v17
    ds_read_b32 v19, v18
    ds_read_b128 v[128:131], v12 offset:0
    ds_read_b128 v[132:135], v12 offset:768
    ds_read_b128 v[136:139], v12 offset:1024
    ds_read_b128 v[140:143], v12 offset:1792
    v_add_f32_dpp v171, v96, v98 row_ror:8 row_mask:0xf bank_mask:0x3
    v_add_f32_dpp v172, v97, v99 row_ror:8 row_mask:0xf bank_mask:0x3
    v_add_f32_dpp v173, v98, v100 row_ror:8 row_mask:0xf bank_mask:0x3
    v_add_f32_dpp v174, v99, v101 row_ror:8 row_mask:0xf bank_mask:0x3
    v_add_f32_dpp v175, v100, v102 row_ror:8 row_mask:0xf bank_mask:0x3
    v_add_f32_dpp v176, v101, v103 row_ror:8 row_mask:0xf bank_mask:0x3
    v_add_f32_dpp v171, v106, v104 row_ror:8 row_mask:0xf bank_mask:0xc
    v_add_f32_dpp v172, v107, v105 row_ror:8 row_mask:0xf bank_mask:0xc
    v_add_f32_dpp v173, v108, v106 row_ror:8 row_mask:0xf bank_mask:0xc
    v_add_f32_dpp v174, v109, v107 row_ror:8 row_mask:0xf bank_mask:0xc
    v_add_f32_dpp v175, v110, v108 row_ror:8 row_mask:0xf bank_mask:0xc
    v_add_f32_dpp v176, v111, v109 row_ror:8 row_mask:0xf bank_mask:0xc
    v_add_f32_dpp v168, v103, v101 row_ror:8 row_mask:0xf bank_mask:0xc
    v_add_f32_dpp v169, v104, v102 row_ror:8 row_mask:0xf bank_mask:0xc
    v_add_f32_dpp v170, v105, v103 row_ror:8 row_mask:0xf bank_mask:0xc
    v_add_f32_dpp v183, v112, v114 row_ror:8 row_mask:0xf bank_mask:0x3
    v_add_f32_dpp v184, v113, v115 row_ror:8 row_mask:0xf bank_mask:0x3
    v_add_f32_dpp v185, v114, v116 row_ror:8 row_mask:0xf bank_mask:0x3
    v_add_f32_dpp v186, v115, v117 row_ror:8 row_mask:0xf bank_mask:0x3
    v_add_f32_dpp v187, v116, v118 row_ror:8 row_mask:0xf bank_mask:0x3
    v_add_f32_dpp v188, v117, v119 row_ror:8 row_mask:0xf bank_mask:0x3
    v_add_f32_dpp v183, v122, v120 row_ror:8 row_mask:0xf bank_mask:0xc
    v_add_f32_dpp v184, v123, v121 row_ror:8 row_mask:0xf bank_mask:0xc
    v_add_f32_dpp v185, v124, v122 row_ror:8 row_mask:0xf bank_mask:0xc
    v_add_f32_dpp v186, v125, v123 row_ror:8 row_mask:0xf bank_mask:0xc
    v_add_f32_dpp v187, v126, v124 row_ror:8 row_mask:0xf bank_mask:0xc
    v_add_f32_dpp v188, v127, v125 row_ror:8 row_mask:0xf bank_mask:0xc
    v_add_f32_dpp v180, v119, v117 row_ror:8 row_mask:0xf bank_mask:0xc
    v_add_f32_dpp v181, v120, v118 row_ror:8 row_mask:0xf bank_mask:0xc
    v_add_f32_dpp v182, v121, v119 row_ror:8 row_mask:0xf bank_mask:0xc
    v_add_f32_dpp v51, v171, v172 row_shl:4 row_mask:0xf bank_mask:0x5
    v_add_f32_dpp v52, v172, v173 row_shl:4 row_mask:0xf bank_mask:0x5
    v_add_f32_dpp v53, v173, v174 row_shl:4 row_mask:0xf bank_mask:0x5
    v_add_f32_dpp v54, v174, v175 row_shl:4 row_mask:0xf bank_mask:0x5
    v_add_f32_dpp v55, v175, v176 row_shl:4 row_mask:0xf bank_mask:0x5
    v_add_f32_dpp v51, v184, v183 row_shr:4 row_mask:0xf bank_mask:0xa
    v_add_f32_dpp v52, v185, v184 row_shr:4 row_mask:0xf bank_mask:0xa
    v_add_f32_dpp v53, v186, v185 row_shr:4 row_mask:0xf bank_mask:0xa
    v_add_f32_dpp v54, v187, v186 row_shr:4 row_mask:0xf bank_mask:0xa
    v_add_f32_dpp v55, v188, v187 row_shr:4 row_mask:0xf bank_mask:0xa
    v_fmac_f32 v51, s14, v165
    v_fmac_f32 v52, s14, v166
    v_fmac_f32 v53, s14, v167
    v_fmac_f32 v54, s14, v177
    v_fmac_f32_e64 v55, s14, v178
    v_cvt_pk_bf16_f32 v86, v52, v53
    v_cvt_pk_bf16_f32 v87, v54, v55
    s_mov_b32 s28, 2097152
.L_hw0:
    s_waitcnt lgkmcnt(0)
    v_readfirstlane_b32 s15, v19
    s_cmp_lg_u32 s15, 0
    s_cbranch_scc1 .L_tdone
    ds_read_b32 v19, v18
    ds_read_b128 v[128:131], v12 offset:0
    ds_read_b128 v[132:135], v12 offset:768
    ds_read_b128 v[136:139], v12 offset:1024
    ds_read_b128 v[140:143], v12 offset:1792
    s_sub_u32 s28, s28, 1
    s_cbranch_scc0 .L_hw0
    s_branch .L_tdone
.L_t1:
    s_nop 0
    ds_read_b64_tr_b16 v[128:129], v10 offset:32
    ds_read_b64_tr_b16 v[130:131], v10 offset:0
    ds_read_b128 v[160:163], v11 offset:384
    ds_read_b64_tr_b16 v[132:133], v10 offset:544
    ds_read_b64_tr_b16 v[134:135], v10 offset:512
    ds_read_b128 v[164:167], v11 offset:896
    ds_read_b64_tr_b16 v[136:137], v10 offset:1056
    ds_read_b64_tr_b16 v[138:139], v10 offset:1024
    ds_read_b128 v[168:171], v11 offset:1408
    ds_read_b64_tr_b16 v[140:141], v10 offset:1568
    ds_read_b64_tr_b16 v[142:143], v10 offset:1536
    ds_read_b128 v[172:175], v11 offset:1920
    s_waitcnt lgkmcnt(6)
    s_nop 0
    v_mfma_f32_32x32x16_bf16 v[64:79], v[128:131], v[164:167], 0
    ds_read_b64_tr_b16 v[144:145], v10 offset:2080
    ds_read_b64_tr_b16 v[146:147], v10 offset:2048
    ds_read_b128 v[176:179], v11 offset:2432
    v_mfma_f32_32x32x16_bf16 v[80:95], v[132:135], v[164:167], 0
    ds_read_b64_tr_b16 v[148:149], v10 offset:2592
    ds_read_b64_tr_b16 v[150:151], v10 offset:2560
    ds_read_b128 v[180:183], v11 offset:2944
    v_mfma_f32_32x32x16_bf16 v[64:79], v[132:135], v[160:163], v[64:79]
    ds_read_b64_tr_b16 v[152:153], v10 offset:3104
    ds_read_b64_tr_b16 v[154:155], v10 offset:3072
    ds_read_b128 v[184:187], v11 offset:3456
    s_waitcnt lgkmcnt(12)
    s_nop 0
    v_mfma_f32_32x32x16_bf16 v[80:95], v[128:131], v[168:171], v[80:95]
    ds_read_b64_tr_b16 v[192:193], v10 offset:160
    ds_read_b64_tr_b16 v[194:195], v10 offset:128
    ds_read_b128 v[224:227], v11 offset:256
    s_waitcnt lgkmcnt(12)
    s_nop 0
    v_mfma_f32_32x32x16_bf16 v[96:111], v[136:139], v[172:175], 0
    ds_read_b64_tr_b16 v[196:197], v10 offset:672
    ds_read_b64_tr_b16 v[198:199], v10 offset:640
    ds_read_b128 v[228:231], v11 offset:768
    v_mfma_f32_32x32x16_bf16 v[80:95], v[136:139], v[160:163], v[80:95]
    ds_read_b64_tr_b16 v[200:201], v10 offset:1184
    ds_read_b64_tr_b16 v[202:203], v10 offset:1152
    ds_read_b128 v[232:235], v11 offset:1280
    v_mfma_f32_32x32x16_bf16 v[96:111], v[140:143], v[168:171], v[96:111]
    ds_read_b64_tr_b16 v[204:205], v10 offset:1696
    ds_read_b64_tr_b16 v[206:207], v10 offset:1664
    ds_read_b128 v[236:239], v11 offset:1792
    v_mfma_f32_32x32x16_bf16 v[112:127], v[140:143], v[172:175], 0
    ds_read_b64_tr_b16 v[208:209], v10 offset:2208
    ds_read_b64_tr_b16 v[210:211], v10 offset:2176
    ds_read_b128 v[240:243], v11 offset:2304
    s_waitcnt lgkmcnt(15)
    s_nop 0
    v_mfma_f32_32x32x16_bf16 v[96:111], v[132:135], v[176:179], v[96:111]
    ds_read_b64_tr_b16 v[212:213], v10 offset:2720
    ds_read_b64_tr_b16 v[214:215], v10 offset:2688
    ds_read_b128 v[244:247], v11 offset:2816
    v_mfma_f32_32x32x16_bf16 v[112:127], v[136:139], v[176:179], v[112:127]
    ds_read_b64_tr_b16 v[216:217], v10 offset:3232
    ds_read_b64_tr_b16 v[218:219], v10 offset:3200
    ds_read_b128 v[248:251], v11 offset:3328
    v_mfma_f32_32x32x16_bf16 v[96:111], v[144:147], v[164:167], v[96:111]
    v_mfma_f32_32x32x16_bf16 v[112:127], v[144:147], v[168:171], v[112:127]
    s_waitcnt lgkmcnt(15)
    s_nop 0
    v_mfma_f32_32x32x16_bf16 v[96:111], v[128:131], v[180:183], v[96:111]
    v_mfma_f32_32x32x16_bf16 v[112:127], v[132:135], v[180:183], v[112:127]
    v_mfma_f32_32x32x16_bf16 v[96:111], v[148:151], v[160:163], v[96:111]
    v_mfma_f32_32x32x16_bf16 v[112:127], v[148:151], v[164:167], v[112:127]
    s_waitcnt lgkmcnt(15)
    s_nop 0
    v_mfma_f32_32x32x16_bf16 v[112:127], v[128:131], v[184:187], v[112:127]
    v_mfma_f32_32x32x16_bf16 v[112:127], v[152:155], v[160:163], v[112:127]
    s_waitcnt lgkmcnt(0)
    s_nop 0
    v_mfma_f32_32x32x16_bf16 v[64:79], v[192:195], v[228:231], v[64:79]
    ds_read_b64_tr_b16 v[128:129], v10 offset:288
    ds_read_b64_tr_b16 v[130:131], v10 offset:256
    v_mfma_f32_32x32x16_bf16 v[80:95], v[196:199], v[228:231], v[80:95]
    ds_read_b128 v[160:163], v11 offset:128
    ds_read_b64_tr_b16 v[132:133], v10 offset:800
    v_mfma_f32_32x32x16_bf16 v[64:79], v[196:199], v[224:227], v[64:79]
    ds_read_b64_tr_b16 v[134:135], v10 offset:768
    ds_read_b128 v[164:167], v11 offset:640
    v_mfma_f32_32x32x16_bf16 v[80:95], v[192:195], v[232:235], v[80:95]
    ds_read_b64_tr_b16 v[136:137], v10 offset:1312
    ds_read_b64_tr_b16 v[138:139], v10 offset:1280
    v_mfma_f32_32x32x16_bf16 v[96:111], v[200:203], v[236:239], v[96:111]
    ds_read_b128 v[168:171], v11 offset:1152
    ds_read_b64_tr_b16 v[140:141], v10 offset:1824
    v_mfma_f32_32x32x16_bf16 v[80:95], v[200:203], v[224:227], v[80:95]
    ds_read_b64_tr_b16 v[142:143], v10 offset:1792
    ds_read_b128 v[172:175], v11 offset:1664
    v_mfma_f32_32x32x16_bf16 v[96:111], v[204:207], v[232:235], v[96:111]
    ds_read_b64_tr_b16 v[144:145], v10 offset:2336
    ds_read_b64_tr_b16 v[146:147], v10 offset:2304
    v_mfma_f32_32x32x16_bf16 v[112:127], v[204:207], v[236:239], v[112:127]
    ds_read_b128 v[176:179], v11 offset:2176
    ds_read_b64_tr_b16 v[148:149], v10 offset:2848
    v_mfma_f32_32x32x16_bf16 v[96:111], v[196:199], v[240:243], v[96:111]
    ds_read_b64_tr_b16 v[150:151], v10 offset:2816
    ds_read_b128 v[180:183], v11 offset:2688
    v_mfma_f32_32x32x16_bf16 v[112:127], v[200:203], v[240:243], v[112:127]
    ds_read_b64_tr_b16 v[152:153], v10 offset:3360
    ds_read_b64_tr_b16 v[154:155], v10 offset:3328
    v_mfma_f32_32x32x16_bf16 v[96:111], v[208:211], v[228:231], v[96:111]
    ds_read_b128 v[184:187], v11 offset:3200
    v_mfma_f32_32x32x16_bf16 v[112:127], v[208:211], v[232:235], v[112:127]
    v_mfma_f32_32x32x16_bf16 v[96:111], v[192:195], v[244:247], v[96:111]
    v_mfma_f32_32x32x16_bf16 v[112:127], v[196:199], v[244:247], v[112:127]
    v_mfma_f32_32x32x16_bf16 v[96:111], v[212:215], v[224:227], v[96:111]
    v_mfma_f32_32x32x16_bf16 v[112:127], v[212:215], v[228:231], v[112:127]
    v_mfma_f32_32x32x16_bf16 v[112:127], v[192:195], v[248:251], v[112:127]
    v_mfma_f32_32x32x16_bf16 v[112:127], v[216:219], v[224:227], v[112:127]
    s_waitcnt lgkmcnt(0)
    s_nop 0
    v_mfma_f32_32x32x16_bf16 v[64:79], v[128:131], v[164:167], v[64:79]
    ds_read_b64_tr_b16 v[192:193], v10 offset:416
    ds_read_b64_tr_b16 v[194:195], v10 offset:384
    v_mfma_f32_32x32x16_bf16 v[80:95], v[132:135], v[164:167], v[80:95]
    ds_read_b128 v[224:227], v11 offset:0
    ds_read_b64_tr_b16 v[196:197], v10 offset:928
    v_mfma_f32_32x32x16_bf16 v[64:79], v[132:135], v[160:163], v[64:79]
    ds_read_b64_tr_b16 v[198:199], v10 offset:896
    ds_read_b128 v[228:231], v11 offset:512
    v_mfma_f32_32x32x16_bf16 v[80:95], v[128:131], v[168:171], v[80:95]
    ds_read_b64_tr_b16 v[200:201], v10 offset:1440
    ds_read_b64_tr_b16 v[202:203], v10 offset:1408
    v_mfma_f32_32x32x16_bf16 v[96:111], v[136:139], v[172:175], v[96:111]
    ds_read_b128 v[232:235], v11 offset:1024
    ds_read_b64_tr_b16 v[204:205], v10 offset:1952
    v_mfma_f32_32x32x16_bf16 v[80:95], v[136:139], v[160:163], v[80:95]
    ds_read_b64_tr_b16 v[206:207], v10 offset:1920
    ds_read_b128 v[236:239], v11 offset:1536
    v_mfma_f32_32x32x16_bf16 v[96:111], v[140:143], v[168:171], v[96:111]
    ds_read_b64_tr_b16 v[208:209], v10 offset:2464
    ds_read_b64_tr_b16 v[210:211], v10 offset:2432
    v_mfma_f32_32x32x16_bf16 v[112:127], v[140:143], v[172:175], v[112:127]
    ds_read_b128 v[240:243], v11 offset:2048
    ds_read_b64_tr_b16 v[212:213], v10 offset:2976
    v_mfma_f32_32x32x16_bf16 v[96:111], v[132:135], v[176:179], v[96:111]
    ds_read_b64_tr_b16 v[214:215], v10 offset:2944
    ds_read_b128 v[244:247], v11 offset:2560
    v_mfma_f32_32x32x16_bf16 v[112:127], v[136:139], v[176:179], v[112:127]
    ds_read_b64_tr_b16 v[216:217], v10 offset:3488
    ds_read_b64_tr_b16 v[218:219], v10 offset:3456
    v_mfma_f32_32x32x16_bf16 v[96:111], v[144:147], v[164:167], v[96:111]
    ds_read_b128 v[248:251], v11 offset:3072
    v_mfma_f32_32x32x16_bf16 v[112:127], v[144:147], v[168:171], v[112:127]
    v_mfma_f32_32x32x16_bf16 v[96:111], v[128:131], v[180:183], v[96:111]
    v_mfma_f32_32x32x16_bf16 v[112:127], v[132:135], v[180:183], v[112:127]
    v_mfma_f32_32x32x16_bf16 v[96:111], v[148:151], v[160:163], v[96:111]
    v_mfma_f32_32x32x16_bf16 v[112:127], v[148:151], v[164:167], v[112:127]
    v_mfma_f32_32x32x16_bf16 v[112:127], v[128:131], v[184:187], v[112:127]
    v_mfma_f32_32x32x16_bf16 v[112:127], v[152:155], v[160:163], v[112:127]
    s_waitcnt lgkmcnt(0)
    s_lshl_b32 s15, s10, 2
    s_add_u32 s15, s15, 147200
    v_mov_b32 v16, s15
    v_mov_b32 v17, s34
    v_add_u32 v16, 16, v16
    v_xor_b32 v18, 4, v16
    v_mfma_f32_32x32x16_bf16 v[80:95], v[196:199], v[228:231], v[80:95]
    ds_read_b32 v32, v13 offset:0
    ds_read_b32 v33, v13 offset:32
    s_mov_b32 s30, 0xfff0fff0
    s_mov_b32 s31, s30
    s_lshl_b32 s14, s17, 16
    v_mfma_f32_32x32x16_bf16 v[64:79], v[192:195], v[228:231], v[64:79]
    ds_read_b32 v34, v13 offset:64
    ds_read_b32 v35, v13 offset:96
    s_and_b32 s15, s17, 0xffff0000
    s_bitcmp0_b32 s12, 0
    s_cselect_b32 s14, s14, s15
    v_mfma_f32_32x32x16_bf16 v[80:95], v[192:195], v[232:235], v[80:95]
    ds_read_b32 v36, v13 offset:2048
    ds_read_b32 v37, v13 offset:2080
    s_lshl_b32 s12, s12, 12
    s_nop 0
    s_add_u32 s12, s12, 12582912
    v_mfma_f32_32x32x16_bf16 v[64:79], v[196:199], v[224:227], v[64:79]
    ds_read_b32 v38, v13 offset:2112
    ds_read_b32 v39, v13 offset:2144
    v_mfma_f32_32x32x16_bf16 v[80:95], v[200:203], v[224:227], v[80:95]
    v_mfma_f32_32x32x16_bf16 v[112:127], v[204:207], v[236:239], v[112:127]
    s_nop 7
    s_nop 0
    v_add_f32_dpp v147, v64, v66 row_ror:8 row_mask:0xf bank_mask:0x3
    v_add_f32_dpp v148, v65, v67 row_ror:8 row_mask:0xf bank_mask:0x3
    v_add_f32_dpp v149, v66, v68 row_ror:8 row_mask:0xf bank_mask:0x3
    v_add_f32_dpp v150, v67, v69 row_ror:8 row_mask:0xf bank_mask:0x3
    v_add_f32_dpp v151, v68, v70 row_ror:8 row_mask:0xf bank_mask:0x3
    v_mfma_f32_32x32x16_bf16 v[96:111], v[200:203], v[236:239], v[96:111]
    v_add_f32_dpp v152, v69, v71 row_ror:8 row_mask:0xf bank_mask:0x3
    v_add_f32_dpp v147, v74, v72 row_ror:8 row_mask:0xf bank_mask:0xc
    v_add_f32_dpp v148, v75, v73 row_ror:8 row_mask:0xf bank_mask:0xc
    v_add_f32_dpp v149, v76, v74 row_ror:8 row_mask:0xf bank_mask:0xc
    v_add_f32_dpp v150, v77, v75 row_ror:8 row_mask:0xf bank_mask:0xc
    v_mfma_f32_32x32x16_bf16 v[112:127], v[200:203], v[240:243], v[112:127]
    v_add_f32_dpp v151, v78, v76 row_ror:8 row_mask:0xf bank_mask:0xc
    v_add_f32_dpp v152, v79, v77 row_ror:8 row_mask:0xf bank_mask:0xc
    v_add_f32_dpp v144, v71, v69 row_ror:8 row_mask:0xf bank_mask:0xc
    v_add_f32_dpp v145, v72, v70 row_ror:8 row_mask:0xf bank_mask:0xc
    v_add_f32_dpp v146, v73, v71 row_ror:8 row_mask:0xf bank_mask:0xc
    v_mfma_f32_32x32x16_bf16 v[96:111], v[204:207], v[232:235], v[96:111]
    v_add_f32_dpp v43, v147, v148 row_shl:4 row_mask:0xf bank_mask:0x5
    v_add_f32_dpp v44, v148, v149 row_shl:4 row_mask:0xf bank_mask:0x5
    v_add_f32_dpp v45, v149, v150 row_shl:4 row_mask:0xf bank_mask:0x5
    v_add_f32_dpp v46, v150, v151 row_shl:4 row_mask:0xf bank_mask:0x5
    v_add_f32_dpp v47, v151, v152 row_shl:4 row_mask:0xf bank_mask:0x5
    v_mfma_f32_32x32x16_bf16 v[112:127], v[208:211], v[232:235], v[112:127]
    s_waitcnt lgkmcnt(0)
    s_mov_b64 exec, s[30:31]
    ds_write_b128 v12, v[76:79] offset:272
    s_mov_b64 exec, -1
    v_lshlrev_b32 v56, 16, v32
    v_mfma_f32_32x32x16_bf16 v[96:111], v[196:199], v[240:243], v[96:111]
    v_and_b32 v60, 0xffff0000, v32
    v_lshlrev_b32_e64 v57, 16, v33
    v_and_b32 v61, 0xffff0000, v33
    v_lshlrev_b32_e64 v58, 16, v34
    v_and_b32 v62, 0xffff0000, v34
    v_mfma_f32_32x32x16_bf16 v[112:127], v[196:199], v[244:247], v[112:127]
    v_lshlrev_b32_e64 v59, 16, v35
    v_and_b32 v63, 0xffff0000, v35
    s_mov_b64 exec, s[30:31]
    s_nop 0
    ds_write_b128 v12, v[92:95] offset:528
    s_mov_b64 exec, -1
    s_nop 0
    v_mfma_f32_32x32x16_bf16 v[96:111], v[208:211], v[228:231], v[96:111]
    v_add_f32_dpp v159, v80, v82 row_ror:8 row_mask:0xf bank_mask:0x3
    v_add_f32_dpp v160, v81, v83 row_ror:8 row_mask:0xf bank_mask:0x3
    v_add_f32_dpp v161, v82, v84 row_ror:8 row_mask:0xf bank_mask:0x3
    v_add_f32_dpp v162, v83, v85 row_ror:8 row_mask:0xf bank_mask:0x3
    v_add_f32_dpp v163, v84, v86 row_ror:8 row_mask:0xf bank_mask:0x3
    v_mfma_f32_32x32x16_bf16 v[112:127], v[212:215], v[228:231], v[112:127]
    v_add_f32_dpp v164, v85, v87 row_ror:8 row_mask:0xf bank_mask:0x3
    v_add_f32_dpp v159, v90, v88 row_ror:8 row_mask:0xf bank_mask:0xc
    v_add_f32_dpp v160, v91, v89 row_ror:8 row_mask:0xf bank_mask:0xc
    v_add_f32_dpp v161, v92, v90 row_ror:8 row_mask:0xf bank_mask:0xc
    v_add_f32_dpp v162, v93, v91 row_ror:8 row_mask:0xf bank_mask:0xc
    v_mfma_f32_32x32x16_bf16 v[96:111], v[192:195], v[244:247], v[96:111]
    v_add_f32_dpp v163, v94, v92 row_ror:8 row_mask:0xf bank_mask:0xc
    v_add_f32_dpp v164, v95, v93 row_ror:8 row_mask:0xf bank_mask:0xc
    v_add_f32_dpp v156, v87, v85 row_ror:8 row_mask:0xf bank_mask:0xc
    v_add_f32_dpp v157, v88, v86 row_ror:8 row_mask:0xf bank_mask:0xc
    v_add_f32_dpp v158, v89, v87 row_ror:8 row_mask:0xf bank_mask:0xc
    v_mfma_f32_32x32x16_bf16 v[112:127], v[192:195], v[248:251], v[112:127]
    v_add_f32_dpp v43, v160, v159 row_shr:4 row_mask:0xf bank_mask:0xa
    v_add_f32_dpp v44, v161, v160 row_shr:4 row_mask:0xf bank_mask:0xa
    v_add_f32_dpp v45, v162, v161 row_shr:4 row_mask:0xf bank_mask:0xa
    v_add_f32_dpp v46, v163, v162 row_shr:4 row_mask:0xf bank_mask:0xa
    v_add_f32_dpp v47, v164, v163 row_shr:4 row_mask:0xf bank_mask:0xa
    v_mfma_f32_32x32x16_bf16 v[96:111], v[212:215], v[224:227], v[96:111]
    v_lshlrev_b32_e64 v153, 16, v36
    v_and_b32 v166, 0xffff0000, v36
    v_lshlrev_b32_e64 v154, 16, v37
    v_and_b32 v167, 0xffff0000, v37
    v_lshlrev_b32_e64 v155, 16, v38
    v_mfma_f32_32x32x16_bf16 v[112:127], v[216:219], v[224:227], v[112:127]
    v_and_b32 v177, 0xffff0000, v38
    v_lshlrev_b32_e64 v165, 16, v39
    v_and_b32 v178, 0xffff0000, v39
    v_fmac_f32 v43, s14, v59
    v_fmac_f32 v44, s14, v60
    v_fmac_f32 v45, s14, v61
    v_fmac_f32 v46, s14, v62
    v_fmac_f32_e64 v47, s14, v63
    v_cvt_pk_bf16_f32 v82, v44, v45
    v_cvt_pk_bf16_f32 v83, v46, v47
    s_mov_b64 exec, s[30:31]
    s_nop 0
    ds_write_b128 v12, v[108:111] offset:1296
    ds_write_b128 v12, v[124:127] offset:1552
    s_mov_b64 exec, -1
    s_nop 0
    ds_write_b32 v16, v17
    ds_read_b32 v19, v18
    ds_read_b128 v[128:131], v12 offset:256
    ds_read_b128 v[132:135], v12 offset:512
    ds_read_b128 v[136:139], v12 offset:1280
    ds_read_b128 v[140:143], v12 offset:1536
    v_add_f32_dpp v171, v96, v98 row_ror:8 row_mask:0xf bank_mask:0x3
    v_add_f32_dpp v172, v97, v99 row_ror:8 row_mask:0xf bank_mask:0x3
    v_add_f32_dpp v173, v98, v100 row_ror:8 row_mask:0xf bank_mask:0x3
    v_add_f32_dpp v174, v99, v101 row_ror:8 row_mask:0xf bank_mask:0x3
    v_add_f32_dpp v175, v100, v102 row_ror:8 row_mask:0xf bank_mask:0x3
    v_add_f32_dpp v176, v101, v103 row_ror:8 row_mask:0xf bank_mask:0x3
    v_add_f32_dpp v171, v106, v104 row_ror:8 row_mask:0xf bank_mask:0xc
    v_add_f32_dpp v172, v107, v105 row_ror:8 row_mask:0xf bank_mask:0xc
    v_add_f32_dpp v173, v108, v106 row_ror:8 row_mask:0xf bank_mask:0xc
    v_add_f32_dpp v174, v109, v107 row_ror:8 row_mask:0xf bank_mask:0xc
    v_add_f32_dpp v175, v110, v108 row_ror:8 row_mask:0xf bank_mask:0xc
    v_add_f32_dpp v176, v111, v109 row_ror:8 row_mask:0xf bank_mask:0xc
    v_add_f32_dpp v168, v103, v101 row_ror:8 row_mask:0xf bank_mask:0xc
    v_add_f32_dpp v169, v104, v102 row_ror:8 row_mask:0xf bank_mask:0xc
    v_add_f32_dpp v170, v105, v103 row_ror:8 row_mask:0xf bank_mask:0xc
    v_add_f32_dpp v183, v112, v114 row_ror:8 row_mask:0xf bank_mask:0x3
    v_add_f32_dpp v184, v113, v115 row_ror:8 row_mask:0xf bank_mask:0x3
    v_add_f32_dpp v185, v114, v116 row_ror:8 row_mask:0xf bank_mask:0x3
    v_add_f32_dpp v186, v115, v117 row_ror:8 row_mask:0xf bank_mask:0x3
    v_add_f32_dpp v187, v116, v118 row_ror:8 row_mask:0xf bank_mask:0x3
    v_add_f32_dpp v188, v117, v119 row_ror:8 row_mask:0xf bank_mask:0x3
    v_add_f32_dpp v183, v122, v120 row_ror:8 row_mask:0xf bank_mask:0xc
    v_add_f32_dpp v184, v123, v121 row_ror:8 row_mask:0xf bank_mask:0xc
    v_add_f32_dpp v185, v124, v122 row_ror:8 row_mask:0xf bank_mask:0xc
    v_add_f32_dpp v186, v125, v123 row_ror:8 row_mask:0xf bank_mask:0xc
    v_add_f32_dpp v187, v126, v124 row_ror:8 row_mask:0xf bank_mask:0xc
    v_add_f32_dpp v188, v127, v125 row_ror:8 row_mask:0xf bank_mask:0xc
    v_add_f32_dpp v180, v119, v117 row_ror:8 row_mask:0xf bank_mask:0xc
    v_add_f32_dpp v181, v120, v118 row_ror:8 row_mask:0xf bank_mask:0xc
    v_add_f32_dpp v182, v121, v119 row_ror:8 row_mask:0xf bank_mask:0xc
    v_add_f32_dpp v51, v171, v172 row_shl:4 row_mask:0xf bank_mask:0x5
    v_add_f32_dpp v52, v172, v173 row_shl:4 row_mask:0xf bank_mask:0x5
    v_add_f32_dpp v53, v173, v174 row_shl:4 row_mask:0xf bank_mask:0x5
    v_add_f32_dpp v54, v174, v175 row_shl:4 row_mask:0xf bank_mask:0x5
    v_add_f32_dpp v55, v175, v176 row_shl:4 row_mask:0xf bank_mask:0x5
    v_add_f32_dpp v51, v184, v183 row_shr:4 row_mask:0xf bank_mask:0xa
    v_add_f32_dpp v52, v185, v184 row_shr:4 row_mask:0xf bank_mask:0xa
    v_add_f32_dpp v53, v186, v185 row_shr:4 row_mask:0xf bank_mask:0xa
    v_add_f32_dpp v54, v187, v186 row_shr:4 row_mask:0xf bank_mask:0xa
    v_add_f32_dpp v55, v188, v187 row_shr:4 row_mask:0xf bank_mask:0xa
    v_fmac_f32 v51, s14, v165
    v_fmac_f32 v52, s14, v166
    v_fmac_f32 v53, s14, v167
    v_fmac_f32 v54, s14, v177
    v_fmac_f32_e64 v55, s14, v178
    v_cvt_pk_bf16_f32 v86, v52, v53
    v_cvt_pk_bf16_f32 v87, v54, v55
    s_mov_b32 s28, 2097152
.L_hw1:
    s_waitcnt lgkmcnt(0)
    v_readfirstlane_b32 s15, v19
    s_cmp_lg_u32 s15, 0
    s_cbranch_scc1 .L_tdone
    ds_read_b32 v19, v18
    ds_read_b128 v[128:131], v12 offset:256
    ds_read_b128 v[132:135], v12 offset:512
    ds_read_b128 v[136:139], v12 offset:1280
    ds_read_b128 v[140:143], v12 offset:1536
    s_sub_u32 s28, s28, 1
    s_cbranch_scc0 .L_hw1
.L_tdone:
    s_waitcnt lgkmcnt(0)
    s_nop 0
    v_add_f32_dpp v144, v129, v131 row_ror:8 row_mask:0xf bank_mask:0x3
    v_add_f32_dpp v145, v130, v64 row_ror:8 row_mask:0xf bank_mask:0x3
    v_add_f32_dpp v146, v131, v65 row_ror:8 row_mask:0xf bank_mask:0x3
    v_add_f32_dpp v156, v133, v135 row_ror:8 row_mask:0xf bank_mask:0x3
    v_add_f32_dpp v157, v134, v80 row_ror:8 row_mask:0xf bank_mask:0x3
    v_add_f32_dpp v158, v135, v81 row_ror:8 row_mask:0xf bank_mask:0x3
    v_add_f32_dpp v168, v137, v139 row_ror:8 row_mask:0xf bank_mask:0x3
    v_add_f32_dpp v169, v138, v96 row_ror:8 row_mask:0xf bank_mask:0x3
    v_add_f32_dpp v170, v139, v97 row_ror:8 row_mask:0xf bank_mask:0x3
    v_add_f32_dpp v40, v144, v145 row_shl:4 row_mask:0xf bank_mask:0x5
    v_add_f32_dpp v41, v145, v146 row_shl:4 row_mask:0xf bank_mask:0x5
    v_add_f32_dpp v42, v146, v147 row_shl:4 row_mask:0xf bank_mask:0x5
    v_add_f32_dpp v180, v141, v143 row_ror:8 row_mask:0xf bank_mask:0x3
    v_add_f32_dpp v181, v142, v112 row_ror:8 row_mask:0xf bank_mask:0x3
    v_add_f32_dpp v182, v143, v113 row_ror:8 row_mask:0xf bank_mask:0x3
    v_add_f32_dpp v40, v157, v156 row_shr:4 row_mask:0xf bank_mask:0xa
    v_add_f32_dpp v41, v158, v157 row_shr:4 row_mask:0xf bank_mask:0xa
    v_add_f32_dpp v42, v159, v158 row_shr:4 row_mask:0xf bank_mask:0xa
    v_add_f32_dpp v48, v168, v169 row_shl:4 row_mask:0xf bank_mask:0x5
    v_add_f32_dpp v49, v169, v170 row_shl:4 row_mask:0xf bank_mask:0x5
    v_add_f32_dpp v50, v170, v171 row_shl:4 row_mask:0xf bank_mask:0x5
    v_fmac_f32 v40, s14, v56
    v_fmac_f32 v41, s14, v57
    v_fmac_f32_e64 v42, s14, v58
    v_add_f32_dpp v48, v181, v180 row_shr:4 row_mask:0xf bank_mask:0xa
    v_add_f32_dpp v49, v182, v181 row_shr:4 row_mask:0xf bank_mask:0xa
    v_add_f32_dpp v50, v183, v182 row_shr:4 row_mask:0xf bank_mask:0xa
    v_cvt_pk_bf16_f32 v80, v40, v41
    v_cvt_pk_bf16_f32 v81, v42, v43
    buffer_store_dwordx4 v[80:83], v14, s[68:71], s12 offen sc1
    v_fmac_f32 v48, s14, v153
    v_fmac_f32 v49, s14, v154
    v_fmac_f32_e64 v50, s14, v155
    v_cvt_pk_bf16_f32 v84, v48, v49
    v_cvt_pk_bf16_f32 v85, v50, v51
    buffer_store_dwordx4 v[84:87], v14, s[68:71], s12 offen offset:2048 sc1
    v_mov_b32 v11, 147248
    v_mov_b32 v12, 1
    s_mov_b64 exec, 1
    ds_add_u32 v11, v12
    s_mov_b64 exec, -1
    v_and_b32 v8, 7, v1
    v_lshrrev_b32 v9, 3, v1
    v_lshlrev_b32 v9, 12, v9
    v_bfe_u32 v10, v1, 4, 1
    v_xor_b32 v10, v8, v10
    s_lshl_b32 s14, s10, 1
    s_and_b32 s14, s14, 4
    v_xor_b32 v10, s14, v10
    v_lshl_add_u32 v9, v10, 4, v9
    v_xor_b32_e64 v10, 32, v9
    v_add_u32 v10, 32768, v10
    s_lshl2_add_u32 s14, s6, s10
    s_lshl_b32 s14, s14, 10
    v_lshlrev_b32_e64 v8, 7, v8
    s_add_u32 s14, s14, 15532032
    s_lshl_b32 s15, s6, 18
    s_lshl_b32 s26, s8, 7
    s_add_u32 s15, s15, s26
    s_lshl_b32 s26, s10, 16
    s_add_u32 s15, s15, s26
    s_nop 0
    s_add_u32 s15, s15, 12582912
    v_mov_b32 v11, 147236
    v_mov_b32_e64 v12, 1
    s_waitcnt vmcnt(0)
    s_mov_b64 exec, 1
    ds_add_rtn_u32 v13, v11, v12
    s_waitcnt lgkmcnt(0)
    v_readfirstlane_b32 s26, v13
    s_cmp_lg_u32 s26, 3
    s_cbranch_scc1 .L_nosig
    s_lshl_b32 s26, s2, 7
    s_nop 0
    s_add_u32 s26, s26, 15532032
    v_mov_b32_e64 v13, 0
    buffer_store_dword v17, v13, s[68:71], s26 offen sc1
.L_nosig:
    s_mov_b64 exec, -1
    s_nop 0
    s_mov_b32 s28, 2097152
.L_yd:
    ds_read_b32 v13, v11 offset:16
    s_sub_u32 s28, s28, 1
    s_cbranch_scc1 .L_ydx
    s_waitcnt lgkmcnt(0)
    v_readfirstlane_b32 s26, v13
    s_cmp_eq_u32 s26, 4
    s_cbranch_scc1 .L_ydx
    s_sleep 2
    s_branch .L_yd
.L_ydx:
    s_lshl_b32 s26, s10, 11
    s_nop 0
    s_add_u32 m0, s26, 131072
    s_mov_b32 s28, 262144
.L_poll:
    buffer_load_dword v13, v8, s[68:71], s14 offen sc1
    s_sub_u32 s28, s28, 1
    s_cbranch_scc1 .L_got
    s_waitcnt vmcnt(0)
    v_cmp_ne_u32_e64 vcc, s34, v13
    s_cbranch_vccz .L_got
    s_sleep 4
    s_branch .L_poll
.L_got:
    buffer_load_dwordx4 v9, s[68:71], s15 offen sc1 lds
    s_add_u32 m0, m0, 1024
    s_nop 0
    s_nop 0
    buffer_load_dwordx4 v10, s[68:71], s15 offen sc1 lds
    s_lshl_b32 s26, s10, 4
    s_nop 0
    s_add_u32 s26, s26, 131072
    v_lshrrev_b32 v12, 4, v1
    v_lshlrev_b32 v12, 10, v12
    v_bfe_u32 v13, v1, 2, 2
    v_lshl_add_u32 v12, v13, 7, v12
    v_and_b32_e64 v13, 1, v1
    v_lshl_add_u32 v12, v13, 3, v12
    v_bfe_u32 v13, v1, 1, 1
.L_pp5:
    s_cbranch_execz .L_pb5
    s_nop 0
    v_lshl_add_u32 v12, v13, 12, v12
    v_lshl_add_u32 v12, v13, 6, v12
    v_bfe_u32 v13, v1, 3, 2
    v_lshl_add_u32 v12, v13, 4, v12
    v_xor_b32 v12, s26, v12
    v_xor_b32 v18, 64, v12
    v_lshrrev_b32 v14, 4, v1
    v_lshlrev_b32 v14, 11, v14
    v_and_b32_e64 v13, 15, v1
    v_lshl_add_u32 v14, v13, 4, v14
    v_bfe_u32 v13, v1, 3, 1
    v_lshl_add_u32 v14, v13, 15, v14
    s_lshl_b32 s27, s10, 7
    v_xor_b32 v14, s27, v14
    s_add_u32 s25, s24, 32768
    v_lshlrev_b32_e64 v96, 16, v24
    v_and_b32 v97, 0xffff0000, v24
    v_lshlrev_b32_e64 v98, 16, v25
    v_and_b32 v99, 0xffff0000, v25
    v_lshlrev_b32_e64 v100, 16, v26
    v_and_b32 v101, 0xffff0000, v26
    v_lshlrev_b32_e64 v102, 16, v27
    v_and_b32 v103, 0xffff0000, v27
    v_lshlrev_b32_e64 v104, 16, v28
    v_and_b32 v105, 0xffff0000, v28
    v_lshlrev_b32_e64 v106, 16, v29
    v_and_b32 v107, 0xffff0000, v29
    v_lshlrev_b32_e64 v108, 16, v30
    v_and_b32 v109, 0xffff0000, v30
    v_lshlrev_b32_e64 v110, 16, v31
    v_and_b32 v111, 0xffff0000, v31
    s_setprio 2
    s_nop 0
    s_mov_b32 s27, 0xffff0000
    s_mov_b32 s29, 0x3f803f80
    v_mov_b32_e64 v16, 1
    s_waitcnt vmcnt(0)
    s_mov_b64 exec, 1
    ds_add_u32 v11, v16 offset:24
    s_mov_b64 exec, -1
    s_nop 0
    s_mov_b32 s28, 2097152
.L_y2:
    ds_read_b64 v[20:21], v11 offset:20
    s_sub_u32 s28, s28, 1
    s_cbranch_scc1 .L_y2x
    s_waitcnt lgkmcnt(0)
    v_and_b32_e64 v20, v20, v21
    s_nop 0
    v_readfirstlane_b32 s26, v20
    s_cmp_eq_u32 s26, 4
    s_cbranch_scc1 .L_y2x
    s_branch .L_y2
.L_y2x:
    ds_read_b64_tr_b16 v[72:73], v12 offset:0
    ds_read_b64_tr_b16 v[74:75], v12 offset:512
    ds_read_b64_tr_b16 v[76:77], v18 offset:0
    ds_read_b64_tr_b16 v[78:79], v18 offset:512
    ds_read_b128 v[128:131], v14 offset:0
    ds_read_b128 v[132:135], v14 offset:8192
    ds_read_b128 v[136:139], v14 offset:16384
    ds_read_b128 v[140:143], v14 offset:24576
    ds_read_b128 v[144:147], v14 offset:1024
    ds_read_b128 v[148:151], v14 offset:9216
    ds_read_b128 v[152:155], v14 offset:17408
    ds_read_b128 v[156:159], v14 offset:25600
    s_waitcnt lgkmcnt(10)
    v_lshlrev_b32 v80, 16, v72
    v_and_b32 v81, s27, v72
    v_lshlrev_b32 v82, 16, v73
    v_and_b32 v83, s27, v73
    v_lshlrev_b32 v84, 16, v74
    v_and_b32 v85, s27, v74
    v_lshlrev_b32 v86, 16, v75
    v_and_b32 v87, s27, v75
    v_add_f32 v96, v96, v80
    v_add_f32 v97, v97, v81
    v_add_f32 v98, v98, v82
    v_add_f32 v99, v99, v83
    v_add_f32 v100, v100, v84
    v_add_f32 v101, v101, v85
    v_add_f32 v102, v102, v86
    v_add_f32 v103, v103, v87
    s_waitcnt lgkmcnt(8)
    v_lshlrev_b32 v80, 16, v76
    v_and_b32 v81, s27, v76
    v_lshlrev_b32 v82, 16, v77
    v_and_b32 v83, s27, v77
    v_lshlrev_b32 v84, 16, v78
    v_and_b32 v85, s27, v78
    v_lshlrev_b32 v86, 16, v79
    v_and_b32 v87, s27, v79
    v_add_f32 v104, v104, v80
    v_add_f32 v105, v105, v81
    v_add_f32 v106, v106, v82
    v_add_f32 v107, v107, v83
    v_add_f32 v108, v108, v84
    v_add_f32 v109, v109, v85
    v_add_f32 v110, v110, v86
    v_add_f32 v111, v111, v87
    s_waitcnt lgkmcnt(4)
    v_add_f32 v128, v128, v132
    v_add_f32 v129, v129, v133
    v_add_f32 v136, v136, v140
    v_add_f32 v137, v137, v141
    v_add_f32 v130, v130, v134
    v_add_f32 v131, v131, v135
    v_add_f32 v138, v138, v142
    v_add_f32 v139, v139, v143
    v_add_f32 v128, v128, v136
    v_add_f32 v129, v129, v137
    v_add_f32 v130, v130, v138
    v_add_f32_e64 v131, v131, v139
    v_cvt_pk_bf16_f32 v128, v128, v96
    v_cvt_pk_bf16_f32 v129, v129, v97
    v_cvt_pk_bf16_f32 v130, v130, v98
    v_cvt_pk_bf16_f32 v131, v131, v99
    v_dot2_f32_bf16 v128, v128, s29, 0
    v_dot2_f32_bf16 v129, v129, s29, 0
    v_dot2_f32_bf16 v130, v130, s29, 0
    v_dot2_f32_bf16 v131, v131, s29, 0
    s_waitcnt lgkmcnt(0)
    v_add_f32 v144, v144, v148
    v_add_f32 v145, v145, v149
    v_add_f32 v152, v152, v156
    v_add_f32 v153, v153, v157
    v_add_f32 v146, v146, v150
    v_add_f32 v147, v147, v151
    v_add_f32 v154, v154, v158
    v_add_f32 v155, v155, v159
    v_add_f32 v144, v144, v152
    v_add_f32 v145, v145, v153
    v_add_f32 v146, v146, v154
    v_add_f32_e64 v147, v147, v155
    v_cvt_pk_bf16_f32 v144, v144, v100
    v_cvt_pk_bf16_f32 v145, v145, v101
    v_cvt_pk_bf16_f32 v146, v146, v102
    v_cvt_pk_bf16_f32 v147, v147, v103
    v_dot2_f32_bf16 v144, v144, s29, 0
    v_dot2_f32_bf16 v145, v145, s29, 0
    v_dot2_f32_bf16 v146, v146, s29, 0
    v_dot2_f32_bf16 v147, v147, s29, 0
    v_cvt_pk_bf16_f32 v64, v128, v129
    v_cvt_pk_bf16_f32 v65, v130, v131
    v_cvt_pk_bf16_f32 v66, v144, v145
    v_cvt_pk_bf16_f32 v67, v146, v147
    buffer_store_dwordx4 v[64:67], v15, s[64:67], s24 offen sc1
    s_barrier
    s_nop 0
    ds_read_b128 v[160:163], v14 offset:512
    ds_read_b128 v[164:167], v14 offset:8704
    ds_read_b128 v[168:171], v14 offset:16896
    ds_read_b128 v[172:175], v14 offset:25088
    ds_read_b128 v[176:179], v14 offset:1536
    ds_read_b128 v[180:183], v14 offset:9728
    ds_read_b128 v[184:187], v14 offset:17920
    ds_read_b128 v[188:191], v14 offset:26112
    s_waitcnt lgkmcnt(4)
    s_nop 0
    v_pk_add_f32 v[160:161], v[160:161], v[164:165]
    v_pk_add_f32 v[168:169], v[168:169], v[172:173]
    v_pk_add_f32 v[162:163], v[162:163], v[166:167]
    v_pk_add_f32 v[170:171], v[170:171], v[174:175]
    v_pk_add_f32 v[160:161], v[160:161], v[168:169]
    v_pk_add_f32 v[162:163], v[162:163], v[170:171]
    v_cvt_pk_bf16_f32 v160, v160, v104
    v_cvt_pk_bf16_f32 v161, v161, v105
    v_cvt_pk_bf16_f32 v162, v162, v106
    v_cvt_pk_bf16_f32 v163, v163, v107
    v_dot2_f32_bf16 v160, v160, s29, 0
    v_dot2_f32_bf16 v161, v161, s29, 0
    v_dot2_f32_bf16 v162, v162, s29, 0
    v_dot2_f32_bf16 v163, v163, s29, 0
    s_waitcnt lgkmcnt(0)
    s_nop 0
    v_pk_add_f32 v[176:177], v[176:177], v[180:181]
    v_pk_add_f32 v[184:185], v[184:185], v[188:189]
    v_pk_add_f32 v[178:179], v[178:179], v[182:183]
    v_pk_add_f32 v[186:187], v[186:187], v[190:191]
    v_pk_add_f32 v[176:177], v[176:177], v[184:185]
    v_pk_add_f32 v[178:179], v[178:179], v[186:187]
    v_cvt_pk_bf16_f32 v176, v176, v108
    v_cvt_pk_bf16_f32 v177, v177, v109
    v_cvt_pk_bf16_f32 v178, v178, v110
    v_cvt_pk_bf16_f32 v179, v179, v111
    v_dot2_f32_bf16 v176, v176, s29, 0
    v_dot2_f32_bf16 v177, v177, s29, 0
    v_dot2_f32_bf16 v178, v178, s29, 0
    v_dot2_f32_bf16 v179, v179, s29, 0
    v_cvt_pk_bf16_f32 v68, v160, v161
    v_cvt_pk_bf16_f32 v69, v162, v163
    v_cvt_pk_bf16_f32 v70, v176, v177
    v_cvt_pk_bf16_f32 v71, v178, v179
    buffer_store_dwordx4 v[68:71], v15, s[64:67], s25 offen sc1
    s_lshl_b32 s15, s2, 2
    s_add_u32 s15, s15, s10
    s_cmp_lg_u32 s15, 0
    s_cbranch_scc1 .L_fin
    v_mov_b32 v13, 15597568
    s_mov_b64 exec, 1
    s_nop 0
    buffer_store_dword v17, v13, s[68:71], 0 offen sc1
    s_mov_b64 exec, -1
    s_branch .L_fin
    s_nop 0
    s_nop 0
    s_nop 0
    s_nop 0
    s_nop 0
    s_nop 0
    s_nop 0
    s_nop 0
    s_nop 0
    s_nop 0
    s_nop 0
    s_nop 0
    s_nop 0
    s_nop 0
    s_nop 0
    s_nop 0
    s_nop 0
    s_nop 0
    s_nop 0
    s_nop 0
    s_nop 0
    s_nop 0
    s_nop 0
    s_nop 0
    s_nop 0
    s_nop 0
    s_nop 0
    s_nop 0
    s_nop 0
    s_nop 0
    s_nop 0
    s_nop 0
    s_nop 0
    s_nop 0
    s_nop 0
    s_nop 0
    s_nop 0
    s_nop 0
    s_nop 0
    s_nop 0
    s_nop 0
    s_nop 0
    s_nop 0
    s_nop 0
    s_nop 0
    s_nop 0
    s_nop 0
    s_nop 0
    s_nop 0
    s_nop 0
    s_nop 0
    s_nop 0
    s_nop 0
    s_nop 0
    s_nop 0
    s_nop 0
    s_nop 0
    s_nop 0
    s_nop 0
    s_nop 0
    s_nop 0
    s_nop 0
    s_nop 0
    s_nop 0
    s_nop 0
    s_nop 0
    s_nop 0
    s_nop 0
    s_nop 0
    s_nop 0
    s_nop 0
    s_nop 0
    s_nop 0
    s_nop 0
    s_nop 0
    s_nop 0
    s_nop 0
    s_nop 0
    s_nop 0
    s_nop 0
    s_nop 0
    s_nop 0
    s_nop 0
    s_nop 0
    s_nop 0
    s_nop 0
    s_nop 0
    s_nop 0
    s_nop 0
    s_nop 0
    s_nop 0
    s_nop 0
    s_nop 0
    s_nop 0
    s_nop 0
    s_nop 0
    s_nop 0
    s_nop 0
    s_nop 0
    s_nop 0
    s_nop 0
    s_nop 0
    s_nop 0
    s_nop 0
    s_nop 0
    s_nop 0
    s_nop 0
    s_nop 0
    s_nop 0
    s_nop 0
    s_nop 0
    s_nop 0
    s_nop 0
    s_nop 0
    s_nop 0
    s_nop 0
    s_nop 0
    s_nop 0
    s_nop 0
    s_nop 0
    s_nop 0
    s_nop 0
    s_nop 0
    s_nop 0
    s_nop 0
    s_nop 0
    s_nop 0
    s_nop 0
    s_nop 0
    s_nop 0
    s_nop 0
    s_nop 0
    s_nop 0
    s_nop 0
    s_nop 0
    s_nop 0
    s_nop 0
    s_nop 0
    s_nop 0
    s_nop 0
    s_nop 0
    s_nop 0
    s_nop 0
    s_nop 0
    s_nop 0
    s_nop 0
    s_nop 0
    s_nop 0
    s_nop 0
    s_nop 0
    s_nop 0
    s_nop 0
    s_nop 0
    s_nop 0
    s_nop 0
    s_nop 0
    s_nop 0
    s_nop 0
    s_nop 0
    s_nop 0
    s_nop 0
    s_nop 0
    s_nop 0
    s_nop 0
    s_nop 0
    s_nop 0
    s_nop 0
    s_nop 0
    s_nop 0
    s_nop 0
    s_nop 0
    s_nop 0
    s_nop 0
    s_nop 0
    s_nop 0
    s_nop 0
    s_nop 0
    s_nop 0
    s_nop 0
    s_nop 0
    s_nop 0
    s_nop 0
    s_nop 0
    s_nop 0
    s_nop 0
    s_nop 0
    s_nop 0
    s_nop 0
    s_nop 0
    s_nop 0
    s_nop 0
    s_nop 0
    s_nop 0
    s_nop 0
    s_nop 0
    s_nop 0
    s_nop 0
    s_nop 0
    s_nop 0
    s_nop 0
    s_nop 0
    s_nop 0
    s_nop 0
    s_nop 0
    s_nop 0
    s_nop 0
    s_nop 0
    s_nop 0
    s_nop 0
    s_nop 0
    s_nop 0
    s_nop 0
    s_nop 0
    s_nop 0
.L_w03:
    s_cbranch_scc1 .L_xtag
    s_nop 0
    s_load_dword s34, s[46:47], s15
.L_xtag:
    s_lshl_b32 s10, s3, 13
    s_nop 0
    s_add_u32 s10, s10, 65536
    v_and_b32 v60, 7, v1
    v_lshlrev_b32 v60, 4, v60
    v_lshl_add_u32 v60, v1, 7, v60
    v_add_u32 v112, s10, v60
    v_xor_b32 v113, 16, v112
    v_xor_b32 v114, 32, v112
    v_xor_b32 v115, 48, v112
    v_xor_b32_e64 v116, 64, v112
    v_xor_b32 v117, 80, v112
    v_xor_b32 v118, 96, v112
    v_xor_b32 v119, 112, v112
    v_and_b32 v60, 15, v1
    v_lshrrev_b32 v61, 4, v1
    v_bfe_u32 v62, v1, 1, 3
    v_xor_b32 v62, v62, v61
    v_lshlrev_b32 v62, 4, v62
    v_lshl_add_u32 v62, v60, 7, v62
    s_lshl_b32 s10, s3, 13
    v_add_u32 v2, s10, v62
    v_xor_b32_e64 v3, 64, v2
    v_add_u32 v4, 0x10000, v2
    v_add_u32 v5, 0x10000, v3
    v_lshrrev_b32 v62, 5, v1
    v_lshlrev_b32 v10, 12, v62
    v_bfe_u32 v62, v1, 4, 1
    v_mul_u32_u24 v62, 1088, v62
    v_add_u32_e64 v10, v10, v62
    v_bfe_u32 v62, v1, 2, 2
    v_lshl_add_u32 v10, v62, 7, v10
    v_bfe_u32 v62, v1, 3, 1
    v_lshl_add_u32 v10, v62, 4, v10
    v_bfe_u32 v62, v1, 1, 1
    v_lshl_add_u32 v10, v62, 5, v10
    v_and_b32_e64 v62, 1, v1
    v_lshl_add_u32 v10, v62, 3, v10
    v_add_u32 v10, 98304, v10
    v_xor_b32 v11, 16, v10
    v_xor_b32 v12, 64, v10
    v_xor_b32 v13, 80, v10
    s_lshl_b32 s11, s3, 8
    s_nop 0
    s_add_u32 s11, s11, 146048
    v_lshl_add_u32 v48, v60, 2, s11
    v_lshlrev_b32_e64 v49, 2, v1
    v_add_u32 v49, 162432, v49
    v_mov_b32 v50, 147232
    s_mov_b32 vcc_lo, -1
    s_mov_b32 vcc_hi, 0
    s_lshl_b32 s12, s4, 2
    s_add_u32 s12, s12, s3
    s_mul_i32 s12, s12, 224
    s_mul_i32 s13, s5, 7
    s_add_u32 s13, s13, s9
    s_lshl_b32 s13, s13, 2
    s_add_u32 s12, s12, s13
    s_lshl_b32 s12, s12, 10
    s_nop 0
    s_add_u32 s13, s12, 114688
    v_lshlrev_b32_e64 v51, 4, v60
    v_lshl_add_u32 v51, v61, 9, v51
    s_mov_b64 s[60:61], s[40:41]
    s_nop 0
    s_mov_b32 s62, 1835008
    s_mov_b32 s63, 0x20000
    s_mov_b64 s[64:65], s[42:43]
    s_nop 0
    s_mov_b32 s66, 0x200000
    s_mov_b32 s67, 0x20000
    s_mov_b64 s[68:69], s[46:47]
    s_nop 0
    s_mov_b32 s70, 18874368
    s_mov_b32 s71, 0x20000
    s_mov_b64 s[72:73], s[44:45]
    s_nop 0
    s_mov_b32 s74, 256
    s_mov_b32 s75, 0x20000
    s_lshl2_add_u32 s21, s4, s3
    s_lshl2_add_u32 s21, s21, s5
    s_lshl_b32 s21, s21, 3
    s_add_u32 s21, s21, s9
    s_lshl_b32 s21, s21, 7
    s_nop 0
    s_add_u32 s21, s21, 14680064
    v_lshrrev_b32 v8, 3, v1
    v_and_b32 v9, 7, v1
    v_bfe_u32 v60, v1, 4, 1
    v_lshlrev_b32 v60, 2, v60
    v_xor_b32 v9, v9, v60
    v_lshlrev_b32_e64 v9, 4, v9
    v_lshl_add_u32 v14, v8, 10, v9
    s_mul_i32 s24, s3, 458752
    s_lshl_b32 s25, s6, 7
    s_add_u32 s24, s24, s25
    v_add_u32_e64 v14, s24, v14
    v_add_u32 v15, 7168, v14
    s_lshl_b32 s25, s7, 1
    s_add_u32 s25, s25, s9
    s_and_b32 s25, s25, 7
    s_mul_i32 s25, s25, 7
    s_lshr_b32 s25, s25, 1
    s_lshl_b32 s25, s25, 14
    s_lshl_b32 s27, s3, 13
    v_lshrrev_b32 v8, 5, v1
    v_bfe_u32 v9, v1, 2, 2
    v_lshl_add_u32 v8, v8, 2, v9
    v_lshlrev_b32_e64 v8, 7, v8
    v_bfe_u32 v9, v1, 4, 1
    v_lshl_add_u32 v8, v9, 5, v8
    v_and_b32_e64 v9, 3, v1
    v_lshl_add_u32 v8, v9, 3, v8
    v_bfe_u32 v9, v1, 3, 1
    v_lshl_add_u32 v8, v9, 6, v8
    v_add_u32 v6, s27, v8
    v_xor_b32 v7, 64, v6
    v_add_u32 v8, 0x10000, v6
    v_add_u32 v9, 0x10000, v7
    s_waitcnt vmcnt(0)
    s_nop 0
    v_mul_f32 v64, 0x3fb8aa00, v102
    v_rndne_f32 v65, v64
    v_sub_f32 v64, v64, v65
    v_fmac_f32 v64, 0x36eca570, v102
    v_exp_f32 v64, v64
    v_cvt_i32_f32 v65, v65
    v_ldexp_f32 v64, v64, v65
    v_cvt_pk_bf16_f32 v64, v64, v64
    v_lshlrev_b32 v64, 16, v64
    v_mul_f32 v96, v64, v96
    v_mul_f32_e64 v97, v64, v97
    v_mul_f32 v96, 0x3fb8aa3b, v96
    v_mul_f32 v97, 0x3e22f983, v97
    v_mul_f32 v66, v64, v98
    v_mul_f32_e64 v67, v64, v99
    v_mul_f32 v72, 0x41000000, v96
    v_mul_f32 v73, 0x41000000, v97
    v_exp_f32 v72, v72
    v_fract_f32 v73, v73
    v_cos_f32 v70, v73
    v_sin_f32 v71, v73
    v_mul_f32 v70, v70, v72
    v_mul_f32 v71, v71, v72
    v_mul_f32 v74, v100, v66
    v_mul_f32 v75, v100, v67
    v_fma_f32 v74, -v101, v67, v74
    v_fmac_f32 v75, v101, v66
    v_mul_f32 v72, v70, v70
    v_mul_f32_e64 v73, v70, v71
    v_fma_f32 v72, -v71, v71, v72
    v_fmac_f32 v73, v71, v70
    v_mul_f32 v76, v74, v70
    v_mul_f32_e64 v77, v74, v71
    v_fma_f32 v76, -v75, v71, v76
    v_fmac_f32 v77, v75, v70
    v_mul_f32 v78, v74, v72
    v_mul_f32_e64 v79, v74, v73
    v_fma_f32 v78, -v75, v73, v78
    v_fmac_f32 v79, v75, v72
    v_mul_f32 v80, v76, v72
    v_mul_f32_e64 v81, v76, v73
    v_fma_f32 v80, -v77, v73, v80
    v_fmac_f32_e64 v81, v77, v72
    v_cvt_pk_bf16_f32 v208, v74, v76
    v_cvt_pk_bf16_f32 v212, v75, v77
    v_mul_f32 v74, v78, v72
    v_mul_f32 v75, v78, v73
    v_fma_f32 v74, -v79, v73, v74
    v_fmac_f32 v75, v79, v72
    v_mul_f32 v76, v80, v72
    v_mul_f32_e64 v77, v80, v73
    v_fma_f32 v76, -v81, v73, v76
    v_fmac_f32_e64 v77, v81, v72
    v_cvt_pk_bf16_f32 v209, v78, v80
    v_cvt_pk_bf16_f32 v213, v79, v81
    v_mul_f32 v78, v74, v72
    v_mul_f32 v79, v74, v73
    v_fma_f32 v78, -v75, v73, v78
    v_fmac_f32 v79, v75, v72
    v_mul_f32 v80, v76, v72
    v_mul_f32_e64 v81, v76, v73
    v_fma_f32 v80, -v77, v73, v80
    v_fmac_f32_e64 v81, v77, v72
    v_cvt_pk_bf16_f32 v210, v74, v76
    v_cvt_pk_bf16_f32 v214, v75, v77
    v_mul_f32 v74, v78, v72
    v_mul_f32 v75, v78, v73
    v_fma_f32 v74, -v79, v73, v74
    v_fmac_f32 v75, v79, v72
    v_mul_f32 v76, v80, v72
    v_mul_f32_e64 v77, v80, v73
    v_fma_f32 v76, -v81, v73, v76
    v_fmac_f32_e64 v77, v81, v72
    v_cvt_pk_bf16_f32 v211, v78, v80
    v_cvt_pk_bf16_f32 v215, v79, v81
    ds_write_b128 v112, v[208:211]
    ds_write_b128 v116, v[212:215]
    v_mul_f32 v78, v74, v72
    v_mul_f32 v79, v74, v73
    v_fma_f32 v78, -v75, v73, v78
    v_fmac_f32 v79, v75, v72
    v_mul_f32 v80, v76, v72
    v_mul_f32_e64 v81, v76, v73
    v_fma_f32 v80, -v77, v73, v80
    v_fmac_f32_e64 v81, v77, v72
    v_cvt_pk_bf16_f32 v216, v74, v76
    v_cvt_pk_bf16_f32 v220, v75, v77
    v_mul_f32 v74, v78, v72
    v_mul_f32 v75, v78, v73
    v_fma_f32 v74, -v79, v73, v74
    v_fmac_f32 v75, v79, v72
    v_mul_f32 v76, v80, v72
    v_mul_f32_e64 v77, v80, v73
    v_fma_f32 v76, -v81, v73, v76
    v_fmac_f32_e64 v77, v81, v72
    v_cvt_pk_bf16_f32 v217, v78, v80
    v_cvt_pk_bf16_f32 v221, v79, v81
    v_mul_f32 v78, v74, v72
    v_mul_f32 v79, v74, v73
    v_fma_f32 v78, -v75, v73, v78
    v_fmac_f32 v79, v75, v72
    v_mul_f32 v80, v76, v72
    v_mul_f32_e64 v81, v76, v73
    v_fma_f32 v80, -v77, v73, v80
    v_fmac_f32_e64 v81, v77, v72
    v_cvt_pk_bf16_f32 v218, v74, v76
    v_cvt_pk_bf16_f32 v222, v75, v77
    v_mul_f32 v74, v78, v72
    v_mul_f32 v75, v78, v73
    v_fma_f32 v74, -v79, v73, v74
    v_fmac_f32 v75, v79, v72
    v_mul_f32 v76, v80, v72
    v_mul_f32_e64 v77, v80, v73
    v_fma_f32 v76, -v81, v73, v76
    v_fmac_f32_e64 v77, v81, v72
    v_cvt_pk_bf16_f32 v219, v78, v80
    v_cvt_pk_bf16_f32 v223, v79, v81
    ds_write_b128 v113, v[216:219]
    ds_write_b128 v117, v[220:223]
    v_mul_f32 v78, v74, v72
    v_mul_f32 v79, v74, v73
    v_fma_f32 v78, -v75, v73, v78
    v_fmac_f32 v79, v75, v72
    v_mul_f32 v80, v76, v72
    v_mul_f32_e64 v81, v76, v73
    v_fma_f32 v80, -v77, v73, v80
    v_fmac_f32_e64 v81, v77, v72
    v_cvt_pk_bf16_f32 v208, v74, v76
    v_cvt_pk_bf16_f32 v212, v75, v77
    v_mul_f32 v74, v78, v72
    v_mul_f32 v75, v78, v73
    v_fma_f32 v74, -v79, v73, v74
    v_fmac_f32 v75, v79, v72
    v_mul_f32 v76, v80, v72
    v_mul_f32_e64 v77, v80, v73
    v_fma_f32 v76, -v81, v73, v76
    v_fmac_f32_e64 v77, v81, v72
    v_cvt_pk_bf16_f32 v209, v78, v80
    v_cvt_pk_bf16_f32 v213, v79, v81
    v_mul_f32 v78, v74, v72
    v_mul_f32 v79, v74, v73
    v_fma_f32 v78, -v75, v73, v78
    v_fmac_f32 v79, v75, v72
    v_mul_f32 v80, v76, v72
    v_mul_f32_e64 v81, v76, v73
    v_fma_f32 v80, -v77, v73, v80
    v_fmac_f32_e64 v81, v77, v72
    v_cvt_pk_bf16_f32 v210, v74, v76
    v_cvt_pk_bf16_f32 v214, v75, v77
    v_mul_f32 v74, v78, v72
    v_mul_f32 v75, v78, v73
    v_fma_f32 v74, -v79, v73, v74
    v_fmac_f32 v75, v79, v72
    v_mul_f32 v76, v80, v72
    v_mul_f32_e64 v77, v80, v73
    v_fma_f32 v76, -v81, v73, v76
    v_fmac_f32_e64 v77, v81, v72
    v_cvt_pk_bf16_f32 v211, v78, v80
    v_cvt_pk_bf16_f32 v215, v79, v81
    ds_write_b128 v114, v[208:211]
    ds_write_b128 v118, v[212:215]
    v_mul_f32 v78, v74, v72
    v_mul_f32 v79, v74, v73
    v_fma_f32 v78, -v75, v73, v78
    v_fmac_f32 v79, v75, v72
    v_mul_f32 v80, v76, v72
    v_mul_f32_e64 v81, v76, v73
    v_fma_f32 v80, -v77, v73, v80
    v_fmac_f32_e64 v81, v77, v72
    v_cvt_pk_bf16_f32 v216, v74, v76
    v_cvt_pk_bf16_f32 v220, v75, v77
    v_mul_f32 v74, v78, v72
    v_mul_f32 v75, v78, v73
    v_fma_f32 v74, -v79, v73, v74
    v_fmac_f32 v75, v79, v72
    v_mul_f32 v76, v80, v72
    v_mul_f32_e64 v77, v80, v73
    v_fma_f32 v76, -v81, v73, v76
    v_fmac_f32_e64 v77, v81, v72
    v_cvt_pk_bf16_f32 v217, v78, v80
    v_cvt_pk_bf16_f32 v221, v79, v81
    v_mul_f32 v78, v74, v72
    v_mul_f32 v79, v74, v73
    v_fma_f32 v78, -v75, v73, v78
    v_fmac_f32 v79, v75, v72
    v_mul_f32 v80, v76, v72
    v_mul_f32_e64 v81, v76, v73
    v_fma_f32 v80, -v77, v73, v80
    v_fmac_f32_e64 v81, v77, v72
    v_cvt_pk_bf16_f32 v218, v74, v76
    v_cvt_pk_bf16_f32 v222, v75, v77
    v_cvt_pk_bf16_f32 v219, v78, v80
    v_cvt_pk_bf16_f32 v223, v79, v81
    ds_write_b128 v115, v[216:219]
    ds_write_b128 v119, v[220:223]
    s_cmp_ge_u32 s7, 28
    s_waitcnt lgkmcnt(0)
    s_cbranch_scc1 .L_auxbar
    s_add_u32 s34, s34, 2
    s_or_b32 s34, s34, 1
.L_g1:
    s_barrier
    ds_read_b128 v[96:99], v2 offset:0
    ds_read_b64_tr_b16 v[64:65], v10 offset:0
    ds_read_b64_tr_b16 v[66:67], v10 offset:512
    ds_read_b128 v[100:103], v2 offset:2048
    ds_read_b128 v[104:107], v2 offset:4096
    ds_read_b128 v[108:111], v2 offset:6144
    ds_read_b64_tr_b16 v[68:69], v11 offset:0
    ds_read_b64_tr_b16 v[70:71], v11 offset:512
    ds_read_b64_tr_b16 v[72:73], v12 offset:0
    ds_read_b64_tr_b16 v[74:75], v12 offset:512
    ds_read_b64_tr_b16 v[76:77], v13 offset:0
    ds_read_b64_tr_b16 v[78:79], v13 offset:512
    s_waitcnt lgkmcnt(9)
    s_nop 0
    v_mfma_f32_16x16x32_bf16 v[128:131], v[64:67], v[96:99], 0
    ds_read_b64_tr_b16 v[80:81], v10 offset:2048
    s_waitcnt lgkmcnt(9)
    s_nop 0
    v_mfma_f32_16x16x32_bf16 v[160:163], v[64:67], v[100:103], 0
    ds_read_b64_tr_b16 v[82:83], v10 offset:2560
    s_waitcnt lgkmcnt(9)
    s_nop 0
    v_mfma_f32_16x16x32_bf16 v[192:195], v[64:67], v[104:107], 0
    ds_read_b64_tr_b16 v[84:85], v11 offset:2048
    s_waitcnt lgkmcnt(9)
    s_nop 0
    v_mfma_f32_16x16x32_bf16 v[224:227], v[64:67], v[108:111], 0
    ds_read_b64_tr_b16 v[86:87], v11 offset:2560
    s_waitcnt lgkmcnt(8)
    s_nop 0
    v_mfma_f32_16x16x32_bf16 v[228:231], v[68:71], v[108:111], 0
    ds_read_b64_tr_b16 v[88:89], v12 offset:2048
    v_mfma_f32_16x16x32_bf16 v[196:199], v[68:71], v[104:107], 0
    ds_read_b64_tr_b16 v[90:91], v12 offset:2560
    v_mfma_f32_16x16x32_bf16 v[164:167], v[68:71], v[100:103], 0
    ds_read_b64_tr_b16 v[92:93], v13 offset:2048
    v_mfma_f32_16x16x32_bf16 v[132:135], v[68:71], v[96:99], 0
    ds_read_b64_tr_b16 v[94:95], v13 offset:2560
    s_waitcnt lgkmcnt(10)
    s_nop 0
    v_mfma_f32_16x16x32_bf16 v[136:139], v[72:75], v[96:99], 0
    v_mfma_f32_16x16x32_bf16 v[168:171], v[72:75], v[100:103], 0
    v_mfma_f32_16x16x32_bf16 v[200:203], v[72:75], v[104:107], 0
    v_mfma_f32_16x16x32_bf16 v[232:235], v[72:75], v[108:111], 0
    s_waitcnt lgkmcnt(8)
    s_nop 0
    v_mfma_f32_16x16x32_bf16 v[236:239], v[76:79], v[108:111], 0
    v_mfma_f32_16x16x32_bf16 v[204:207], v[76:79], v[104:107], 0
    v_mfma_f32_16x16x32_bf16 v[172:175], v[76:79], v[100:103], 0
    v_mfma_f32_16x16x32_bf16 v[140:143], v[76:79], v[96:99], 0
    s_waitcnt lgkmcnt(6)
    s_nop 0
    v_mfma_f32_16x16x32_bf16 v[144:147], v[80:83], v[96:99], 0
    s_waitcnt lgkmcnt(0)
    s_barrier
    ds_read_b128 v[112:115], v3 offset:0
    v_mfma_f32_16x16x32_bf16 v[176:179], v[80:83], v[100:103], 0
    ds_read_b64_tr_b16 v[64:65], v10 offset:8192
    v_mfma_f32_16x16x32_bf16 v[208:211], v[80:83], v[104:107], 0
    ds_read_b64_tr_b16 v[66:67], v10 offset:8704
    v_mfma_f32_16x16x32_bf16 v[240:243], v[80:83], v[108:111], 0
    ds_read_b128 v[116:119], v3 offset:2048
    v_mfma_f32_16x16x32_bf16 v[244:247], v[84:87], v[108:111], 0
    ds_read_b128 v[120:123], v3 offset:4096
    v_mfma_f32_16x16x32_bf16 v[212:215], v[84:87], v[104:107], 0
    ds_read_b128 v[124:127], v3 offset:6144
    v_mfma_f32_16x16x32_bf16 v[180:183], v[84:87], v[100:103], 0
    ds_read_b64_tr_b16 v[68:69], v11 offset:8192
    v_mfma_f32_16x16x32_bf16 v[148:151], v[84:87], v[96:99], 0
    ds_read_b64_tr_b16 v[70:71], v11 offset:8704
    v_mfma_f32_16x16x32_bf16 v[152:155], v[88:91], v[96:99], 0
    ds_read_b64_tr_b16 v[72:73], v12 offset:8192
    v_mfma_f32_16x16x32_bf16 v[184:187], v[88:91], v[100:103], 0
    ds_read_b64_tr_b16 v[74:75], v12 offset:8704
    v_mfma_f32_16x16x32_bf16 v[216:219], v[88:91], v[104:107], 0
    ds_read_b64_tr_b16 v[76:77], v13 offset:8192
    v_mfma_f32_16x16x32_bf16 v[248:251], v[88:91], v[108:111], 0
    ds_read_b64_tr_b16 v[78:79], v13 offset:8704
    v_mfma_f32_16x16x32_bf16 v[252:255], v[92:95], v[108:111], 0
    v_mfma_f32_16x16x32_bf16 v[220:223], v[92:95], v[104:107], 0
    v_mfma_f32_16x16x32_bf16 v[188:191], v[92:95], v[100:103], 0
    v_mfma_f32_16x16x32_bf16 v[156:159], v[92:95], v[96:99], 0
    s_waitcnt lgkmcnt(9)
    s_nop 0
    v_mfma_f32_16x16x32_bf16 v[128:131], v[64:67], v[112:115], v[128:131]
    ds_read_b64_tr_b16 v[80:81], v10 offset:10240
    s_waitcnt lgkmcnt(9)
    s_nop 0
    v_mfma_f32_16x16x32_bf16 v[160:163], v[64:67], v[116:119], v[160:163]
    ds_read_b64_tr_b16 v[82:83], v10 offset:10752
    s_waitcnt lgkmcnt(9)
    s_nop 0
    v_mfma_f32_16x16x32_bf16 v[192:195], v[64:67], v[120:123], v[192:195]
    ds_read_b64_tr_b16 v[84:85], v11 offset:10240
    s_waitcnt lgkmcnt(9)
    s_nop 0
    v_mfma_f32_16x16x32_bf16 v[224:227], v[64:67], v[124:127], v[224:227]
    ds_read_b64_tr_b16 v[86:87], v11 offset:10752
    s_waitcnt lgkmcnt(8)
    s_nop 0
    v_mfma_f32_16x16x32_bf16 v[228:231], v[68:71], v[124:127], v[228:231]
    ds_read_b64_tr_b16 v[88:89], v12 offset:10240
    v_mfma_f32_16x16x32_bf16 v[196:199], v[68:71], v[120:123], v[196:199]
    ds_read_b64_tr_b16 v[90:91], v12 offset:10752
    v_mfma_f32_16x16x32_bf16 v[164:167], v[68:71], v[116:119], v[164:167]
    ds_read_b64_tr_b16 v[92:93], v13 offset:10240
    v_mfma_f32_16x16x32_bf16 v[132:135], v[68:71], v[112:115], v[132:135]
    ds_read_b64_tr_b16 v[94:95], v13 offset:10752
    s_waitcnt lgkmcnt(10)
    s_nop 0
    v_mfma_f32_16x16x32_bf16 v[136:139], v[72:75], v[112:115], v[136:139]
    v_mfma_f32_16x16x32_bf16 v[168:171], v[72:75], v[116:119], v[168:171]
    v_mfma_f32_16x16x32_bf16 v[200:203], v[72:75], v[120:123], v[200:203]
    v_mfma_f32_16x16x32_bf16 v[232:235], v[72:75], v[124:127], v[232:235]
    s_waitcnt lgkmcnt(8)
    s_nop 0
    v_mfma_f32_16x16x32_bf16 v[236:239], v[76:79], v[124:127], v[236:239]
    v_mfma_f32_16x16x32_bf16 v[204:207], v[76:79], v[120:123], v[204:207]
    v_mfma_f32_16x16x32_bf16 v[172:175], v[76:79], v[116:119], v[172:175]
    v_mfma_f32_16x16x32_bf16 v[140:143], v[76:79], v[112:115], v[140:143]
    s_waitcnt lgkmcnt(6)
    s_nop 0
    v_mfma_f32_16x16x32_bf16 v[144:147], v[80:83], v[112:115], v[144:147]
    s_waitcnt lgkmcnt(0)
    s_barrier
    ds_read_b128 v[96:99], v2 offset:32768
    v_mfma_f32_16x16x32_bf16 v[176:179], v[80:83], v[116:119], v[176:179]
    ds_read_b64_tr_b16 v[64:65], v10 offset:16384
    v_mfma_f32_16x16x32_bf16 v[208:211], v[80:83], v[120:123], v[208:211]
    ds_read_b64_tr_b16 v[66:67], v10 offset:16896
    v_mfma_f32_16x16x32_bf16 v[240:243], v[80:83], v[124:127], v[240:243]
    ds_read_b128 v[100:103], v2 offset:34816
    v_mfma_f32_16x16x32_bf16 v[244:247], v[84:87], v[124:127], v[244:247]
    ds_read_b128 v[104:107], v2 offset:36864
    v_mfma_f32_16x16x32_bf16 v[212:215], v[84:87], v[120:123], v[212:215]
    ds_read_b128 v[108:111], v2 offset:38912
    v_mfma_f32_16x16x32_bf16 v[180:183], v[84:87], v[116:119], v[180:183]
    ds_read_b64_tr_b16 v[68:69], v11 offset:16384
    v_mfma_f32_16x16x32_bf16 v[148:151], v[84:87], v[112:115], v[148:151]
    ds_read_b64_tr_b16 v[70:71], v11 offset:16896
    v_mfma_f32_16x16x32_bf16 v[152:155], v[88:91], v[112:115], v[152:155]
    ds_read_b64_tr_b16 v[72:73], v12 offset:16384
    v_mfma_f32_16x16x32_bf16 v[184:187], v[88:91], v[116:119], v[184:187]
    ds_read_b64_tr_b16 v[74:75], v12 offset:16896
    v_mfma_f32_16x16x32_bf16 v[216:219], v[88:91], v[120:123], v[216:219]
    ds_read_b64_tr_b16 v[76:77], v13 offset:16384
    v_mfma_f32_16x16x32_bf16 v[248:251], v[88:91], v[124:127], v[248:251]
    ds_read_b64_tr_b16 v[78:79], v13 offset:16896
    v_mfma_f32_16x16x32_bf16 v[252:255], v[92:95], v[124:127], v[252:255]
    v_mfma_f32_16x16x32_bf16 v[220:223], v[92:95], v[120:123], v[220:223]
    v_mfma_f32_16x16x32_bf16 v[188:191], v[92:95], v[116:119], v[188:191]
    v_mfma_f32_16x16x32_bf16 v[156:159], v[92:95], v[112:115], v[156:159]
    s_waitcnt lgkmcnt(9)
    s_nop 0
    v_mfma_f32_16x16x32_bf16 v[128:131], v[64:67], v[96:99], v[128:131]
    ds_read_b64_tr_b16 v[80:81], v10 offset:18432
    s_waitcnt lgkmcnt(9)
    s_nop 0
    v_mfma_f32_16x16x32_bf16 v[160:163], v[64:67], v[100:103], v[160:163]
    ds_read_b64_tr_b16 v[82:83], v10 offset:18944
    s_waitcnt lgkmcnt(9)
    s_nop 0
    v_mfma_f32_16x16x32_bf16 v[192:195], v[64:67], v[104:107], v[192:195]
    ds_read_b64_tr_b16 v[84:85], v11 offset:18432
    s_waitcnt lgkmcnt(9)
    s_nop 0
    v_mfma_f32_16x16x32_bf16 v[224:227], v[64:67], v[108:111], v[224:227]
    ds_read_b64_tr_b16 v[86:87], v11 offset:18944
    s_waitcnt lgkmcnt(8)
    s_nop 0
    v_mfma_f32_16x16x32_bf16 v[228:231], v[68:71], v[108:111], v[228:231]
    ds_read_b64_tr_b16 v[88:89], v12 offset:18432
    v_mfma_f32_16x16x32_bf16 v[196:199], v[68:71], v[104:107], v[196:199]
    ds_read_b64_tr_b16 v[90:91], v12 offset:18944
    v_mfma_f32_16x16x32_bf16 v[164:167], v[68:71], v[100:103], v[164:167]
    ds_read_b64_tr_b16 v[92:93], v13 offset:18432
    v_mfma_f32_16x16x32_bf16 v[132:135], v[68:71], v[96:99], v[132:135]
    ds_read_b64_tr_b16 v[94:95], v13 offset:18944
    s_waitcnt lgkmcnt(10)
    s_nop 0
    v_mfma_f32_16x16x32_bf16 v[136:139], v[72:75], v[96:99], v[136:139]
    v_mfma_f32_16x16x32_bf16 v[168:171], v[72:75], v[100:103], v[168:171]
    v_mfma_f32_16x16x32_bf16 v[200:203], v[72:75], v[104:107], v[200:203]
    v_mfma_f32_16x16x32_bf16 v[232:235], v[72:75], v[108:111], v[232:235]
    s_waitcnt lgkmcnt(8)
    s_nop 0
    v_mfma_f32_16x16x32_bf16 v[236:239], v[76:79], v[108:111], v[236:239]
    v_mfma_f32_16x16x32_bf16 v[204:207], v[76:79], v[104:107], v[204:207]
    v_mfma_f32_16x16x32_bf16 v[172:175], v[76:79], v[100:103], v[172:175]
    v_mfma_f32_16x16x32_bf16 v[140:143], v[76:79], v[96:99], v[140:143]
    s_waitcnt lgkmcnt(6)
    s_nop 0
    v_mfma_f32_16x16x32_bf16 v[144:147], v[80:83], v[96:99], v[144:147]
    s_waitcnt lgkmcnt(0)
    s_barrier
    ds_read_b128 v[112:115], v3 offset:32768
    v_mfma_f32_16x16x32_bf16 v[176:179], v[80:83], v[100:103], v[176:179]
    ds_read_b64_tr_b16 v[64:65], v10 offset:24576
    v_mfma_f32_16x16x32_bf16 v[208:211], v[80:83], v[104:107], v[208:211]
    ds_read_b64_tr_b16 v[66:67], v10 offset:25088
    v_mfma_f32_16x16x32_bf16 v[240:243], v[80:83], v[108:111], v[240:243]
    ds_read_b128 v[116:119], v3 offset:34816
    v_mfma_f32_16x16x32_bf16 v[244:247], v[84:87], v[108:111], v[244:247]
    ds_read_b128 v[120:123], v3 offset:36864
    v_mfma_f32_16x16x32_bf16 v[212:215], v[84:87], v[104:107], v[212:215]
    ds_read_b128 v[124:127], v3 offset:38912
    v_mfma_f32_16x16x32_bf16 v[180:183], v[84:87], v[100:103], v[180:183]
    ds_read_b64_tr_b16 v[68:69], v11 offset:24576
    v_mfma_f32_16x16x32_bf16 v[148:151], v[84:87], v[96:99], v[148:151]
    ds_read_b64_tr_b16 v[70:71], v11 offset:25088
    v_mfma_f32_16x16x32_bf16 v[152:155], v[88:91], v[96:99], v[152:155]
    ds_read_b64_tr_b16 v[72:73], v12 offset:24576
    v_mfma_f32_16x16x32_bf16 v[184:187], v[88:91], v[100:103], v[184:187]
    ds_read_b64_tr_b16 v[74:75], v12 offset:25088
    v_mfma_f32_16x16x32_bf16 v[216:219], v[88:91], v[104:107], v[216:219]
    ds_read_b64_tr_b16 v[76:77], v13 offset:24576
    v_mfma_f32_16x16x32_bf16 v[248:251], v[88:91], v[108:111], v[248:251]
    ds_read_b64_tr_b16 v[78:79], v13 offset:25088
    v_mfma_f32_16x16x32_bf16 v[252:255], v[92:95], v[108:111], v[252:255]
    v_mfma_f32_16x16x32_bf16 v[220:223], v[92:95], v[104:107], v[220:223]
    v_mfma_f32_16x16x32_bf16 v[188:191], v[92:95], v[100:103], v[188:191]
    v_mfma_f32_16x16x32_bf16 v[156:159], v[92:95], v[96:99], v[156:159]
    s_waitcnt lgkmcnt(9)
    s_nop 0
    v_mfma_f32_16x16x32_bf16 v[128:131], v[64:67], v[112:115], v[128:131]
    ds_read_b64_tr_b16 v[80:81], v10 offset:26624
    s_waitcnt lgkmcnt(9)
    s_nop 0
    v_mfma_f32_16x16x32_bf16 v[160:163], v[64:67], v[116:119], v[160:163]
    ds_read_b64_tr_b16 v[82:83], v10 offset:27136
    s_waitcnt lgkmcnt(9)
    s_nop 0
    v_mfma_f32_16x16x32_bf16 v[192:195], v[64:67], v[120:123], v[192:195]
    ds_read_b64_tr_b16 v[84:85], v11 offset:26624
    s_waitcnt lgkmcnt(9)
    s_nop 0
    v_mfma_f32_16x16x32_bf16 v[224:227], v[64:67], v[124:127], v[224:227]
    ds_read_b64_tr_b16 v[86:87], v11 offset:27136
    s_waitcnt lgkmcnt(8)
    s_nop 0
    v_mfma_f32_16x16x32_bf16 v[228:231], v[68:71], v[124:127], v[228:231]
    ds_read_b64_tr_b16 v[88:89], v12 offset:26624
    v_mfma_f32_16x16x32_bf16 v[196:199], v[68:71], v[120:123], v[196:199]
    ds_read_b64_tr_b16 v[90:91], v12 offset:27136
    v_mfma_f32_16x16x32_bf16 v[164:167], v[68:71], v[116:119], v[164:167]
    ds_read_b64_tr_b16 v[92:93], v13 offset:26624
    v_mfma_f32_16x16x32_bf16 v[132:135], v[68:71], v[112:115], v[132:135]
    ds_read_b64_tr_b16 v[94:95], v13 offset:27136
    s_waitcnt lgkmcnt(10)
    s_nop 0
    v_mfma_f32_16x16x32_bf16 v[136:139], v[72:75], v[112:115], v[136:139]
    v_mfma_f32_16x16x32_bf16 v[168:171], v[72:75], v[116:119], v[168:171]
    v_mfma_f32_16x16x32_bf16 v[200:203], v[72:75], v[120:123], v[200:203]
    v_mfma_f32_16x16x32_bf16 v[232:235], v[72:75], v[124:127], v[232:235]
    s_waitcnt lgkmcnt(8)
    s_nop 0
    v_mfma_f32_16x16x32_bf16 v[236:239], v[76:79], v[124:127], v[236:239]
    v_mfma_f32_16x16x32_bf16 v[204:207], v[76:79], v[120:123], v[204:207]
    v_mfma_f32_16x16x32_bf16 v[172:175], v[76:79], v[116:119], v[172:175]
    v_mfma_f32_16x16x32_bf16 v[140:143], v[76:79], v[112:115], v[140:143]
    s_waitcnt lgkmcnt(6)
    s_nop 0
    v_mfma_f32_16x16x32_bf16 v[144:147], v[80:83], v[112:115], v[144:147]
    s_waitcnt lgkmcnt(0)
    s_barrier
    ds_read_b128 v[96:99], v4 offset:0
    v_mfma_f32_16x16x32_bf16 v[176:179], v[80:83], v[116:119], v[176:179]
    ds_read_b64_tr_b16 v[64:65], v10 offset:0
    v_mfma_f32_16x16x32_bf16 v[208:211], v[80:83], v[120:123], v[208:211]
    ds_read_b64_tr_b16 v[66:67], v10 offset:512
    v_mfma_f32_16x16x32_bf16 v[240:243], v[80:83], v[124:127], v[240:243]
    ds_read_b128 v[100:103], v4 offset:2048
    v_mfma_f32_16x16x32_bf16 v[244:247], v[84:87], v[124:127], v[244:247]
    ds_read_b128 v[104:107], v4 offset:4096
    v_mfma_f32_16x16x32_bf16 v[212:215], v[84:87], v[120:123], v[212:215]
    ds_read_b128 v[108:111], v4 offset:6144
    v_mfma_f32_16x16x32_bf16 v[180:183], v[84:87], v[116:119], v[180:183]
    ds_read_b64_tr_b16 v[68:69], v11 offset:0
    v_mfma_f32_16x16x32_bf16 v[148:151], v[84:87], v[112:115], v[148:151]
    ds_read_b64_tr_b16 v[70:71], v11 offset:512
    v_mfma_f32_16x16x32_bf16 v[152:155], v[88:91], v[112:115], v[152:155]
    ds_read_b64_tr_b16 v[72:73], v12 offset:0
    v_mfma_f32_16x16x32_bf16 v[184:187], v[88:91], v[116:119], v[184:187]
    ds_read_b64_tr_b16 v[74:75], v12 offset:512
    v_mfma_f32_16x16x32_bf16 v[216:219], v[88:91], v[120:123], v[216:219]
    ds_read_b64_tr_b16 v[76:77], v13 offset:0
    v_mfma_f32_16x16x32_bf16 v[248:251], v[88:91], v[124:127], v[248:251]
    ds_read_b64_tr_b16 v[78:79], v13 offset:512
    v_mfma_f32_16x16x32_bf16 v[252:255], v[92:95], v[124:127], v[252:255]
    v_mfma_f32_16x16x32_bf16 v[220:223], v[92:95], v[120:123], v[220:223]
    v_mfma_f32_16x16x32_bf16 v[188:191], v[92:95], v[116:119], v[188:191]
    v_mfma_f32_16x16x32_bf16 v[156:159], v[92:95], v[112:115], v[156:159]
    s_waitcnt lgkmcnt(9)
    s_nop 0
    v_mfma_f32_16x16x32_bf16 v[128:131], v[64:67], v[96:99], v[128:131]
    ds_read_b64_tr_b16 v[80:81], v10 offset:2048
    s_waitcnt lgkmcnt(9)
    s_nop 0
    v_mfma_f32_16x16x32_bf16 v[160:163], v[64:67], v[100:103], v[160:163]
    ds_read_b64_tr_b16 v[82:83], v10 offset:2560
    s_waitcnt lgkmcnt(9)
    s_nop 0
    v_mfma_f32_16x16x32_bf16 v[192:195], v[64:67], v[104:107], v[192:195]
    ds_read_b64_tr_b16 v[84:85], v11 offset:2048
    s_waitcnt lgkmcnt(9)
    s_nop 0
    v_mfma_f32_16x16x32_bf16 v[224:227], v[64:67], v[108:111], v[224:227]
    ds_read_b64_tr_b16 v[86:87], v11 offset:2560
    s_waitcnt lgkmcnt(8)
    s_nop 0
    v_mfma_f32_16x16x32_bf16 v[228:231], v[68:71], v[108:111], v[228:231]
    ds_read_b64_tr_b16 v[88:89], v12 offset:2048
    v_mfma_f32_16x16x32_bf16 v[196:199], v[68:71], v[104:107], v[196:199]
    ds_read_b64_tr_b16 v[90:91], v12 offset:2560
    v_mfma_f32_16x16x32_bf16 v[164:167], v[68:71], v[100:103], v[164:167]
    ds_read_b64_tr_b16 v[92:93], v13 offset:2048
    v_mfma_f32_16x16x32_bf16 v[132:135], v[68:71], v[96:99], v[132:135]
    ds_read_b64_tr_b16 v[94:95], v13 offset:2560
    s_waitcnt lgkmcnt(10)
    s_nop 0
    v_mfma_f32_16x16x32_bf16 v[136:139], v[72:75], v[96:99], v[136:139]
    v_mfma_f32_16x16x32_bf16 v[168:171], v[72:75], v[100:103], v[168:171]
    v_mfma_f32_16x16x32_bf16 v[200:203], v[72:75], v[104:107], v[200:203]
    v_mfma_f32_16x16x32_bf16 v[232:235], v[72:75], v[108:111], v[232:235]
    s_waitcnt lgkmcnt(8)
    s_nop 0
    v_mfma_f32_16x16x32_bf16 v[236:239], v[76:79], v[108:111], v[236:239]
    v_mfma_f32_16x16x32_bf16 v[204:207], v[76:79], v[104:107], v[204:207]
    v_mfma_f32_16x16x32_bf16 v[172:175], v[76:79], v[100:103], v[172:175]
    v_mfma_f32_16x16x32_bf16 v[140:143], v[76:79], v[96:99], v[140:143]
    s_waitcnt lgkmcnt(6)
    s_nop 0
    v_mfma_f32_16x16x32_bf16 v[144:147], v[80:83], v[96:99], v[144:147]
    s_waitcnt lgkmcnt(0)
    s_barrier
    ds_read_b128 v[112:115], v5 offset:0
    v_mfma_f32_16x16x32_bf16 v[176:179], v[80:83], v[100:103], v[176:179]
    ds_read_b64_tr_b16 v[64:65], v10 offset:8192
    v_mfma_f32_16x16x32_bf16 v[208:211], v[80:83], v[104:107], v[208:211]
    ds_read_b64_tr_b16 v[66:67], v10 offset:8704
    v_mfma_f32_16x16x32_bf16 v[240:243], v[80:83], v[108:111], v[240:243]
    ds_read_b128 v[116:119], v5 offset:2048
    v_mfma_f32_16x16x32_bf16 v[244:247], v[84:87], v[108:111], v[244:247]
    ds_read_b128 v[120:123], v5 offset:4096
    v_mfma_f32_16x16x32_bf16 v[212:215], v[84:87], v[104:107], v[212:215]
    ds_read_b128 v[124:127], v5 offset:6144
    v_mfma_f32_16x16x32_bf16 v[180:183], v[84:87], v[100:103], v[180:183]
    ds_read_b64_tr_b16 v[68:69], v11 offset:8192
    v_mfma_f32_16x16x32_bf16 v[148:151], v[84:87], v[96:99], v[148:151]
    ds_read_b64_tr_b16 v[70:71], v11 offset:8704
    v_mfma_f32_16x16x32_bf16 v[152:155], v[88:91], v[96:99], v[152:155]
    ds_read_b64_tr_b16 v[72:73], v12 offset:8192
    v_mfma_f32_16x16x32_bf16 v[184:187], v[88:91], v[100:103], v[184:187]
    ds_read_b64_tr_b16 v[74:75], v12 offset:8704
    v_mfma_f32_16x16x32_bf16 v[216:219], v[88:91], v[104:107], v[216:219]
    ds_read_b64_tr_b16 v[76:77], v13 offset:8192
    v_mfma_f32_16x16x32_bf16 v[248:251], v[88:91], v[108:111], v[248:251]
    ds_read_b64_tr_b16 v[78:79], v13 offset:8704
    v_mfma_f32_16x16x32_bf16 v[252:255], v[92:95], v[108:111], v[252:255]
    v_mfma_f32_16x16x32_bf16 v[220:223], v[92:95], v[104:107], v[220:223]
    v_mfma_f32_16x16x32_bf16 v[188:191], v[92:95], v[100:103], v[188:191]
    v_mfma_f32_16x16x32_bf16 v[156:159], v[92:95], v[96:99], v[156:159]
    s_waitcnt lgkmcnt(9)
    s_nop 0
    v_mfma_f32_16x16x32_bf16 v[128:131], v[64:67], v[112:115], v[128:131]
    ds_read_b64_tr_b16 v[80:81], v10 offset:10240
    s_waitcnt lgkmcnt(9)
    s_nop 0
    v_mfma_f32_16x16x32_bf16 v[160:163], v[64:67], v[116:119], v[160:163]
    ds_read_b64_tr_b16 v[82:83], v10 offset:10752
    s_waitcnt lgkmcnt(9)
    s_nop 0
    v_mfma_f32_16x16x32_bf16 v[192:195], v[64:67], v[120:123], v[192:195]
    ds_read_b64_tr_b16 v[84:85], v11 offset:10240
    s_waitcnt lgkmcnt(9)
    s_nop 0
    v_mfma_f32_16x16x32_bf16 v[224:227], v[64:67], v[124:127], v[224:227]
    ds_read_b64_tr_b16 v[86:87], v11 offset:10752
    s_waitcnt lgkmcnt(8)
    s_nop 0
    v_mfma_f32_16x16x32_bf16 v[228:231], v[68:71], v[124:127], v[228:231]
    ds_read_b64_tr_b16 v[88:89], v12 offset:10240
    v_mfma_f32_16x16x32_bf16 v[196:199], v[68:71], v[120:123], v[196:199]
    ds_read_b64_tr_b16 v[90:91], v12 offset:10752
    v_mfma_f32_16x16x32_bf16 v[164:167], v[68:71], v[116:119], v[164:167]
    ds_read_b64_tr_b16 v[92:93], v13 offset:10240
    v_mfma_f32_16x16x32_bf16 v[132:135], v[68:71], v[112:115], v[132:135]
    ds_read_b64_tr_b16 v[94:95], v13 offset:10752
    s_waitcnt lgkmcnt(10)
    s_nop 0
    v_mfma_f32_16x16x32_bf16 v[136:139], v[72:75], v[112:115], v[136:139]
    v_mfma_f32_16x16x32_bf16 v[168:171], v[72:75], v[116:119], v[168:171]
    v_mfma_f32_16x16x32_bf16 v[200:203], v[72:75], v[120:123], v[200:203]
    v_mfma_f32_16x16x32_bf16 v[232:235], v[72:75], v[124:127], v[232:235]
    s_waitcnt lgkmcnt(8)
    s_nop 0
    v_mfma_f32_16x16x32_bf16 v[236:239], v[76:79], v[124:127], v[236:239]
    v_mfma_f32_16x16x32_bf16 v[204:207], v[76:79], v[120:123], v[204:207]
    v_mfma_f32_16x16x32_bf16 v[172:175], v[76:79], v[116:119], v[172:175]
    v_mfma_f32_16x16x32_bf16 v[140:143], v[76:79], v[112:115], v[140:143]
    s_waitcnt lgkmcnt(6)
    s_nop 0
    v_mfma_f32_16x16x32_bf16 v[144:147], v[80:83], v[112:115], v[144:147]
    s_waitcnt lgkmcnt(0)
    s_barrier
    ds_read_b128 v[96:99], v2 offset:0
    v_mfma_f32_16x16x32_bf16 v[176:179], v[80:83], v[116:119], v[176:179]
    ds_read_b64_tr_b16 v[64:65], v10 offset:16384
    v_mfma_f32_16x16x32_bf16 v[208:211], v[80:83], v[120:123], v[208:211]
    ds_read_b64_tr_b16 v[66:67], v10 offset:16896
    v_mfma_f32_16x16x32_bf16 v[240:243], v[80:83], v[124:127], v[240:243]
    ds_read_b128 v[100:103], v2 offset:2048
    v_mfma_f32_16x16x32_bf16 v[244:247], v[84:87], v[124:127], v[244:247]
    ds_read_b128 v[104:107], v2 offset:4096
    v_mfma_f32_16x16x32_bf16 v[212:215], v[84:87], v[120:123], v[212:215]
    ds_read_b128 v[108:111], v2 offset:6144
    v_mfma_f32_16x16x32_bf16 v[180:183], v[84:87], v[116:119], v[180:183]
    ds_read_b64_tr_b16 v[68:69], v11 offset:16384
    v_mfma_f32_16x16x32_bf16 v[148:151], v[84:87], v[112:115], v[148:151]
    ds_read_b64_tr_b16 v[70:71], v11 offset:16896
    v_mfma_f32_16x16x32_bf16 v[152:155], v[88:91], v[112:115], v[152:155]
    ds_read_b64_tr_b16 v[72:73], v12 offset:16384
    v_mfma_f32_16x16x32_bf16 v[184:187], v[88:91], v[116:119], v[184:187]
    ds_read_b64_tr_b16 v[74:75], v12 offset:16896
    v_mfma_f32_16x16x32_bf16 v[216:219], v[88:91], v[120:123], v[216:219]
    ds_read_b64_tr_b16 v[76:77], v13 offset:16384
    v_mfma_f32_16x16x32_bf16 v[248:251], v[88:91], v[124:127], v[248:251]
    ds_read_b64_tr_b16 v[78:79], v13 offset:16896
    v_mfma_f32_16x16x32_bf16 v[252:255], v[92:95], v[124:127], v[252:255]
    v_mfma_f32_16x16x32_bf16 v[220:223], v[92:95], v[120:123], v[220:223]
    v_mfma_f32_16x16x32_bf16 v[188:191], v[92:95], v[116:119], v[188:191]
    v_mfma_f32_16x16x32_bf16 v[156:159], v[92:95], v[112:115], v[156:159]
    s_waitcnt lgkmcnt(9)
    s_nop 0
    v_mfma_f32_16x16x32_bf16 v[128:131], v[64:67], v[96:99], v[128:131]
    ds_read_b64_tr_b16 v[80:81], v10 offset:18432
    s_waitcnt lgkmcnt(9)
    s_nop 0
    v_mfma_f32_16x16x32_bf16 v[160:163], v[64:67], v[100:103], v[160:163]
    ds_read_b64_tr_b16 v[82:83], v10 offset:18944
    s_waitcnt lgkmcnt(9)
    s_nop 0
    v_mfma_f32_16x16x32_bf16 v[192:195], v[64:67], v[104:107], v[192:195]
    ds_read_b64_tr_b16 v[84:85], v11 offset:18432
    s_waitcnt lgkmcnt(9)
    s_nop 0
    v_mfma_f32_16x16x32_bf16 v[224:227], v[64:67], v[108:111], v[224:227]
    ds_read_b64_tr_b16 v[86:87], v11 offset:18944
    s_waitcnt lgkmcnt(8)
    s_nop 0
    v_mfma_f32_16x16x32_bf16 v[228:231], v[68:71], v[108:111], v[228:231]
    ds_read_b64_tr_b16 v[88:89], v12 offset:18432
    v_mfma_f32_16x16x32_bf16 v[196:199], v[68:71], v[104:107], v[196:199]
    ds_read_b64_tr_b16 v[90:91], v12 offset:18944
    v_mfma_f32_16x16x32_bf16 v[164:167], v[68:71], v[100:103], v[164:167]
    ds_read_b64_tr_b16 v[92:93], v13 offset:18432
    v_mfma_f32_16x16x32_bf16 v[132:135], v[68:71], v[96:99], v[132:135]
    ds_read_b64_tr_b16 v[94:95], v13 offset:18944
    s_waitcnt lgkmcnt(10)
    s_nop 0
    v_mfma_f32_16x16x32_bf16 v[136:139], v[72:75], v[96:99], v[136:139]
    v_mfma_f32_16x16x32_bf16 v[168:171], v[72:75], v[100:103], v[168:171]
    v_mfma_f32_16x16x32_bf16 v[200:203], v[72:75], v[104:107], v[200:203]
    v_mfma_f32_16x16x32_bf16 v[232:235], v[72:75], v[108:111], v[232:235]
    s_waitcnt lgkmcnt(8)
    s_nop 0
    v_mfma_f32_16x16x32_bf16 v[236:239], v[76:79], v[108:111], v[236:239]
    v_mfma_f32_16x16x32_bf16 v[204:207], v[76:79], v[104:107], v[204:207]
    v_mfma_f32_16x16x32_bf16 v[172:175], v[76:79], v[100:103], v[172:175]
    v_mfma_f32_16x16x32_bf16 v[140:143], v[76:79], v[96:99], v[140:143]
    s_waitcnt lgkmcnt(6)
    s_nop 0
    v_mfma_f32_16x16x32_bf16 v[144:147], v[80:83], v[96:99], v[144:147]
    s_waitcnt lgkmcnt(0)
    s_barrier
    ds_read_b128 v[112:115], v3 offset:0
    v_mfma_f32_16x16x32_bf16 v[176:179], v[80:83], v[100:103], v[176:179]
    ds_read_b64_tr_b16 v[64:65], v10 offset:24576
    v_mfma_f32_16x16x32_bf16 v[208:211], v[80:83], v[104:107], v[208:211]
    ds_read_b64_tr_b16 v[66:67], v10 offset:25088
    v_mfma_f32_16x16x32_bf16 v[240:243], v[80:83], v[108:111], v[240:243]
    ds_read_b128 v[116:119], v3 offset:2048
    v_mfma_f32_16x16x32_bf16 v[244:247], v[84:87], v[108:111], v[244:247]
    ds_read_b128 v[120:123], v3 offset:4096
    v_mfma_f32_16x16x32_bf16 v[212:215], v[84:87], v[104:107], v[212:215]
    ds_read_b128 v[124:127], v3 offset:6144
    v_mfma_f32_16x16x32_bf16 v[180:183], v[84:87], v[100:103], v[180:183]
    ds_read_b64_tr_b16 v[68:69], v11 offset:24576
    v_mfma_f32_16x16x32_bf16 v[148:151], v[84:87], v[96:99], v[148:151]
    ds_read_b64_tr_b16 v[70:71], v11 offset:25088
    v_mfma_f32_16x16x32_bf16 v[152:155], v[88:91], v[96:99], v[152:155]
    ds_read_b64_tr_b16 v[72:73], v12 offset:24576
    v_mfma_f32_16x16x32_bf16 v[184:187], v[88:91], v[100:103], v[184:187]
    ds_read_b64_tr_b16 v[74:75], v12 offset:25088
    v_mfma_f32_16x16x32_bf16 v[216:219], v[88:91], v[104:107], v[216:219]
    ds_read_b64_tr_b16 v[76:77], v13 offset:24576
    v_mfma_f32_16x16x32_bf16 v[248:251], v[88:91], v[108:111], v[248:251]
    ds_read_b64_tr_b16 v[78:79], v13 offset:25088
    v_mfma_f32_16x16x32_bf16 v[252:255], v[92:95], v[108:111], v[252:255]
    v_mfma_f32_16x16x32_bf16 v[220:223], v[92:95], v[104:107], v[220:223]
    v_mfma_f32_16x16x32_bf16 v[188:191], v[92:95], v[100:103], v[188:191]
    v_mfma_f32_16x16x32_bf16 v[156:159], v[92:95], v[96:99], v[156:159]
    s_waitcnt lgkmcnt(9)
    s_nop 0
    v_mfma_f32_16x16x32_bf16 v[128:131], v[64:67], v[112:115], v[128:131]
    ds_read_b64_tr_b16 v[80:81], v10 offset:26624
    s_waitcnt lgkmcnt(9)
    s_nop 0
    v_mfma_f32_16x16x32_bf16 v[160:163], v[64:67], v[116:119], v[160:163]
    ds_read_b64_tr_b16 v[82:83], v10 offset:27136
    s_waitcnt lgkmcnt(9)
    s_nop 0
    v_mfma_f32_16x16x32_bf16 v[192:195], v[64:67], v[120:123], v[192:195]
    ds_read_b64_tr_b16 v[84:85], v11 offset:26624
    s_waitcnt lgkmcnt(9)
    s_nop 0
    v_mfma_f32_16x16x32_bf16 v[224:227], v[64:67], v[124:127], v[224:227]
    ds_read_b64_tr_b16 v[86:87], v11 offset:27136
    s_waitcnt lgkmcnt(8)
    s_nop 0
    v_mfma_f32_16x16x32_bf16 v[228:231], v[68:71], v[124:127], v[228:231]
    ds_read_b64_tr_b16 v[88:89], v12 offset:26624
    v_mfma_f32_16x16x32_bf16 v[196:199], v[68:71], v[120:123], v[196:199]
    ds_read_b64_tr_b16 v[90:91], v12 offset:27136
    v_mfma_f32_16x16x32_bf16 v[164:167], v[68:71], v[116:119], v[164:167]
    ds_read_b64_tr_b16 v[92:93], v13 offset:26624
    v_mfma_f32_16x16x32_bf16 v[132:135], v[68:71], v[112:115], v[132:135]
    ds_read_b64_tr_b16 v[94:95], v13 offset:27136
    s_waitcnt lgkmcnt(10)
    s_nop 0
    v_mfma_f32_16x16x32_bf16 v[136:139], v[72:75], v[112:115], v[136:139]
    v_mfma_f32_16x16x32_bf16 v[168:171], v[72:75], v[116:119], v[168:171]
    v_mfma_f32_16x16x32_bf16 v[200:203], v[72:75], v[120:123], v[200:203]
    v_mfma_f32_16x16x32_bf16 v[232:235], v[72:75], v[124:127], v[232:235]
    s_waitcnt lgkmcnt(8)
    s_nop 0
    v_mfma_f32_16x16x32_bf16 v[236:239], v[76:79], v[124:127], v[236:239]
    v_mfma_f32_16x16x32_bf16 v[204:207], v[76:79], v[120:123], v[204:207]
    v_mfma_f32_16x16x32_bf16 v[172:175], v[76:79], v[116:119], v[172:175]
    v_mfma_f32_16x16x32_bf16 v[140:143], v[76:79], v[112:115], v[140:143]
    s_waitcnt lgkmcnt(6)
    s_nop 0
    v_mfma_f32_16x16x32_bf16 v[144:147], v[80:83], v[112:115], v[144:147]
    s_waitcnt lgkmcnt(0)
    s_barrier
    ds_read_b128 v[96:99], v2 offset:32768
    v_mfma_f32_16x16x32_bf16 v[176:179], v[80:83], v[116:119], v[176:179]
    ds_read_b64_tr_b16 v[64:65], v10 offset:0
    v_mfma_f32_16x16x32_bf16 v[208:211], v[80:83], v[120:123], v[208:211]
    ds_read_b64_tr_b16 v[66:67], v10 offset:512
    v_mfma_f32_16x16x32_bf16 v[240:243], v[80:83], v[124:127], v[240:243]
    ds_read_b128 v[100:103], v2 offset:34816
    v_mfma_f32_16x16x32_bf16 v[244:247], v[84:87], v[124:127], v[244:247]
    ds_read_b128 v[104:107], v2 offset:36864
    v_mfma_f32_16x16x32_bf16 v[212:215], v[84:87], v[120:123], v[212:215]
    ds_read_b128 v[108:111], v2 offset:38912
    v_mfma_f32_16x16x32_bf16 v[180:183], v[84:87], v[116:119], v[180:183]
    ds_read_b64_tr_b16 v[68:69], v11 offset:0
    v_mfma_f32_16x16x32_bf16 v[148:151], v[84:87], v[112:115], v[148:151]
    ds_read_b64_tr_b16 v[70:71], v11 offset:512
    v_mfma_f32_16x16x32_bf16 v[152:155], v[88:91], v[112:115], v[152:155]
    ds_read_b64_tr_b16 v[72:73], v12 offset:0
    v_mfma_f32_16x16x32_bf16 v[184:187], v[88:91], v[116:119], v[184:187]
    ds_read_b64_tr_b16 v[74:75], v12 offset:512
    v_mfma_f32_16x16x32_bf16 v[216:219], v[88:91], v[120:123], v[216:219]
    ds_read_b64_tr_b16 v[76:77], v13 offset:0
    v_mfma_f32_16x16x32_bf16 v[248:251], v[88:91], v[124:127], v[248:251]
    ds_read_b64_tr_b16 v[78:79], v13 offset:512
    v_mfma_f32_16x16x32_bf16 v[252:255], v[92:95], v[124:127], v[252:255]
    v_mfma_f32_16x16x32_bf16 v[220:223], v[92:95], v[120:123], v[220:223]
    v_mfma_f32_16x16x32_bf16 v[188:191], v[92:95], v[116:119], v[188:191]
    v_mfma_f32_16x16x32_bf16 v[156:159], v[92:95], v[112:115], v[156:159]
    s_waitcnt lgkmcnt(9)
    s_nop 0
    v_mfma_f32_16x16x32_bf16 v[128:131], v[64:67], v[96:99], v[128:131]
    ds_read_b64_tr_b16 v[80:81], v10 offset:2048
    s_waitcnt lgkmcnt(9)
    s_nop 0
    v_mfma_f32_16x16x32_bf16 v[160:163], v[64:67], v[100:103], v[160:163]
    ds_read_b64_tr_b16 v[82:83], v10 offset:2560
    s_waitcnt lgkmcnt(9)
    s_nop 0
    v_mfma_f32_16x16x32_bf16 v[192:195], v[64:67], v[104:107], v[192:195]
    ds_read_b64_tr_b16 v[84:85], v11 offset:2048
    s_waitcnt lgkmcnt(9)
    s_nop 0
    v_mfma_f32_16x16x32_bf16 v[224:227], v[64:67], v[108:111], v[224:227]
    ds_read_b64_tr_b16 v[86:87], v11 offset:2560
    s_waitcnt lgkmcnt(8)
.L_pp0:
    s_cbranch_execz .L_pb0
    v_mfma_f32_16x16x32_bf16 v[228:231], v[68:71], v[108:111], v[228:231]
    ds_read_b64_tr_b16 v[88:89], v12 offset:2048
    v_mfma_f32_16x16x32_bf16 v[196:199], v[68:71], v[104:107], v[196:199]
    ds_read_b64_tr_b16 v[90:91], v12 offset:2560
    v_mfma_f32_16x16x32_bf16 v[164:167], v[68:71], v[100:103], v[164:167]
    ds_read_b64_tr_b16 v[92:93], v13 offset:2048
    v_mfma_f32_16x16x32_bf16 v[132:135], v[68:71], v[96:99], v[132:135]
    ds_read_b64_tr_b16 v[94:95], v13 offset:2560
    s_waitcnt lgkmcnt(10)
    s_nop 0
    v_mfma_f32_16x16x32_bf16 v[136:139], v[72:75], v[96:99], v[136:139]
    v_mfma_f32_16x16x32_bf16 v[168:171], v[72:75], v[100:103], v[168:171]
    v_mfma_f32_16x16x32_bf16 v[200:203], v[72:75], v[104:107], v[200:203]
    v_mfma_f32_16x16x32_bf16 v[232:235], v[72:75], v[108:111], v[232:235]
    s_waitcnt lgkmcnt(8)
    s_nop 0
    v_mfma_f32_16x16x32_bf16 v[236:239], v[76:79], v[108:111], v[236:239]
    v_mfma_f32_16x16x32_bf16 v[204:207], v[76:79], v[104:107], v[204:207]
    v_mfma_f32_16x16x32_bf16 v[172:175], v[76:79], v[100:103], v[172:175]
    v_mfma_f32_16x16x32_bf16 v[140:143], v[76:79], v[96:99], v[140:143]
    s_waitcnt lgkmcnt(6)
    s_nop 0
    v_mfma_f32_16x16x32_bf16 v[144:147], v[80:83], v[96:99], v[144:147]
    s_waitcnt lgkmcnt(0)
    s_barrier
    ds_read_b128 v[112:115], v3 offset:32768
    v_mfma_f32_16x16x32_bf16 v[176:179], v[80:83], v[100:103], v[176:179]
    ds_read_b64_tr_b16 v[64:65], v10 offset:8192
    v_mfma_f32_16x16x32_bf16 v[208:211], v[80:83], v[104:107], v[208:211]
    ds_read_b64_tr_b16 v[66:67], v10 offset:8704
    v_mfma_f32_16x16x32_bf16 v[240:243], v[80:83], v[108:111], v[240:243]
    ds_read_b128 v[116:119], v3 offset:34816
    v_mfma_f32_16x16x32_bf16 v[244:247], v[84:87], v[108:111], v[244:247]
    ds_read_b128 v[120:123], v3 offset:36864
    v_mfma_f32_16x16x32_bf16 v[212:215], v[84:87], v[104:107], v[212:215]
    ds_read_b128 v[124:127], v3 offset:38912
    v_mfma_f32_16x16x32_bf16 v[180:183], v[84:87], v[100:103], v[180:183]
    ds_read_b64_tr_b16 v[68:69], v11 offset:8192
    v_mfma_f32_16x16x32_bf16 v[148:151], v[84:87], v[96:99], v[148:151]
    ds_read_b64_tr_b16 v[70:71], v11 offset:8704
    v_mfma_f32_16x16x32_bf16 v[152:155], v[88:91], v[96:99], v[152:155]
    ds_read_b64_tr_b16 v[72:73], v12 offset:8192
    v_mfma_f32_16x16x32_bf16 v[184:187], v[88:91], v[100:103], v[184:187]
    ds_read_b64_tr_b16 v[74:75], v12 offset:8704
    v_mfma_f32_16x16x32_bf16 v[216:219], v[88:91], v[104:107], v[216:219]
    ds_read_b64_tr_b16 v[76:77], v13 offset:8192
    v_mfma_f32_16x16x32_bf16 v[248:251], v[88:91], v[108:111], v[248:251]
    ds_read_b64_tr_b16 v[78:79], v13 offset:8704
    v_mfma_f32_16x16x32_bf16 v[252:255], v[92:95], v[108:111], v[252:255]
    v_mfma_f32_16x16x32_bf16 v[220:223], v[92:95], v[104:107], v[220:223]
    v_mfma_f32_16x16x32_bf16 v[188:191], v[92:95], v[100:103], v[188:191]
    v_mfma_f32_16x16x32_bf16 v[156:159], v[92:95], v[96:99], v[156:159]
    s_waitcnt lgkmcnt(9)
    s_nop 0
    v_mfma_f32_16x16x32_bf16 v[128:131], v[64:67], v[112:115], v[128:131]
    ds_read_b64_tr_b16 v[80:81], v10 offset:10240
    s_waitcnt lgkmcnt(9)
    s_nop 0
    v_mfma_f32_16x16x32_bf16 v[160:163], v[64:67], v[116:119], v[160:163]
    ds_read_b64_tr_b16 v[82:83], v10 offset:10752
    s_waitcnt lgkmcnt(9)
    s_nop 0
    v_mfma_f32_16x16x32_bf16 v[192:195], v[64:67], v[120:123], v[192:195]
    ds_read_b64_tr_b16 v[84:85], v11 offset:10240
    s_waitcnt lgkmcnt(9)
    s_nop 0
    v_mfma_f32_16x16x32_bf16 v[224:227], v[64:67], v[124:127], v[224:227]
    ds_read_b64_tr_b16 v[86:87], v11 offset:10752
    s_waitcnt lgkmcnt(8)
    s_nop 0
    v_mfma_f32_16x16x32_bf16 v[228:231], v[68:71], v[124:127], v[228:231]
    ds_read_b64_tr_b16 v[88:89], v12 offset:10240
    v_mfma_f32_16x16x32_bf16 v[196:199], v[68:71], v[120:123], v[196:199]
    ds_read_b64_tr_b16 v[90:91], v12 offset:10752
    v_mfma_f32_16x16x32_bf16 v[164:167], v[68:71], v[116:119], v[164:167]
    ds_read_b64_tr_b16 v[92:93], v13 offset:10240
    v_mfma_f32_16x16x32_bf16 v[132:135], v[68:71], v[112:115], v[132:135]
    ds_read_b64_tr_b16 v[94:95], v13 offset:10752
    s_waitcnt lgkmcnt(10)
    s_nop 0
    v_mfma_f32_16x16x32_bf16 v[136:139], v[72:75], v[112:115], v[136:139]
    v_mfma_f32_16x16x32_bf16 v[168:171], v[72:75], v[116:119], v[168:171]
    v_mfma_f32_16x16x32_bf16 v[200:203], v[72:75], v[120:123], v[200:203]
    v_mfma_f32_16x16x32_bf16 v[232:235], v[72:75], v[124:127], v[232:235]
    s_waitcnt lgkmcnt(8)
    s_nop 0
    v_mfma_f32_16x16x32_bf16 v[236:239], v[76:79], v[124:127], v[236:239]
    v_mfma_f32_16x16x32_bf16 v[204:207], v[76:79], v[120:123], v[204:207]
    v_mfma_f32_16x16x32_bf16 v[172:175], v[76:79], v[116:119], v[172:175]
    v_mfma_f32_16x16x32_bf16 v[140:143], v[76:79], v[112:115], v[140:143]
    s_waitcnt lgkmcnt(6)
    s_nop 0
    v_mfma_f32_16x16x32_bf16 v[144:147], v[80:83], v[112:115], v[144:147]
    s_waitcnt lgkmcnt(0)
    s_barrier
    ds_read_b128 v[96:99], v4 offset:0
    v_mfma_f32_16x16x32_bf16 v[176:179], v[80:83], v[116:119], v[176:179]
    ds_read_b64_tr_b16 v[64:65], v10 offset:16384
    v_mfma_f32_16x16x32_bf16 v[208:211], v[80:83], v[120:123], v[208:211]
    ds_read_b64_tr_b16 v[66:67], v10 offset:16896
    v_mfma_f32_16x16x32_bf16 v[240:243], v[80:83], v[124:127], v[240:243]
    ds_read_b128 v[100:103], v4 offset:2048
    v_mfma_f32_16x16x32_bf16 v[244:247], v[84:87], v[124:127], v[244:247]
    ds_read_b128 v[104:107], v4 offset:4096
    v_mfma_f32_16x16x32_bf16 v[212:215], v[84:87], v[120:123], v[212:215]
    ds_read_b128 v[108:111], v4 offset:6144
    v_mfma_f32_16x16x32_bf16 v[180:183], v[84:87], v[116:119], v[180:183]
    ds_read_b64_tr_b16 v[68:69], v11 offset:16384
    v_mfma_f32_16x16x32_bf16 v[148:151], v[84:87], v[112:115], v[148:151]
    ds_read_b64_tr_b16 v[70:71], v11 offset:16896
    v_mfma_f32_16x16x32_bf16 v[152:155], v[88:91], v[112:115], v[152:155]
    ds_read_b64_tr_b16 v[72:73], v12 offset:16384
    v_mfma_f32_16x16x32_bf16 v[184:187], v[88:91], v[116:119], v[184:187]
    ds_read_b64_tr_b16 v[74:75], v12 offset:16896
    v_mfma_f32_16x16x32_bf16 v[216:219], v[88:91], v[120:123], v[216:219]
    ds_read_b64_tr_b16 v[76:77], v13 offset:16384
    v_mfma_f32_16x16x32_bf16 v[248:251], v[88:91], v[124:127], v[248:251]
    ds_read_b64_tr_b16 v[78:79], v13 offset:16896
    v_mfma_f32_16x16x32_bf16 v[252:255], v[92:95], v[124:127], v[252:255]
    v_mfma_f32_16x16x32_bf16 v[220:223], v[92:95], v[120:123], v[220:223]
    v_mfma_f32_16x16x32_bf16 v[188:191], v[92:95], v[116:119], v[188:191]
    v_mfma_f32_16x16x32_bf16 v[156:159], v[92:95], v[112:115], v[156:159]
    s_waitcnt lgkmcnt(9)
    s_nop 0
    v_mfma_f32_16x16x32_bf16 v[128:131], v[64:67], v[96:99], v[128:131]
    ds_read_b64_tr_b16 v[80:81], v10 offset:18432
    s_waitcnt lgkmcnt(9)
    s_nop 0
    v_mfma_f32_16x16x32_bf16 v[160:163], v[64:67], v[100:103], v[160:163]
    ds_read_b64_tr_b16 v[82:83], v10 offset:18944
    s_waitcnt lgkmcnt(9)
    s_nop 0
    v_mfma_f32_16x16x32_bf16 v[192:195], v[64:67], v[104:107], v[192:195]
    ds_read_b64_tr_b16 v[84:85], v11 offset:18432
    s_waitcnt lgkmcnt(9)
    s_nop 0
    v_mfma_f32_16x16x32_bf16 v[224:227], v[64:67], v[108:111], v[224:227]
    ds_read_b64_tr_b16 v[86:87], v11 offset:18944
    s_waitcnt lgkmcnt(8)
    s_nop 0
    v_mfma_f32_16x16x32_bf16 v[228:231], v[68:71], v[108:111], v[228:231]
    ds_read_b64_tr_b16 v[88:89], v12 offset:18432
    v_mfma_f32_16x16x32_bf16 v[196:199], v[68:71], v[104:107], v[196:199]
    ds_read_b64_tr_b16 v[90:91], v12 offset:18944
    v_mfma_f32_16x16x32_bf16 v[164:167], v[68:71], v[100:103], v[164:167]
    ds_read_b64_tr_b16 v[92:93], v13 offset:18432
    v_mfma_f32_16x16x32_bf16 v[132:135], v[68:71], v[96:99], v[132:135]
    ds_read_b64_tr_b16 v[94:95], v13 offset:18944
    s_waitcnt lgkmcnt(10)
    s_nop 0
    v_mfma_f32_16x16x32_bf16 v[136:139], v[72:75], v[96:99], v[136:139]
    v_mfma_f32_16x16x32_bf16 v[168:171], v[72:75], v[100:103], v[168:171]
    v_mfma_f32_16x16x32_bf16 v[200:203], v[72:75], v[104:107], v[200:203]
    v_mfma_f32_16x16x32_bf16 v[232:235], v[72:75], v[108:111], v[232:235]
    s_waitcnt lgkmcnt(8)
    s_nop 0
    v_mfma_f32_16x16x32_bf16 v[236:239], v[76:79], v[108:111], v[236:239]
    v_mfma_f32_16x16x32_bf16 v[204:207], v[76:79], v[104:107], v[204:207]
    v_mfma_f32_16x16x32_bf16 v[172:175], v[76:79], v[100:103], v[172:175]
    v_mfma_f32_16x16x32_bf16 v[140:143], v[76:79], v[96:99], v[140:143]
    s_waitcnt lgkmcnt(6)
    s_nop 0
    v_mfma_f32_16x16x32_bf16 v[144:147], v[80:83], v[96:99], v[144:147]
    s_waitcnt lgkmcnt(0)
    s_barrier
    ds_read_b128 v[112:115], v5 offset:0
    v_mfma_f32_16x16x32_bf16 v[176:179], v[80:83], v[100:103], v[176:179]
    ds_read_b64_tr_b16 v[64:65], v10 offset:24576
    v_mfma_f32_16x16x32_bf16 v[208:211], v[80:83], v[104:107], v[208:211]
    ds_read_b64_tr_b16 v[66:67], v10 offset:25088
    v_mfma_f32_16x16x32_bf16 v[240:243], v[80:83], v[108:111], v[240:243]
    ds_read_b128 v[116:119], v5 offset:2048
    v_mfma_f32_16x16x32_bf16 v[244:247], v[84:87], v[108:111], v[244:247]
    ds_read_b128 v[120:123], v5 offset:4096
    v_mfma_f32_16x16x32_bf16 v[212:215], v[84:87], v[104:107], v[212:215]
    ds_read_b128 v[124:127], v5 offset:6144
    v_mfma_f32_16x16x32_bf16 v[180:183], v[84:87], v[100:103], v[180:183]
    ds_read_b64_tr_b16 v[68:69], v11 offset:24576
    v_mfma_f32_16x16x32_bf16 v[148:151], v[84:87], v[96:99], v[148:151]
    ds_read_b64_tr_b16 v[70:71], v11 offset:25088
    v_mfma_f32_16x16x32_bf16 v[152:155], v[88:91], v[96:99], v[152:155]
    ds_read_b64_tr_b16 v[72:73], v12 offset:24576
    v_mfma_f32_16x16x32_bf16 v[184:187], v[88:91], v[100:103], v[184:187]
    ds_read_b64_tr_b16 v[74:75], v12 offset:25088
    v_mfma_f32_16x16x32_bf16 v[216:219], v[88:91], v[104:107], v[216:219]
    ds_read_b64_tr_b16 v[76:77], v13 offset:24576
    v_mfma_f32_16x16x32_bf16 v[248:251], v[88:91], v[108:111], v[248:251]
    ds_read_b64_tr_b16 v[78:79], v13 offset:25088
    v_mfma_f32_16x16x32_bf16 v[252:255], v[92:95], v[108:111], v[252:255]
    v_mfma_f32_16x16x32_bf16 v[220:223], v[92:95], v[104:107], v[220:223]
    v_mfma_f32_16x16x32_bf16 v[188:191], v[92:95], v[100:103], v[188:191]
    v_mfma_f32_16x16x32_bf16 v[156:159], v[92:95], v[96:99], v[156:159]
    s_waitcnt lgkmcnt(9)
    s_nop 0
    v_mfma_f32_16x16x32_bf16 v[128:131], v[64:67], v[112:115], v[128:131]
    ds_read_b64_tr_b16 v[80:81], v10 offset:26624
    s_waitcnt lgkmcnt(9)
    s_nop 0
    v_mfma_f32_16x16x32_bf16 v[160:163], v[64:67], v[116:119], v[160:163]
    ds_read_b64_tr_b16 v[82:83], v10 offset:27136
    s_waitcnt lgkmcnt(9)
    s_nop 0
    v_mfma_f32_16x16x32_bf16 v[192:195], v[64:67], v[120:123], v[192:195]
    ds_read_b64_tr_b16 v[84:85], v11 offset:26624
    s_waitcnt lgkmcnt(9)
    s_nop 0
    v_mfma_f32_16x16x32_bf16 v[224:227], v[64:67], v[124:127], v[224:227]
    ds_read_b64_tr_b16 v[86:87], v11 offset:27136
    s_waitcnt lgkmcnt(8)
    s_nop 0
    v_mfma_f32_16x16x32_bf16 v[228:231], v[68:71], v[124:127], v[228:231]
    ds_read_b64_tr_b16 v[88:89], v12 offset:26624
    v_mfma_f32_16x16x32_bf16 v[196:199], v[68:71], v[120:123], v[196:199]
    ds_read_b64_tr_b16 v[90:91], v12 offset:27136
    v_mfma_f32_16x16x32_bf16 v[164:167], v[68:71], v[116:119], v[164:167]
    ds_read_b64_tr_b16 v[92:93], v13 offset:26624
    v_mfma_f32_16x16x32_bf16 v[132:135], v[68:71], v[112:115], v[132:135]
    ds_read_b64_tr_b16 v[94:95], v13 offset:27136
    s_waitcnt lgkmcnt(10)
    s_nop 0
    v_mfma_f32_16x16x32_bf16 v[136:139], v[72:75], v[112:115], v[136:139]
    v_mfma_f32_16x16x32_bf16 v[168:171], v[72:75], v[116:119], v[168:171]
    v_mfma_f32_16x16x32_bf16 v[200:203], v[72:75], v[120:123], v[200:203]
    v_mfma_f32_16x16x32_bf16 v[232:235], v[72:75], v[124:127], v[232:235]
    s_waitcnt lgkmcnt(8)
    s_nop 0
    v_mfma_f32_16x16x32_bf16 v[236:239], v[76:79], v[124:127], v[236:239]
    v_mfma_f32_16x16x32_bf16 v[204:207], v[76:79], v[120:123], v[204:207]
    v_mfma_f32_16x16x32_bf16 v[172:175], v[76:79], v[116:119], v[172:175]
    v_mfma_f32_16x16x32_bf16 v[140:143], v[76:79], v[112:115], v[140:143]
    s_waitcnt lgkmcnt(6)
    s_nop 0
    v_mfma_f32_16x16x32_bf16 v[144:147], v[80:83], v[112:115], v[144:147]
    s_waitcnt lgkmcnt(0)
    s_barrier
    ds_read_b128 v[96:99], v2 offset:0
    v_mfma_f32_16x16x32_bf16 v[176:179], v[80:83], v[116:119], v[176:179]
    ds_read_b64_tr_b16 v[64:65], v10 offset:0
    v_mfma_f32_16x16x32_bf16 v[208:211], v[80:83], v[120:123], v[208:211]
    ds_read_b64_tr_b16 v[66:67], v10 offset:512
    v_mfma_f32_16x16x32_bf16 v[240:243], v[80:83], v[124:127], v[240:243]
    ds_read_b128 v[100:103], v2 offset:2048
    v_mfma_f32_16x16x32_bf16 v[244:247], v[84:87], v[124:127], v[244:247]
    ds_read_b128 v[104:107], v2 offset:4096
    v_mfma_f32_16x16x32_bf16 v[212:215], v[84:87], v[120:123], v[212:215]
    ds_read_b128 v[108:111], v2 offset:6144
    v_mfma_f32_16x16x32_bf16 v[180:183], v[84:87], v[116:119], v[180:183]
    ds_read_b64_tr_b16 v[68:69], v11 offset:0
    v_mfma_f32_16x16x32_bf16 v[148:151], v[84:87], v[112:115], v[148:151]
    ds_read_b64_tr_b16 v[70:71], v11 offset:512
    v_mfma_f32_16x16x32_bf16 v[152:155], v[88:91], v[112:115], v[152:155]
    ds_read_b64_tr_b16 v[72:73], v12 offset:0
    v_mfma_f32_16x16x32_bf16 v[184:187], v[88:91], v[116:119], v[184:187]
    ds_read_b64_tr_b16 v[74:75], v12 offset:512
    v_mfma_f32_16x16x32_bf16 v[216:219], v[88:91], v[120:123], v[216:219]
    ds_read_b64_tr_b16 v[76:77], v13 offset:0
    v_mfma_f32_16x16x32_bf16 v[248:251], v[88:91], v[124:127], v[248:251]
    ds_read_b64_tr_b16 v[78:79], v13 offset:512
    v_mfma_f32_16x16x32_bf16 v[252:255], v[92:95], v[124:127], v[252:255]
    v_mfma_f32_16x16x32_bf16 v[220:223], v[92:95], v[120:123], v[220:223]
    v_mfma_f32_16x16x32_bf16 v[188:191], v[92:95], v[116:119], v[188:191]
    v_mfma_f32_16x16x32_bf16 v[156:159], v[92:95], v[112:115], v[156:159]
    s_waitcnt lgkmcnt(9)
    s_nop 0
    v_mfma_f32_16x16x32_bf16 v[128:131], v[64:67], v[96:99], v[128:131]
    ds_read_b64_tr_b16 v[80:81], v10 offset:2048
    s_waitcnt lgkmcnt(9)
    s_nop 0
    v_mfma_f32_16x16x32_bf16 v[160:163], v[64:67], v[100:103], v[160:163]
    ds_read_b64_tr_b16 v[82:83], v10 offset:2560
    s_waitcnt lgkmcnt(9)
    s_nop 0
    v_mfma_f32_16x16x32_bf16 v[192:195], v[64:67], v[104:107], v[192:195]
    ds_read_b64_tr_b16 v[84:85], v11 offset:2048
    s_waitcnt lgkmcnt(9)
    s_nop 0
    v_mfma_f32_16x16x32_bf16 v[224:227], v[64:67], v[108:111], v[224:227]
    ds_read_b64_tr_b16 v[86:87], v11 offset:2560
    s_waitcnt lgkmcnt(8)
    s_nop 0
    v_mfma_f32_16x16x32_bf16 v[228:231], v[68:71], v[108:111], v[228:231]
    ds_read_b64_tr_b16 v[88:89], v12 offset:2048
    v_mfma_f32_16x16x32_bf16 v[196:199], v[68:71], v[104:107], v[196:199]
    ds_read_b64_tr_b16 v[90:91], v12 offset:2560
    v_mfma_f32_16x16x32_bf16 v[164:167], v[68:71], v[100:103], v[164:167]
    ds_read_b64_tr_b16 v[92:93], v13 offset:2048
    v_mfma_f32_16x16x32_bf16 v[132:135], v[68:71], v[96:99], v[132:135]
    ds_read_b64_tr_b16 v[94:95], v13 offset:2560
    s_waitcnt lgkmcnt(10)
    s_nop 0
    v_mfma_f32_16x16x32_bf16 v[136:139], v[72:75], v[96:99], v[136:139]
    v_mfma_f32_16x16x32_bf16 v[168:171], v[72:75], v[100:103], v[168:171]
    v_mfma_f32_16x16x32_bf16 v[200:203], v[72:75], v[104:107], v[200:203]
    v_mfma_f32_16x16x32_bf16 v[232:235], v[72:75], v[108:111], v[232:235]
    s_waitcnt lgkmcnt(8)
    s_nop 0
    v_mfma_f32_16x16x32_bf16 v[236:239], v[76:79], v[108:111], v[236:239]
    v_mfma_f32_16x16x32_bf16 v[204:207], v[76:79], v[104:107], v[204:207]
    v_mfma_f32_16x16x32_bf16 v[172:175], v[76:79], v[100:103], v[172:175]
    v_mfma_f32_16x16x32_bf16 v[140:143], v[76:79], v[96:99], v[140:143]
    s_waitcnt lgkmcnt(6)
    s_nop 0
    v_mfma_f32_16x16x32_bf16 v[144:147], v[80:83], v[96:99], v[144:147]
    s_waitcnt lgkmcnt(0)
    s_barrier
    ds_read_b128 v[112:115], v3 offset:0
    v_mfma_f32_16x16x32_bf16 v[176:179], v[80:83], v[100:103], v[176:179]
    ds_read_b64_tr_b16 v[64:65], v10 offset:8192
    v_mfma_f32_16x16x32_bf16 v[208:211], v[80:83], v[104:107], v[208:211]
    ds_read_b64_tr_b16 v[66:67], v10 offset:8704
    v_mfma_f32_16x16x32_bf16 v[240:243], v[80:83], v[108:111], v[240:243]
    ds_read_b128 v[116:119], v3 offset:2048
    v_mfma_f32_16x16x32_bf16 v[244:247], v[84:87], v[108:111], v[244:247]
    ds_read_b128 v[120:123], v3 offset:4096
    v_mfma_f32_16x16x32_bf16 v[212:215], v[84:87], v[104:107], v[212:215]
    ds_read_b128 v[124:127], v3 offset:6144
    v_mfma_f32_16x16x32_bf16 v[180:183], v[84:87], v[100:103], v[180:183]
    ds_read_b64_tr_b16 v[68:69], v11 offset:8192
    v_mfma_f32_16x16x32_bf16 v[148:151], v[84:87], v[96:99], v[148:151]
    ds_read_b64_tr_b16 v[70:71], v11 offset:8704
    v_mfma_f32_16x16x32_bf16 v[152:155], v[88:91], v[96:99], v[152:155]
    ds_read_b64_tr_b16 v[72:73], v12 offset:8192
    v_mfma_f32_16x16x32_bf16 v[184:187], v[88:91], v[100:103], v[184:187]
    ds_read_b64_tr_b16 v[74:75], v12 offset:8704
    v_mfma_f32_16x16x32_bf16 v[216:219], v[88:91], v[104:107], v[216:219]
    ds_read_b64_tr_b16 v[76:77], v13 offset:8192
    v_mfma_f32_16x16x32_bf16 v[248:251], v[88:91], v[108:111], v[248:251]
    ds_read_b64_tr_b16 v[78:79], v13 offset:8704
    v_mfma_f32_16x16x32_bf16 v[252:255], v[92:95], v[108:111], v[252:255]
    v_mfma_f32_16x16x32_bf16 v[220:223], v[92:95], v[104:107], v[220:223]
    v_mfma_f32_16x16x32_bf16 v[188:191], v[92:95], v[100:103], v[188:191]
    v_mfma_f32_16x16x32_bf16 v[156:159], v[92:95], v[96:99], v[156:159]
    s_waitcnt lgkmcnt(9)
    s_nop 0
    v_mfma_f32_16x16x32_bf16 v[128:131], v[64:67], v[112:115], v[128:131]
    ds_read_b64_tr_b16 v[80:81], v10 offset:10240
    s_waitcnt lgkmcnt(9)
    s_nop 0
    v_mfma_f32_16x16x32_bf16 v[160:163], v[64:67], v[116:119], v[160:163]
    ds_read_b64_tr_b16 v[82:83], v10 offset:10752
    s_waitcnt lgkmcnt(9)
    s_nop 0
    v_mfma_f32_16x16x32_bf16 v[192:195], v[64:67], v[120:123], v[192:195]
    ds_read_b64_tr_b16 v[84:85], v11 offset:10240
    s_waitcnt lgkmcnt(9)
    s_nop 0
    v_mfma_f32_16x16x32_bf16 v[224:227], v[64:67], v[124:127], v[224:227]
    ds_read_b64_tr_b16 v[86:87], v11 offset:10752
    s_waitcnt lgkmcnt(8)
    s_nop 0
    v_mfma_f32_16x16x32_bf16 v[228:231], v[68:71], v[124:127], v[228:231]
    ds_read_b64_tr_b16 v[88:89], v12 offset:10240
    v_mfma_f32_16x16x32_bf16 v[196:199], v[68:71], v[120:123], v[196:199]
    ds_read_b64_tr_b16 v[90:91], v12 offset:10752
    v_mfma_f32_16x16x32_bf16 v[164:167], v[68:71], v[116:119], v[164:167]
    ds_read_b64_tr_b16 v[92:93], v13 offset:10240
    v_mfma_f32_16x16x32_bf16 v[132:135], v[68:71], v[112:115], v[132:135]
    ds_read_b64_tr_b16 v[94:95], v13 offset:10752
    s_waitcnt lgkmcnt(10)
    s_nop 0
    v_mfma_f32_16x16x32_bf16 v[136:139], v[72:75], v[112:115], v[136:139]
    v_mfma_f32_16x16x32_bf16 v[168:171], v[72:75], v[116:119], v[168:171]
    v_mfma_f32_16x16x32_bf16 v[200:203], v[72:75], v[120:123], v[200:203]
    v_mfma_f32_16x16x32_bf16 v[232:235], v[72:75], v[124:127], v[232:235]
    s_waitcnt lgkmcnt(8)
    s_nop 0
    v_mfma_f32_16x16x32_bf16 v[236:239], v[76:79], v[124:127], v[236:239]
    v_mfma_f32_16x16x32_bf16 v[204:207], v[76:79], v[120:123], v[204:207]
    v_mfma_f32_16x16x32_bf16 v[172:175], v[76:79], v[116:119], v[172:175]
    v_mfma_f32_16x16x32_bf16 v[140:143], v[76:79], v[112:115], v[140:143]
    s_waitcnt lgkmcnt(6)
    s_nop 0
    v_mfma_f32_16x16x32_bf16 v[144:147], v[80:83], v[112:115], v[144:147]
    s_waitcnt lgkmcnt(0)
    s_barrier
    ds_read_b128 v[96:99], v2 offset:32768
    v_mfma_f32_16x16x32_bf16 v[176:179], v[80:83], v[116:119], v[176:179]
    ds_read_b64_tr_b16 v[64:65], v10 offset:16384
    v_mfma_f32_16x16x32_bf16 v[208:211], v[80:83], v[120:123], v[208:211]
    ds_read_b64_tr_b16 v[66:67], v10 offset:16896
    v_mfma_f32_16x16x32_bf16 v[240:243], v[80:83], v[124:127], v[240:243]
    ds_read_b128 v[100:103], v2 offset:34816
    v_mfma_f32_16x16x32_bf16 v[244:247], v[84:87], v[124:127], v[244:247]
    ds_read_b128 v[104:107], v2 offset:36864
    v_mfma_f32_16x16x32_bf16 v[212:215], v[84:87], v[120:123], v[212:215]
    ds_read_b128 v[108:111], v2 offset:38912
    v_mfma_f32_16x16x32_bf16 v[180:183], v[84:87], v[116:119], v[180:183]
    ds_read_b64_tr_b16 v[68:69], v11 offset:16384
    v_mfma_f32_16x16x32_bf16 v[148:151], v[84:87], v[112:115], v[148:151]
    ds_read_b64_tr_b16 v[70:71], v11 offset:16896
    v_mfma_f32_16x16x32_bf16 v[152:155], v[88:91], v[112:115], v[152:155]
    ds_read_b64_tr_b16 v[72:73], v12 offset:16384
    v_mfma_f32_16x16x32_bf16 v[184:187], v[88:91], v[116:119], v[184:187]
    ds_read_b64_tr_b16 v[74:75], v12 offset:16896
    v_mfma_f32_16x16x32_bf16 v[216:219], v[88:91], v[120:123], v[216:219]
    ds_read_b64_tr_b16 v[76:77], v13 offset:16384
    v_mfma_f32_16x16x32_bf16 v[248:251], v[88:91], v[124:127], v[248:251]
    ds_read_b64_tr_b16 v[78:79], v13 offset:16896
    v_mfma_f32_16x16x32_bf16 v[252:255], v[92:95], v[124:127], v[252:255]
    v_mfma_f32_16x16x32_bf16 v[220:223], v[92:95], v[120:123], v[220:223]
    v_mfma_f32_16x16x32_bf16 v[188:191], v[92:95], v[116:119], v[188:191]
    v_mfma_f32_16x16x32_bf16 v[156:159], v[92:95], v[112:115], v[156:159]
    s_waitcnt lgkmcnt(9)
    s_nop 0
    v_mfma_f32_16x16x32_bf16 v[128:131], v[64:67], v[96:99], v[128:131]
    ds_read_b64_tr_b16 v[80:81], v10 offset:18432
    s_waitcnt lgkmcnt(9)
    s_nop 0
    v_mfma_f32_16x16x32_bf16 v[160:163], v[64:67], v[100:103], v[160:163]
    ds_read_b64_tr_b16 v[82:83], v10 offset:18944
    s_waitcnt lgkmcnt(9)
    s_nop 0
    v_mfma_f32_16x16x32_bf16 v[192:195], v[64:67], v[104:107], v[192:195]
    ds_read_b64_tr_b16 v[84:85], v11 offset:18432
    s_waitcnt lgkmcnt(9)
    s_nop 0
    v_mfma_f32_16x16x32_bf16 v[224:227], v[64:67], v[108:111], v[224:227]
    ds_read_b64_tr_b16 v[86:87], v11 offset:18944
    s_waitcnt lgkmcnt(8)
    s_nop 0
    v_mfma_f32_16x16x32_bf16 v[228:231], v[68:71], v[108:111], v[228:231]
    ds_read_b64_tr_b16 v[88:89], v12 offset:18432
    v_mfma_f32_16x16x32_bf16 v[196:199], v[68:71], v[104:107], v[196:199]
    ds_read_b64_tr_b16 v[90:91], v12 offset:18944
    v_mfma_f32_16x16x32_bf16 v[164:167], v[68:71], v[100:103], v[164:167]
    ds_read_b64_tr_b16 v[92:93], v13 offset:18432
    v_mfma_f32_16x16x32_bf16 v[132:135], v[68:71], v[96:99], v[132:135]
    ds_read_b64_tr_b16 v[94:95], v13 offset:18944
    s_waitcnt lgkmcnt(10)
    s_nop 0
    v_mfma_f32_16x16x32_bf16 v[136:139], v[72:75], v[96:99], v[136:139]
    v_mfma_f32_16x16x32_bf16 v[168:171], v[72:75], v[100:103], v[168:171]
    v_mfma_f32_16x16x32_bf16 v[200:203], v[72:75], v[104:107], v[200:203]
    v_mfma_f32_16x16x32_bf16 v[232:235], v[72:75], v[108:111], v[232:235]
    s_waitcnt lgkmcnt(8)
    s_nop 0
    v_mfma_f32_16x16x32_bf16 v[236:239], v[76:79], v[108:111], v[236:239]
    v_mfma_f32_16x16x32_bf16 v[204:207], v[76:79], v[104:107], v[204:207]
    v_mfma_f32_16x16x32_bf16 v[172:175], v[76:79], v[100:103], v[172:175]
    v_mfma_f32_16x16x32_bf16 v[140:143], v[76:79], v[96:99], v[140:143]
    s_waitcnt lgkmcnt(6)
    s_nop 0
    v_mfma_f32_16x16x32_bf16 v[144:147], v[80:83], v[96:99], v[144:147]
    s_waitcnt lgkmcnt(0)
    s_barrier
    ds_read_b128 v[112:115], v3 offset:32768
    v_mfma_f32_16x16x32_bf16 v[176:179], v[80:83], v[100:103], v[176:179]
    ds_read_b64_tr_b16 v[64:65], v10 offset:24576
    v_mfma_f32_16x16x32_bf16 v[208:211], v[80:83], v[104:107], v[208:211]
    ds_read_b64_tr_b16 v[66:67], v10 offset:25088
    v_mfma_f32_16x16x32_bf16 v[240:243], v[80:83], v[108:111], v[240:243]
    ds_read_b128 v[116:119], v3 offset:34816
    v_mfma_f32_16x16x32_bf16 v[244:247], v[84:87], v[108:111], v[244:247]
    ds_read_b128 v[120:123], v3 offset:36864
    v_mfma_f32_16x16x32_bf16 v[212:215], v[84:87], v[104:107], v[212:215]
    ds_read_b128 v[124:127], v3 offset:38912
    v_mfma_f32_16x16x32_bf16 v[180:183], v[84:87], v[100:103], v[180:183]
    ds_read_b64_tr_b16 v[68:69], v11 offset:24576
    v_mfma_f32_16x16x32_bf16 v[148:151], v[84:87], v[96:99], v[148:151]
    ds_read_b64_tr_b16 v[70:71], v11 offset:25088
    v_mfma_f32_16x16x32_bf16 v[152:155], v[88:91], v[96:99], v[152:155]
    ds_read_b64_tr_b16 v[72:73], v12 offset:24576
    v_mfma_f32_16x16x32_bf16 v[184:187], v[88:91], v[100:103], v[184:187]
    ds_read_b64_tr_b16 v[74:75], v12 offset:25088
    v_mfma_f32_16x16x32_bf16 v[216:219], v[88:91], v[104:107], v[216:219]
    ds_read_b64_tr_b16 v[76:77], v13 offset:24576
    v_mfma_f32_16x16x32_bf16 v[248:251], v[88:91], v[108:111], v[248:251]
    ds_read_b64_tr_b16 v[78:79], v13 offset:25088
    v_mfma_f32_16x16x32_bf16 v[252:255], v[92:95], v[108:111], v[252:255]
    v_mfma_f32_16x16x32_bf16 v[220:223], v[92:95], v[104:107], v[220:223]
    v_mfma_f32_16x16x32_bf16 v[188:191], v[92:95], v[100:103], v[188:191]
    v_mfma_f32_16x16x32_bf16 v[156:159], v[92:95], v[96:99], v[156:159]
    s_waitcnt lgkmcnt(9)
    s_nop 0
    v_mfma_f32_16x16x32_bf16 v[128:131], v[64:67], v[112:115], v[128:131]
    ds_read_b64_tr_b16 v[80:81], v10 offset:26624
    s_waitcnt lgkmcnt(9)
    s_nop 0
    v_mfma_f32_16x16x32_bf16 v[160:163], v[64:67], v[116:119], v[160:163]
    ds_read_b64_tr_b16 v[82:83], v10 offset:27136
    s_waitcnt lgkmcnt(9)
    s_nop 0
    v_mfma_f32_16x16x32_bf16 v[192:195], v[64:67], v[120:123], v[192:195]
    ds_read_b64_tr_b16 v[84:85], v11 offset:26624
    s_waitcnt lgkmcnt(9)
    s_nop 0
    v_mfma_f32_16x16x32_bf16 v[224:227], v[64:67], v[124:127], v[224:227]
    ds_read_b64_tr_b16 v[86:87], v11 offset:27136
    s_waitcnt lgkmcnt(8)
    s_nop 0
    v_mfma_f32_16x16x32_bf16 v[228:231], v[68:71], v[124:127], v[228:231]
    ds_read_b64_tr_b16 v[88:89], v12 offset:26624
    v_mfma_f32_16x16x32_bf16 v[196:199], v[68:71], v[120:123], v[196:199]
    ds_read_b64_tr_b16 v[90:91], v12 offset:27136
    v_mfma_f32_16x16x32_bf16 v[164:167], v[68:71], v[116:119], v[164:167]
    ds_read_b64_tr_b16 v[92:93], v13 offset:26624
    v_mfma_f32_16x16x32_bf16 v[132:135], v[68:71], v[112:115], v[132:135]
    ds_read_b64_tr_b16 v[94:95], v13 offset:27136
    s_waitcnt lgkmcnt(10)
    s_nop 0
    v_mfma_f32_16x16x32_bf16 v[136:139], v[72:75], v[112:115], v[136:139]
    ds_read_b32 v52, v48 offset:0
    v_mfma_f32_16x16x32_bf16 v[168:171], v[72:75], v[116:119], v[168:171]
    ds_read_b32 v53, v48 offset:64
    v_mfma_f32_16x16x32_bf16 v[200:203], v[72:75], v[120:123], v[200:203]
    ds_read_b32 v54, v48 offset:128
    v_mfma_f32_16x16x32_bf16 v[232:235], v[72:75], v[124:127], v[232:235]
    ds_read_b32 v55, v48 offset:192
    s_waitcnt lgkmcnt(12)
    s_nop 0
    v_mfma_f32_16x16x32_bf16 v[236:239], v[76:79], v[124:127], v[236:239]
    ds_read_b32 v32, v49 offset:0
    v_mfma_f32_16x16x32_bf16 v[204:207], v[76:79], v[120:123], v[204:207]
    ds_read_b32 v33, v49 offset:256
    v_mfma_f32_16x16x32_bf16 v[172:175], v[76:79], v[116:119], v[172:175]
    v_mfma_f32_16x16x32_bf16 v[140:143], v[76:79], v[112:115], v[140:143]
    s_waitcnt lgkmcnt(12)
    s_nop 0
    v_mfma_f32_16x16x32_bf16 v[144:147], v[80:83], v[112:115], v[144:147]
    s_setprio 2
    s_waitcnt lgkmcnt(0)
    s_barrier
    v_lshlrev_b32 v19, 16, v52
    v_mfma_f32_16x16x32_bf16 v[176:179], v[80:83], v[116:119], v[176:179]
    v_lshlrev_b32_e64 v23, 16, v53
    v_mfma_f32_16x16x32_bf16 v[208:211], v[80:83], v[120:123], v[208:211]
    v_lshlrev_b32_e64 v27, 16, v54
    v_mfma_f32_16x16x32_bf16 v[240:243], v[80:83], v[124:127], v[240:243]
    v_lshlrev_b32_e64 v31, 16, v55
    v_mfma_f32_16x16x32_bf16 v[244:247], v[84:87], v[124:127], v[244:247]
    v_and_b32 v30, 0xffff0000, v55
    v_mfma_f32_16x16x32_bf16 v[212:215], v[84:87], v[120:123], v[212:215]
    v_rcp_f32_e64 v29, v30
    v_mfma_f32_16x16x32_bf16 v[180:183], v[84:87], v[116:119], v[180:183]
    v_mul_f32_e64 v30, v30, v30
    v_mfma_f32_16x16x32_bf16 v[148:151], v[84:87], v[112:115], v[148:151]
    v_mul_f32 v28, 0xc0135761, v29
    v_mfma_f32_16x16x32_bf16 v[152:155], v[88:91], v[112:115], v[152:155]
    v_mul_f32_e64 v29, v29, v29
    v_mfma_f32_16x16x32_bf16 v[184:187], v[88:91], v[116:119], v[184:187]
    v_mul_f32 v29, 0x3d372713, v29
    v_mfma_f32_16x16x32_bf16 v[216:219], v[88:91], v[120:123], v[216:219]
    v_mul_f32_e64 v29, v28, v29
    v_mfma_f32_16x16x32_bf16 v[248:251], v[88:91], v[124:127], v[248:251]
    v_and_b32 v26, 0xffff0000, v54
    v_mfma_f32_16x16x32_bf16 v[252:255], v[92:95], v[124:127], v[252:255]
    v_rcp_f32_e64 v25, v26
    v_mfma_f32_16x16x32_bf16 v[220:223], v[92:95], v[120:123], v[220:223]
    v_mul_f32_e64 v26, v26, v26
    v_mfma_f32_16x16x32_bf16 v[188:191], v[92:95], v[116:119], v[188:191]
    v_mul_f32 v24, 0xc0135761, v25
    v_mfma_f32_16x16x32_bf16 v[156:159], v[92:95], v[112:115], v[156:159]
    v_mul_f32_e64 v25, v25, v25
    v_mfma_f32_16x16x1_4b_f32 v[224:239], v32, v31, v[224:239]
    v_mul_f32 v25, 0x3d372713, v25
    v_mul_f32_e64 v25, v24, v25
    v_and_b32 v22, 0xffff0000, v53
    v_rcp_f32 v21, v22
    v_mul_f32 v22, v22, v22
    v_mfma_f32_16x16x1_4b_f32 v[240:255], v33, v31, v[240:255]
    v_mul_f32 v20, 0xc0135761, v21
    v_mul_f32_e64 v21, v21, v21
    v_mul_f32 v21, 0x3d372713, v21
    v_mul_f32_e64 v21, v20, v21
    v_and_b32 v18, 0xffff0000, v52
    v_mfma_f32_16x16x1_4b_f32 v[192:207], v32, v27, v[192:207]
    v_rcp_f32 v17, v18
    v_mul_f32 v18, v18, v18
    v_mul_f32 v16, 0xc0135761, v17
    v_mul_f32_e64 v17, v17, v17
    v_mul_f32 v17, 0x3d372713, v17
    v_mfma_f32_16x16x1_4b_f32 v[208:223], v33, v27, v[208:223]
    v_mul_f32_e64 v17, v16, v17
    v_mfma_f32_16x16x1_4b_f32 v[160:175], v32, v23, v[160:175]
    v_mfma_f32_16x16x1_4b_f32 v[176:191], v33, v23, v[176:191]
    v_mfma_f32_16x16x1_4b_f32 v[128:143], v32, v19, v[128:143]
    v_mfma_f32_16x16x1_4b_f32 v[144:159], v33, v19, v[144:159]
    s_setprio 1
    v_mul_f32 v64, v224, v224
    v_mul_f32 v65, v225, v225
    v_mul_f32 v66, v226, v226
.L_pp1:
    s_cbranch_execz .L_pb1
    s_nop 0
    v_mul_f32 v67, v227, v227
    v_mul_f32 v68, v228, v228
    v_mul_f32 v69, v229, v229
    v_mul_f32 v70, v230, v230
    v_mul_f32_e64 v71, v231, v231
    v_fma_f32 v64, v64, v29, v28
    v_fma_f32 v65, v65, v29, v28
    v_fma_f32 v66, v66, v29, v28
    v_fma_f32 v67, v67, v29, v28
    v_fma_f32 v68, v68, v29, v28
    v_fma_f32 v69, v69, v29, v28
    v_fma_f32 v70, v70, v29, v28
    v_fma_f32 v71, v71, v29, v28
    v_mul_f32 v64, v64, v224
    v_mul_f32 v65, v65, v225
    v_mul_f32 v66, v66, v226
    v_mul_f32 v67, v67, v227
    v_mul_f32 v68, v68, v228
    v_mul_f32 v69, v69, v229
    v_mul_f32 v70, v70, v230
    v_mul_f32 v71, v71, v231
    v_exp_f32 v64, v64
    v_mul_f32 v224, v224, v240
    v_exp_f32 v65, v65
    v_mul_f32 v225, v225, v241
    v_exp_f32 v66, v66
    v_mul_f32 v226, v226, v242
    v_exp_f32 v67, v67
    v_mul_f32 v227, v227, v243
    v_exp_f32 v68, v68
    v_mul_f32 v228, v228, v244
    v_exp_f32 v69, v69
    v_mul_f32 v229, v229, v245
    v_exp_f32 v70, v70
    v_mul_f32 v230, v230, v246
    v_exp_f32 v71, v71
    v_mul_f32 v231, v231, v247
    v_fma_f32 v64, v64, v30, v30
    v_fma_f32 v65, v65, v30, v30
    v_fma_f32 v66, v66, v30, v30
    v_fma_f32 v67, v67, v30, v30
    v_fma_f32 v68, v68, v30, v30
    v_fma_f32 v69, v69, v30, v30
    v_fma_f32 v70, v70, v30, v30
    v_fma_f32 v71, v71, v30, v30
    v_rcp_f32 v64, v64
    v_rcp_f32 v65, v65
    v_rcp_f32 v66, v66
    v_rcp_f32 v67, v67
    v_rcp_f32 v68, v68
    v_rcp_f32 v69, v69
    v_rcp_f32 v70, v70
    v_rcp_f32 v71, v71
    v_mul_f32 v224, v224, v64
    v_mul_f32 v225, v225, v65
    v_mul_f32 v226, v226, v66
    v_mul_f32 v227, v227, v67
    v_mul_f32 v228, v228, v68
    v_mul_f32 v229, v229, v69
    v_mul_f32 v230, v230, v70
    v_mul_f32 v231, v231, v71
    v_cvt_pk_bf16_f32 v72, v224, v225
    v_cvt_pk_bf16_f32 v73, v226, v227
    v_cvt_pk_bf16_f32 v74, v228, v229
    v_cvt_pk_bf16_f32 v75, v230, v231
    buffer_store_dwordx4 v[72:75], v51, s[68:71], s13 offen offset:256 sc1
    v_mul_f32 v80, v232, v232
    v_mul_f32 v81, v233, v233
    v_mul_f32 v82, v234, v234
    v_mul_f32 v83, v235, v235
    v_mul_f32 v84, v236, v236
    v_mul_f32 v85, v237, v237
    v_mul_f32 v86, v238, v238
    v_mul_f32 v87, v239, v239
    v_fma_f32 v80, v80, v29, v28
    v_fma_f32 v81, v81, v29, v28
    v_fma_f32 v82, v82, v29, v28
    v_fma_f32 v83, v83, v29, v28
    v_fma_f32 v84, v84, v29, v28
    v_fma_f32 v85, v85, v29, v28
    v_fma_f32 v86, v86, v29, v28
    v_fma_f32 v87, v87, v29, v28
    v_mul_f32 v80, v80, v232
    v_mul_f32 v81, v81, v233
    v_mul_f32 v82, v82, v234
    v_mul_f32 v83, v83, v235
    v_mul_f32 v84, v84, v236
    v_mul_f32 v85, v85, v237
    v_mul_f32 v86, v86, v238
    v_mul_f32 v87, v87, v239
    v_exp_f32 v80, v80
    v_mul_f32 v232, v232, v248
    v_exp_f32 v81, v81
    v_mul_f32 v233, v233, v249
    v_exp_f32 v82, v82
    v_mul_f32 v234, v234, v250
    v_exp_f32 v83, v83
    v_mul_f32 v235, v235, v251
    v_exp_f32 v84, v84
    v_mul_f32 v236, v236, v252
    v_exp_f32 v85, v85
    v_mul_f32 v237, v237, v253
    v_exp_f32 v86, v86
    v_mul_f32 v238, v238, v254
    v_exp_f32 v87, v87
    v_mul_f32 v239, v239, v255
    v_fma_f32 v80, v80, v30, v30
    v_fma_f32 v81, v81, v30, v30
    v_fma_f32 v82, v82, v30, v30
    v_fma_f32 v83, v83, v30, v30
    v_fma_f32 v84, v84, v30, v30
    v_fma_f32 v85, v85, v30, v30
    v_fma_f32 v86, v86, v30, v30
    v_fma_f32 v87, v87, v30, v30
    v_rcp_f32 v80, v80
    v_rcp_f32 v81, v81
    v_rcp_f32 v82, v82
    v_rcp_f32 v83, v83
    v_rcp_f32 v84, v84
    v_rcp_f32 v85, v85
    v_rcp_f32 v86, v86
    v_rcp_f32 v87, v87
    v_mul_f32 v232, v232, v80
    v_mul_f32 v233, v233, v81
    v_mul_f32 v234, v234, v82
    v_mul_f32 v235, v235, v83
    v_mul_f32 v236, v236, v84
    v_mul_f32 v237, v237, v85
    v_mul_f32 v238, v238, v86
    v_mul_f32 v239, v239, v87
    v_cvt_pk_bf16_f32 v88, v232, v233
    v_cvt_pk_bf16_f32 v89, v234, v235
    v_cvt_pk_bf16_f32 v90, v236, v237
    v_cvt_pk_bf16_f32 v91, v238, v239
    buffer_store_dwordx4 v[88:91], v51, s[68:71], s13 offen offset:2304 sc1
    v_mul_f32 v64, v192, v192
    v_mul_f32 v65, v193, v193
    v_mul_f32 v66, v194, v194
    v_mul_f32 v67, v195, v195
    v_mul_f32 v68, v196, v196
    v_mul_f32 v69, v197, v197
    v_mul_f32 v70, v198, v198
    v_mul_f32 v71, v199, v199
    v_fma_f32 v64, v64, v25, v24
    v_fma_f32 v65, v65, v25, v24
    v_fma_f32 v66, v66, v25, v24
    v_fma_f32 v67, v67, v25, v24
    v_fma_f32 v68, v68, v25, v24
    v_fma_f32 v69, v69, v25, v24
    v_fma_f32 v70, v70, v25, v24
    v_fma_f32 v71, v71, v25, v24
    v_mul_f32 v64, v64, v192
    v_mul_f32 v65, v65, v193
    v_mul_f32 v66, v66, v194
    v_mul_f32 v67, v67, v195
    v_mul_f32 v68, v68, v196
    v_mul_f32 v69, v69, v197
    v_mul_f32 v70, v70, v198
    v_mul_f32 v71, v71, v199
    v_exp_f32 v64, v64
    v_mul_f32 v192, v192, v208
    v_exp_f32 v65, v65
    v_mul_f32 v193, v193, v209
    v_exp_f32 v66, v66
    v_mul_f32 v194, v194, v210
    v_exp_f32 v67, v67
    v_mul_f32 v195, v195, v211
    v_exp_f32 v68, v68
    v_mul_f32 v196, v196, v212
    v_exp_f32 v69, v69
    v_mul_f32 v197, v197, v213
    v_exp_f32 v70, v70
    v_mul_f32 v198, v198, v214
    v_exp_f32 v71, v71
    v_mul_f32 v199, v199, v215
    v_fma_f32 v64, v64, v26, v26
    v_fma_f32 v65, v65, v26, v26
    v_fma_f32 v66, v66, v26, v26
    v_fma_f32 v67, v67, v26, v26
    v_fma_f32 v68, v68, v26, v26
    v_fma_f32 v69, v69, v26, v26
    v_fma_f32 v70, v70, v26, v26
    v_fma_f32 v71, v71, v26, v26
    v_rcp_f32 v64, v64
    v_rcp_f32 v65, v65
    v_rcp_f32 v66, v66
    v_rcp_f32 v67, v67
    v_rcp_f32 v68, v68
    v_rcp_f32 v69, v69
    v_rcp_f32 v70, v70
    v_rcp_f32 v71, v71
    v_mul_f32 v192, v192, v64
    v_mul_f32 v193, v193, v65
    v_mul_f32 v194, v194, v66
    v_mul_f32 v195, v195, v67
    v_mul_f32 v196, v196, v68
    v_mul_f32 v197, v197, v69
    v_mul_f32 v198, v198, v70
    v_mul_f32 v199, v199, v71
    v_cvt_pk_bf16_f32 v72, v192, v193
    v_cvt_pk_bf16_f32 v73, v194, v195
    v_cvt_pk_bf16_f32 v74, v196, v197
    v_cvt_pk_bf16_f32 v75, v198, v199
    buffer_store_dwordx4 v[72:75], v51, s[68:71], s13 offen offset:0 sc1
    v_mul_f32 v80, v200, v200
    v_mul_f32 v81, v201, v201
    v_mul_f32 v82, v202, v202
    v_mul_f32 v83, v203, v203
    v_mul_f32 v84, v204, v204
    v_mul_f32 v85, v205, v205
    v_mul_f32 v86, v206, v206
    v_mul_f32 v87, v207, v207
    v_fma_f32 v80, v80, v25, v24
    v_fma_f32 v81, v81, v25, v24
    v_fma_f32 v82, v82, v25, v24
    v_fma_f32 v83, v83, v25, v24
    v_fma_f32 v84, v84, v25, v24
    v_fma_f32 v85, v85, v25, v24
    v_fma_f32 v86, v86, v25, v24
    v_fma_f32 v87, v87, v25, v24
    v_mul_f32 v80, v80, v200
    v_mul_f32 v81, v81, v201
    v_mul_f32 v82, v82, v202
    v_mul_f32 v83, v83, v203
    v_mul_f32 v84, v84, v204
    v_mul_f32 v85, v85, v205
    v_mul_f32 v86, v86, v206
    v_mul_f32 v87, v87, v207
    v_exp_f32 v80, v80
    v_mul_f32 v200, v200, v216
    v_exp_f32 v81, v81
    v_mul_f32 v201, v201, v217
    v_exp_f32 v82, v82
    v_mul_f32 v202, v202, v218
    v_exp_f32 v83, v83
    v_mul_f32 v203, v203, v219
    v_exp_f32 v84, v84
    v_mul_f32 v204, v204, v220
    v_exp_f32 v85, v85
    v_mul_f32 v205, v205, v221
    v_exp_f32 v86, v86
    v_mul_f32 v206, v206, v222
    v_exp_f32 v87, v87
    v_mul_f32 v207, v207, v223
    v_fma_f32 v80, v80, v26, v26
    v_fma_f32 v81, v81, v26, v26
    v_fma_f32 v82, v82, v26, v26
    v_fma_f32 v83, v83, v26, v26
    v_fma_f32 v84, v84, v26, v26
    v_fma_f32 v85, v85, v26, v26
    v_fma_f32 v86, v86, v26, v26
    v_fma_f32 v87, v87, v26, v26
    v_rcp_f32 v80, v80
    v_rcp_f32 v81, v81
    v_rcp_f32 v82, v82
    v_rcp_f32 v83, v83
    v_rcp_f32 v84, v84
    v_rcp_f32 v85, v85
    v_rcp_f32 v86, v86
    v_rcp_f32 v87, v87
    v_mul_f32 v200, v200, v80
    v_mul_f32 v201, v201, v81
    v_mul_f32 v202, v202, v82
    v_mul_f32 v203, v203, v83
    v_mul_f32 v204, v204, v84
    v_mul_f32 v205, v205, v85
    v_mul_f32 v206, v206, v86
    v_mul_f32 v207, v207, v87
    v_cvt_pk_bf16_f32 v88, v200, v201
    v_cvt_pk_bf16_f32 v89, v202, v203
    v_cvt_pk_bf16_f32 v90, v204, v205
    v_cvt_pk_bf16_f32 v91, v206, v207
    buffer_store_dwordx4 v[88:91], v51, s[68:71], s13 offen offset:2048 sc1
    v_mul_f32 v64, v160, v160
    v_mul_f32 v65, v161, v161
    v_mul_f32 v66, v162, v162
    v_mul_f32 v67, v163, v163
    v_mul_f32 v68, v164, v164
    v_mul_f32 v69, v165, v165
    v_mul_f32 v70, v166, v166
    v_mul_f32 v71, v167, v167
    v_fma_f32 v64, v64, v21, v20
    v_fma_f32 v65, v65, v21, v20
    v_fma_f32 v66, v66, v21, v20
    v_fma_f32 v67, v67, v21, v20
    v_fma_f32 v68, v68, v21, v20
    v_fma_f32 v69, v69, v21, v20
    v_fma_f32 v70, v70, v21, v20
    v_fma_f32 v71, v71, v21, v20
    v_mul_f32 v64, v64, v160
    v_mul_f32 v65, v65, v161
    v_mul_f32 v66, v66, v162
    v_mul_f32 v67, v67, v163
    v_mul_f32 v68, v68, v164
    v_mul_f32 v69, v69, v165
    v_mul_f32 v70, v70, v166
    v_mul_f32 v71, v71, v167
    v_exp_f32 v64, v64
    v_mul_f32 v160, v160, v176
    v_exp_f32 v65, v65
    v_mul_f32 v161, v161, v177
    v_exp_f32 v66, v66
    v_mul_f32 v162, v162, v178
    v_exp_f32 v67, v67
    v_mul_f32 v163, v163, v179
    v_exp_f32 v68, v68
    v_mul_f32 v164, v164, v180
    v_exp_f32 v69, v69
    v_mul_f32 v165, v165, v181
    v_exp_f32 v70, v70
    v_mul_f32 v166, v166, v182
    v_exp_f32 v71, v71
    v_mul_f32 v167, v167, v183
    v_fma_f32 v64, v64, v22, v22
    v_fma_f32 v65, v65, v22, v22
    v_fma_f32 v66, v66, v22, v22
    v_fma_f32 v67, v67, v22, v22
    v_fma_f32 v68, v68, v22, v22
    v_fma_f32 v69, v69, v22, v22
    v_fma_f32 v70, v70, v22, v22
    v_fma_f32 v71, v71, v22, v22
    v_rcp_f32 v64, v64
    v_rcp_f32 v65, v65
    v_rcp_f32 v66, v66
    v_rcp_f32 v67, v67
    v_rcp_f32 v68, v68
    v_rcp_f32 v69, v69
    v_rcp_f32 v70, v70
    v_rcp_f32 v71, v71
    v_mul_f32 v160, v160, v64
    v_mul_f32 v161, v161, v65
    v_mul_f32 v162, v162, v66
    v_mul_f32 v163, v163, v67
    v_mul_f32 v164, v164, v68
    v_mul_f32 v165, v165, v69
    v_mul_f32 v166, v166, v70
    v_mul_f32 v167, v167, v71
    v_cvt_pk_bf16_f32 v72, v160, v161
    v_cvt_pk_bf16_f32 v73, v162, v163
    v_cvt_pk_bf16_f32 v74, v164, v165
    v_cvt_pk_bf16_f32 v75, v166, v167
    buffer_store_dwordx4 v[72:75], v51, s[68:71], s12 offen offset:256 sc1
    v_mul_f32 v80, v168, v168
    v_mul_f32 v81, v169, v169
    v_mul_f32 v82, v170, v170
    v_mul_f32 v83, v171, v171
    v_mul_f32 v84, v172, v172
    v_mul_f32 v85, v173, v173
    v_mul_f32 v86, v174, v174
    v_mul_f32 v87, v175, v175
    v_fma_f32 v80, v80, v21, v20
    v_fma_f32 v81, v81, v21, v20
    v_fma_f32 v82, v82, v21, v20
    v_fma_f32 v83, v83, v21, v20
    v_fma_f32 v84, v84, v21, v20
    v_fma_f32 v85, v85, v21, v20
    v_fma_f32 v86, v86, v21, v20
    v_fma_f32 v87, v87, v21, v20
    v_mul_f32 v80, v80, v168
    v_mul_f32 v81, v81, v169
    v_mul_f32 v82, v82, v170
    v_mul_f32 v83, v83, v171
    v_mul_f32 v84, v84, v172
    v_mul_f32 v85, v85, v173
    v_mul_f32 v86, v86, v174
    v_mul_f32 v87, v87, v175
    v_exp_f32 v80, v80
    v_mul_f32 v168, v168, v184
    v_exp_f32 v81, v81
    v_mul_f32 v169, v169, v185
    v_exp_f32 v82, v82
    v_mul_f32 v170, v170, v186
    v_exp_f32 v83, v83
    v_mul_f32 v171, v171, v187
    v_exp_f32 v84, v84
    v_mul_f32 v172, v172, v188
    v_exp_f32 v85, v85
    v_mul_f32 v173, v173, v189
    v_exp_f32 v86, v86
    v_mul_f32 v174, v174, v190
    v_exp_f32 v87, v87
    v_mul_f32 v175, v175, v191
    v_fma_f32 v80, v80, v22, v22
    v_fma_f32 v81, v81, v22, v22
    v_fma_f32 v82, v82, v22, v22
    v_fma_f32 v83, v83, v22, v22
    v_fma_f32 v84, v84, v22, v22
    v_fma_f32 v85, v85, v22, v22
    v_fma_f32 v86, v86, v22, v22
    v_fma_f32 v87, v87, v22, v22
    v_rcp_f32 v80, v80
    v_rcp_f32 v81, v81
    v_rcp_f32 v82, v82
    v_rcp_f32 v83, v83
    v_rcp_f32 v84, v84
    v_rcp_f32 v85, v85
    v_rcp_f32 v86, v86
    v_rcp_f32 v87, v87
    v_mul_f32 v168, v168, v80
    v_mul_f32 v169, v169, v81
    v_mul_f32 v170, v170, v82
    v_mul_f32 v171, v171, v83
    v_mul_f32 v172, v172, v84
    v_mul_f32 v173, v173, v85
    v_mul_f32 v174, v174, v86
    v_mul_f32 v175, v175, v87
    v_cvt_pk_bf16_f32 v88, v168, v169
    v_cvt_pk_bf16_f32 v89, v170, v171
    v_cvt_pk_bf16_f32 v90, v172, v173
    v_cvt_pk_bf16_f32 v91, v174, v175
    buffer_store_dwordx4 v[88:91], v51, s[68:71], s12 offen offset:2304 sc1
    v_mul_f32 v64, v128, v128
    v_mul_f32 v65, v129, v129
    v_mul_f32 v66, v130, v130
    v_mul_f32 v67, v131, v131
    v_mul_f32 v68, v132, v132
    v_mul_f32 v69, v133, v133
    v_mul_f32 v70, v134, v134
    v_mul_f32 v71, v135, v135
    v_fma_f32 v64, v64, v17, v16
    v_fma_f32 v65, v65, v17, v16
    v_fma_f32 v66, v66, v17, v16
    v_fma_f32 v67, v67, v17, v16
    v_fma_f32 v68, v68, v17, v16
    v_fma_f32 v69, v69, v17, v16
    v_fma_f32 v70, v70, v17, v16
    v_fma_f32 v71, v71, v17, v16
    v_mul_f32 v64, v64, v128
    v_mul_f32 v65, v65, v129
    v_mul_f32 v66, v66, v130
    v_mul_f32 v67, v67, v131
    v_mul_f32 v68, v68, v132
    v_mul_f32 v69, v69, v133
    v_mul_f32 v70, v70, v134
    v_mul_f32 v71, v71, v135
    v_exp_f32 v64, v64
    v_mul_f32 v128, v128, v144
    v_exp_f32 v65, v65
    v_mul_f32 v129, v129, v145
    v_exp_f32 v66, v66
    v_mul_f32 v130, v130, v146
    v_exp_f32 v67, v67
    v_mul_f32 v131, v131, v147
    v_exp_f32 v68, v68
    v_mul_f32 v132, v132, v148
    v_exp_f32 v69, v69
    v_mul_f32 v133, v133, v149
    v_exp_f32 v70, v70
    v_mul_f32 v134, v134, v150
    v_exp_f32 v71, v71
    v_mul_f32 v135, v135, v151
    v_fma_f32 v64, v64, v18, v18
    v_fma_f32 v65, v65, v18, v18
    v_fma_f32 v66, v66, v18, v18
    v_fma_f32 v67, v67, v18, v18
    v_fma_f32 v68, v68, v18, v18
    v_fma_f32 v69, v69, v18, v18
    v_fma_f32 v70, v70, v18, v18
    v_fma_f32 v71, v71, v18, v18
    v_rcp_f32 v64, v64
    v_rcp_f32 v65, v65
    v_rcp_f32 v66, v66
    v_rcp_f32 v67, v67
    v_rcp_f32 v68, v68
    v_rcp_f32 v69, v69
    v_rcp_f32 v70, v70
    v_rcp_f32 v71, v71
    v_mul_f32 v128, v128, v64
    v_mul_f32 v129, v129, v65
    v_mul_f32 v130, v130, v66
    v_mul_f32 v131, v131, v67
    v_mul_f32 v132, v132, v68
    v_mul_f32 v133, v133, v69
    v_mul_f32 v134, v134, v70
    v_mul_f32 v135, v135, v71
    v_cvt_pk_bf16_f32 v72, v128, v129
    v_cvt_pk_bf16_f32 v73, v130, v131
    v_cvt_pk_bf16_f32 v74, v132, v133
    v_cvt_pk_bf16_f32 v75, v134, v135
    buffer_store_dwordx4 v[72:75], v51, s[68:71], s12 offen offset:0 sc1
    s_add_u32 s29, s3, 147208
    v_mov_b32_e64 v52, s29
    ds_write_b8 v52, v52
    v_mul_f32 v80, v136, v136
    v_mul_f32 v81, v137, v137
    v_mul_f32 v82, v138, v138
    v_mul_f32 v83, v139, v139
    v_mul_f32 v84, v140, v140
    v_mul_f32 v85, v141, v141
    v_mul_f32 v86, v142, v142
    v_mul_f32 v87, v143, v143
    v_fma_f32 v80, v80, v17, v16
    v_fma_f32 v81, v81, v17, v16
    v_fma_f32 v82, v82, v17, v16
    v_fma_f32 v83, v83, v17, v16
    v_fma_f32 v84, v84, v17, v16
    v_fma_f32 v85, v85, v17, v16
    v_fma_f32 v86, v86, v17, v16
    v_fma_f32 v87, v87, v17, v16
    v_mul_f32 v80, v80, v136
    v_mul_f32 v81, v81, v137
    v_mul_f32 v82, v82, v138
    v_mul_f32 v83, v83, v139
    v_mul_f32 v84, v84, v140
    v_mul_f32 v85, v85, v141
    v_mul_f32 v86, v86, v142
    v_mul_f32 v87, v87, v143
    v_exp_f32 v80, v80
    v_mul_f32 v136, v136, v152
    v_exp_f32 v81, v81
    v_mul_f32 v137, v137, v153
    v_exp_f32 v82, v82
    v_mul_f32 v138, v138, v154
    v_exp_f32 v83, v83
    v_mul_f32 v139, v139, v155
    v_exp_f32 v84, v84
    v_mul_f32 v140, v140, v156
    v_exp_f32 v85, v85
    v_mul_f32 v141, v141, v157
    v_exp_f32 v86, v86
    v_mul_f32 v142, v142, v158
    v_exp_f32 v87, v87
    v_mul_f32 v143, v143, v159
    v_fma_f32 v80, v80, v18, v18
    v_fma_f32 v81, v81, v18, v18
    v_fma_f32 v82, v82, v18, v18
    v_fma_f32 v83, v83, v18, v18
    v_fma_f32 v84, v84, v18, v18
    v_fma_f32 v85, v85, v18, v18
    v_fma_f32 v86, v86, v18, v18
    v_fma_f32 v87, v87, v18, v18
    v_mov_b32 v11, 147200
    v_rcp_f32 v80, v80
    v_rcp_f32 v81, v81
    v_rcp_f32 v82, v82
    v_rcp_f32 v83, v83
    v_rcp_f32 v84, v84
    v_rcp_f32 v85, v85
    v_rcp_f32 v86, v86
    v_rcp_f32 v87, v87
    ds_read_b32 v12, v11
    v_mul_f32 v136, v136, v80
    v_mul_f32 v137, v137, v81
    v_mul_f32 v138, v138, v82
    v_mul_f32 v139, v139, v83
    v_mul_f32 v140, v140, v84
    v_mul_f32 v141, v141, v85
    v_mul_f32 v142, v142, v86
    v_mul_f32 v143, v143, v87
    v_cvt_pk_bf16_f32 v88, v136, v137
    v_cvt_pk_bf16_f32 v89, v138, v139
    v_cvt_pk_bf16_f32 v90, v140, v141
    v_cvt_pk_bf16_f32 v91, v142, v143
    buffer_store_dwordx4 v[88:91], v51, s[68:71], s12 offen offset:2048 sc1
    s_setprio 0
    s_waitcnt lgkmcnt(0)
    v_readfirstlane_b32 s29, v12
    s_cmp_eq_u32 s29, 2
    s_cbranch_scc1 .L_wfx
.L_g2:
    s_nop 0
    v_mov_b32 v11, 147200
    s_cmp_lt_u32 s7, 28
    s_cbranch_scc1 .L_nax
    s_add_u32 m0, s27, 4096
    s_add_u32 s18, s25, 98304
    s_sub_u32 s19, s25, 360448
    s_min_u32 s18, s18, s19
    s_nop 0
    buffer_load_dwordx4 v14, s[60:63], s18 offen lds
    buffer_load_dwordx4 v15, s[60:63], s18 offen offset:1024 lds
    s_add_u32 m0, s27, 6144
    s_add_u32 s18, s25, 114688
    s_sub_u32 s19, s25, 344064
    s_min_u32 s18, s18, s19
    s_nop 0
    buffer_load_dwordx4 v14, s[60:63], s18 offen lds
    buffer_load_dwordx4 v15, s[60:63], s18 offen offset:1024 lds
    s_add_u32 m0, s27, 98304
    s_add_u32 s18, s25, 131072
    s_sub_u32 s19, s25, 327680
    s_min_u32 s18, s18, s19
    s_nop 0
    buffer_load_dwordx4 v14, s[60:63], s18 offen lds
    buffer_load_dwordx4 v15, s[60:63], s18 offen offset:1024 lds
    s_add_u32 m0, s27, 100352
    s_add_u32 s18, s25, 147456
    s_sub_u32 s19, s25, 311296
    s_min_u32 s18, s18, s19
    s_nop 0
    buffer_load_dwordx4 v14, s[60:63], s18 offen lds
    buffer_load_dwordx4 v15, s[60:63], s18 offen offset:1024 lds
    s_add_u32 m0, s27, 102400
    s_add_u32 s18, s25, 163840
    s_sub_u32 s19, s25, 294912
    s_min_u32 s18, s18, s19
    s_nop 0
    buffer_load_dwordx4 v14, s[60:63], s18 offen lds
    buffer_load_dwordx4 v15, s[60:63], s18 offen offset:1024 lds
    s_add_u32 m0, s27, 104448
    s_add_u32 s18, s25, 180224
    s_sub_u32 s19, s25, 278528
    s_min_u32 s18, s18, s19
    s_nop 0
    buffer_load_dwordx4 v14, s[60:63], s18 offen lds
    buffer_load_dwordx4 v15, s[60:63], s18 offen offset:1024 lds
    s_add_u32 m0, s27, 32768
    s_add_u32 s18, s25, 196608
    s_sub_u32 s19, s25, 262144
    s_min_u32 s18, s18, s19
    s_nop 0
    buffer_load_dwordx4 v14, s[60:63], s18 offen lds
    buffer_load_dwordx4 v15, s[60:63], s18 offen offset:1024 lds
    s_add_u32 m0, s27, 34816
    s_add_u32 s18, s25, 212992
    s_sub_u32 s19, s25, 245760
    s_min_u32 s18, s18, s19
    s_nop 0
    buffer_load_dwordx4 v14, s[60:63], s18 offen lds
    buffer_load_dwordx4 v15, s[60:63], s18 offen offset:1024 lds
    s_add_u32 m0, s27, 36864
    s_add_u32 s18, s25, 229376
    s_sub_u32 s19, s25, 229376
    s_min_u32 s18, s18, s19
    s_nop 0
    buffer_load_dwordx4 v14, s[60:63], s18 offen lds
    buffer_load_dwordx4 v15, s[60:63], s18 offen offset:1024 lds
    s_add_u32 m0, s27, 38912
    s_add_u32 s18, s25, 245760
    s_sub_u32 s19, s25, 212992
    s_min_u32 s18, s18, s19
    s_nop 0
    buffer_load_dwordx4 v14, s[60:63], s18 offen lds
    buffer_load_dwordx4 v15, s[60:63], s18 offen offset:1024 lds
    s_add_u32 m0, s27, 65536
    s_add_u32 s18, s25, 0
    s_nop 0
    s_sub_u32 s19, s25, 458752
    s_min_u32 s18, s18, s19
    s_nop 0
    buffer_load_dwordx4 v14, s[60:63], s18 offen lds
    buffer_load_dwordx4 v15, s[60:63], s18 offen offset:1024 lds
    s_add_u32 m0, s27, 67584
    s_add_u32 s18, s25, 16384
    s_sub_u32 s19, s25, 442368
    s_min_u32 s18, s18, s19
    s_nop 0
    buffer_load_dwordx4 v14, s[60:63], s18 offen lds
    buffer_load_dwordx4 v15, s[60:63], s18 offen offset:1024 lds
    s_add_u32 m0, s27, 69632
    s_add_u32 s18, s25, 32768
    s_sub_u32 s19, s25, 425984
    s_min_u32 s18, s18, s19
    s_nop 0
    buffer_load_dwordx4 v14, s[60:63], s18 offen lds
    buffer_load_dwordx4 v15, s[60:63], s18 offen offset:1024 lds
    s_add_u32 m0, s27, 71680
    s_add_u32 s18, s25, 49152
    s_sub_u32 s19, s25, 409600
    s_min_u32 s18, s18, s19
    s_nop 0
    buffer_load_dwordx4 v14, s[60:63], s18 offen lds
    buffer_load_dwordx4 v15, s[60:63], s18 offen offset:1024 lds
    s_waitcnt vmcnt(0)
.L_nax:
    s_nop 0
    s_mov_b32 s28, 2097152
.L_wf:
    ds_read_b32 v12, v11
    s_sub_u32 s28, s28, 1
    s_cbranch_scc1 .L_wfx
    s_waitcnt lgkmcnt(0)
    v_readfirstlane_b32 s29, v12
    s_cmp_eq_u32 s29, 2
    s_cbranch_scc1 .L_wfx
    s_sleep 1
    s_branch .L_wf
.L_wfx:
    ds_read_b64_tr_b16 v[32:33], v8 offset:0
    ds_read_b64_tr_b16 v[34:35], v8 offset:1024
    ds_read_b64_tr_b16 v[36:37], v9 offset:0
    ds_read_b64_tr_b16 v[38:39], v9 offset:1024
    ds_read_b64_tr_b16 v[40:41], v8 offset:2048
    ds_read_b64_tr_b16 v[42:43], v8 offset:3072
    ds_read_b64_tr_b16 v[44:45], v9 offset:2048
    ds_read_b64_tr_b16 v[46:47], v9 offset:3072
    ds_read_b64_tr_b16 v[48:49], v8 offset:4096
    ds_read_b64_tr_b16 v[50:51], v8 offset:5120
    ds_read_b64_tr_b16 v[52:53], v9 offset:4096
    ds_read_b64_tr_b16 v[54:55], v9 offset:5120
    ds_read_b64_tr_b16 v[56:57], v8 offset:6144
    ds_read_b64_tr_b16 v[58:59], v8 offset:7168
    ds_read_b64_tr_b16 v[60:61], v9 offset:6144
    ds_read_b64_tr_b16 v[62:63], v9 offset:7168
    ds_read_b64_tr_b16 v[192:193], v6 offset:0
    ds_read_b64_tr_b16 v[194:195], v6 offset:1024
    ds_read_b64_tr_b16 v[196:197], v7 offset:0
    ds_read_b64_tr_b16 v[198:199], v7 offset:1024
    ds_read_b64_tr_b16 v[200:201], v6 offset:2048
    ds_read_b64_tr_b16 v[202:203], v6 offset:3072
    ds_read_b64_tr_b16 v[204:205], v7 offset:2048
    ds_read_b64_tr_b16 v[206:207], v7 offset:3072
    ds_read_b64_tr_b16 v[208:209], v6 offset:4096
    ds_read_b64_tr_b16 v[210:211], v6 offset:5120
    ds_read_b64_tr_b16 v[212:213], v7 offset:4096
    ds_read_b64_tr_b16 v[214:215], v7 offset:5120
    ds_read_b64_tr_b16 v[216:217], v6 offset:6144
    ds_read_b64_tr_b16 v[218:219], v6 offset:7168
    ds_read_b64_tr_b16 v[220:221], v7 offset:6144
    ds_read_b64_tr_b16 v[222:223], v7 offset:7168
    ds_read_b64_tr_b16 v[224:225], v8 offset:32768
    ds_read_b64_tr_b16 v[226:227], v8 offset:33792
    ds_read_b64_tr_b16 v[228:229], v9 offset:32768
    ds_read_b64_tr_b16 v[230:231], v9 offset:33792
    ds_read_b64_tr_b16 v[232:233], v8 offset:34816
    ds_read_b64_tr_b16 v[234:235], v8 offset:35840
    ds_read_b64_tr_b16 v[236:237], v9 offset:34816
    ds_read_b64_tr_b16 v[238:239], v9 offset:35840
    ds_read_b64_tr_b16 v[240:241], v8 offset:36864
    ds_read_b64_tr_b16 v[242:243], v8 offset:37888
    ds_read_b64_tr_b16 v[244:245], v9 offset:36864
    ds_read_b64_tr_b16 v[246:247], v9 offset:37888
    ds_read_b64_tr_b16 v[248:249], v8 offset:38912
    ds_read_b64_tr_b16 v[250:251], v8 offset:39936
    ds_read_b64_tr_b16 v[252:253], v9 offset:38912
    ds_read_b64_tr_b16 v[254:255], v9 offset:39936
    v_lshlrev_b32 v2, 4, v1
    s_mul_i32 s11, s3, 28
    s_mul_i32 s12, s8, 224
    s_add_u32 s12, s12, s11
    s_lshl_b32 s12, s12, 10
    v_add_u32_e64 v2, s12, v2
    v_add_u32 v3, 114688, v2
    s_lshr_b32 s12, s25, 4
    s_mov_b32 s15, s27
    v_min_u32 v10, 6, v1
    v_lshlrev_b32 v10, 7, v10
    s_lshl2_add_u32 s14, s8, s3
    s_lshl_b32 s14, s14, 10
    s_add_u32 s14, s14, 14680064
    s_waitcnt lgkmcnt(0)
.L_pp2:
    s_cbranch_execz .L_pb2
    s_add_u32 m0, s27, 65536
    s_add_u32 s18, s25, 262144
    s_sub_u32 s19, s25, 196608
    s_min_u32 s18, s18, s19
    s_nop 0
    buffer_load_dwordx4 v14, s[60:63], s18 offen lds
    buffer_load_dwordx4 v15, s[60:63], s18 offen offset:1024 lds
    s_add_u32 m0, s27, 67584
    s_add_u32 s18, s25, 278528
    s_sub_u32 s19, s25, 180224
    s_min_u32 s18, s18, s19
    s_nop 0
    buffer_load_dwordx4 v14, s[60:63], s18 offen lds
    buffer_load_dwordx4 v15, s[60:63], s18 offen offset:1024 lds
    s_add_u32 m0, s27, 69632
    s_add_u32 s18, s25, 294912
    s_sub_u32 s19, s25, 163840
    s_min_u32 s18, s18, s19
    s_nop 0
    buffer_load_dwordx4 v14, s[60:63], s18 offen lds
    buffer_load_dwordx4 v15, s[60:63], s18 offen offset:1024 lds
    s_cmp_ge_u32 s7, 28
    s_cbranch_scc1 .L_nohs2
    v_mov_b32 v21, s34
    v_lshlrev_b32_e64 v20, 2, v1
    s_waitcnt vmcnt(6)
    s_mov_b64 exec, 1
    s_mov_b32 exec_lo, -1
    buffer_store_dword v21, v20, s[68:71], s21 offen sc1
.L_nohs:
    s_mov_b64 exec, -1
.L_nohs2:
    s_waitcnt lgkmcnt(0)
    s_add_u32 m0, s27, 71680
    s_add_u32 s18, s25, 311296
    s_sub_u32 s19, s25, 147456
    s_min_u32 s18, s18, s19
    s_nop 0
    buffer_load_dwordx4 v14, s[60:63], s18 offen lds
    buffer_load_dwordx4 v15, s[60:63], s18 offen offset:1024 lds
    s_add_u32 m0, s27, 0
    s_nop 0
    s_add_u32 s18, s25, 327680
    s_sub_u32 s19, s25, 131072
    s_min_u32 s18, s18, s19
    s_nop 0
    buffer_load_dwordx4 v14, s[60:63], s18 offen lds
    buffer_load_dwordx4 v15, s[60:63], s18 offen offset:1024 lds
    s_add_u32 m0, s27, 2048
    s_add_u32 s18, s25, 344064
    s_sub_u32 s19, s25, 114688
    s_min_u32 s18, s18, s19
    s_nop 0
    buffer_load_dwordx4 v14, s[60:63], s18 offen lds
    buffer_load_dwordx4 v15, s[60:63], s18 offen offset:1024 lds
    s_add_u32 m0, s27, 4096
    s_add_u32 s18, s25, 360448
    s_sub_u32 s19, s25, 98304
    s_min_u32 s18, s18, s19
    s_nop 0
    buffer_load_dwordx4 v14, s[60:63], s18 offen lds
    buffer_load_dwordx4 v15, s[60:63], s18 offen offset:1024 lds
    s_add_u32 m0, s27, 6144
    s_add_u32 s18, s25, 376832
    s_sub_u32 s19, s25, 81920
    s_min_u32 s18, s18, s19
    s_nop 0
    buffer_load_dwordx4 v14, s[60:63], s18 offen lds
    buffer_load_dwordx4 v15, s[60:63], s18 offen offset:1024 lds
    s_add_u32 m0, s27, 98304
    s_add_u32 s18, s25, 393216
    s_sub_u32 s19, s25, 65536
    s_min_u32 s18, s18, s19
    s_nop 0
    buffer_load_dwordx4 v14, s[60:63], s18 offen lds
    buffer_load_dwordx4 v15, s[60:63], s18 offen offset:1024 lds
    s_add_u32 m0, s27, 100352
    s_add_u32 s18, s25, 409600
    s_sub_u32 s19, s25, 49152
    s_min_u32 s18, s18, s19
    s_nop 0
    buffer_load_dwordx4 v14, s[60:63], s18 offen lds
    buffer_load_dwordx4 v15, s[60:63], s18 offen offset:1024 lds
    s_add_u32 m0, s27, 102400
    s_add_u32 s18, s25, 425984
    s_sub_u32 s19, s25, 32768
    s_min_u32 s18, s18, s19
    s_nop 0
    buffer_load_dwordx4 v14, s[60:63], s18 offen lds
    buffer_load_dwordx4 v15, s[60:63], s18 offen offset:1024 lds
    s_add_u32 m0, s27, 104448
    s_add_u32 s18, s25, 442368
    s_sub_u32 s19, s25, 16384
    s_min_u32 s18, s18, s19
    s_nop 0
    buffer_load_dwordx4 v14, s[60:63], s18 offen lds
    buffer_load_dwordx4 v15, s[60:63], s18 offen offset:1024 lds
    ds_read_b64_tr_b16 v[16:17], v6 offset:32768
    ds_read_b64_tr_b16 v[18:19], v6 offset:33792
    ds_read_b64_tr_b16 v[20:21], v7 offset:32768
    ds_read_b64_tr_b16 v[22:23], v7 offset:33792
    v_lshrrev_b32 v13, 5, v1
    v_lshlrev_b32 v13, 10, v13
    v_and_b32_e64 v14, 31, v1
    v_lshl_add_u32 v13, v14, 4, v13
    v_add_u32_e64 v13, s15, v13
    v_xor_b32 v14, 128, v13
    v_mov_b32_e64 v15, 1
    s_mov_b32 s28, 262144
.L_hp:
    buffer_load_dword v12, v10, s[68:71], s14 offen sc1
    s_sub_u32 s28, s28, 1
    s_cbranch_scc1 .L_hpx
    s_waitcnt vmcnt(0)
    v_cmp_ne_u32 vcc, s34, v12
    s_cbranch_vccz .L_hpx
    s_sleep 1
    s_branch .L_hp
.L_hpx:
    s_setprio 1
    s_add_u32 s16, s12, 12288
    s_sub_u32 s17, s12, 16384
    s_min_u32 s16, s16, s17
    s_nop 0
    buffer_load_dwordx4 v[128:131], v2, s[68:71], s16 offen sc1
    buffer_load_dwordx4 v[132:135], v3, s[68:71], s16 offen sc1
    s_add_u32 s16, s12, 13312
    s_sub_u32 s17, s12, 15360
    s_min_u32 s16, s16, s17
    s_nop 0
    buffer_load_dwordx4 v[136:139], v2, s[68:71], s16 offen sc1
    buffer_load_dwordx4 v[140:143], v3, s[68:71], s16 offen sc1
    s_add_u32 s16, s12, 14336
    s_sub_u32 s17, s12, 14336
    s_min_u32 s16, s16, s17
    s_nop 0
    buffer_load_dwordx4 v[144:147], v2, s[68:71], s16 offen sc1
    buffer_load_dwordx4 v[148:151], v3, s[68:71], s16 offen sc1
    s_add_u32 s16, s12, 15360
    s_sub_u32 s17, s12, 13312
    s_min_u32 s16, s16, s17
    s_nop 0
    buffer_load_dwordx4 v[152:155], v2, s[68:71], s16 offen sc1
    buffer_load_dwordx4 v[156:159], v3, s[68:71], s16 offen sc1
    s_add_u32 s16, s12, 16384
    s_sub_u32 s17, s12, 12288
    s_min_u32 s16, s16, s17
    s_nop 0
    buffer_load_dwordx4 v[160:163], v2, s[68:71], s16 offen sc1
    buffer_load_dwordx4 v[164:167], v3, s[68:71], s16 offen sc1
    s_add_u32 s16, s12, 17408
    s_sub_u32 s17, s12, 11264
    s_min_u32 s16, s16, s17
    s_nop 0
    buffer_load_dwordx4 v[168:171], v2, s[68:71], s16 offen sc1
    buffer_load_dwordx4 v[172:175], v3, s[68:71], s16 offen sc1
    s_add_u32 s16, s12, 18432
    s_sub_u32 s17, s12, 10240
    s_min_u32 s16, s16, s17
    s_nop 0
    buffer_load_dwordx4 v[176:179], v2, s[68:71], s16 offen sc1
    buffer_load_dwordx4 v[180:183], v3, s[68:71], s16 offen sc1
    s_add_u32 s16, s12, 19456
    s_sub_u32 s17, s12, 9216
    s_min_u32 s16, s16, s17
    s_nop 0
    buffer_load_dwordx4 v[184:187], v2, s[68:71], s16 offen sc1
    buffer_load_dwordx4 v[188:191], v3, s[68:71], s16 offen sc1
    s_mov_b32 s28, 2097152
.L_yw:
    ds_read_b32 v12, v11 offset:48
    s_sub_u32 s28, s28, 1
    s_cbranch_scc1 .L_ywx
    s_waitcnt lgkmcnt(0)
    v_readfirstlane_b32 s29, v12
    s_cmp_eq_u32 s29, 4
    s_cbranch_scc1 .L_ywx
    s_sleep 1
    s_branch .L_yw
.L_ywx:
    ds_read_b64_tr_b16 v[24:25], v6 offset:34816
    ds_read_b64_tr_b16 v[26:27], v6 offset:35840
    ds_read_b64_tr_b16 v[28:29], v7 offset:34816
    ds_read_b64_tr_b16 v[30:31], v7 offset:35840
    s_waitcnt lgkmcnt(4)
    s_waitcnt vmcnt(15)
    v_mfma_f32_32x32x16_bf16 v[64:79], v[16:19], v[128:131], 0
    v_mfma_f32_32x32x16_bf16 v[80:95], v[20:23], v[128:131], 0
    s_add_u32 s16, s12, 20480
    s_sub_u32 s17, s12, 8192
    s_min_u32 s16, s16, s17
    s_nop 0
    buffer_load_dwordx4 v[128:131], v2, s[68:71], s16 offen sc1
    s_waitcnt vmcnt(15)
    s_nop 0
    v_mfma_f32_32x32x16_bf16 v[96:111], v[16:19], v[132:135], 0
    v_mfma_f32_32x32x16_bf16 v[112:127], v[20:23], v[132:135], 0
    buffer_load_dwordx4 v[132:135], v3, s[68:71], s16 offen sc1
    ds_read_b64_tr_b16 v[16:17], v6 offset:36864
    ds_read_b64_tr_b16 v[18:19], v6 offset:37888
    ds_read_b64_tr_b16 v[20:21], v7 offset:36864
    ds_read_b64_tr_b16 v[22:23], v7 offset:37888
    s_waitcnt lgkmcnt(4)
    s_waitcnt vmcnt(15)
    v_mfma_f32_32x32x16_bf16 v[64:79], v[24:27], v[136:139], v[64:79]
    v_mfma_f32_32x32x16_bf16 v[80:95], v[28:31], v[136:139], v[80:95]
    s_add_u32 s16, s12, 21504
    s_sub_u32 s17, s12, 7168
    s_min_u32 s16, s16, s17
    s_nop 0
    buffer_load_dwordx4 v[136:139], v2, s[68:71], s16 offen sc1
    s_waitcnt vmcnt(15)
    s_nop 0
    v_mfma_f32_32x32x16_bf16 v[96:111], v[24:27], v[140:143], v[96:111]
    v_mfma_f32_32x32x16_bf16 v[112:127], v[28:31], v[140:143], v[112:127]
    buffer_load_dwordx4 v[140:143], v3, s[68:71], s16 offen sc1
    ds_read_b64_tr_b16 v[24:25], v6 offset:38912
    ds_read_b64_tr_b16 v[26:27], v6 offset:39936
    ds_read_b64_tr_b16 v[28:29], v7 offset:38912
    ds_read_b64_tr_b16 v[30:31], v7 offset:39936
    s_waitcnt lgkmcnt(4)
    s_waitcnt vmcnt(15)
    v_mfma_f32_32x32x16_bf16 v[64:79], v[16:19], v[144:147], v[64:79]
    v_mfma_f32_32x32x16_bf16 v[80:95], v[20:23], v[144:147], v[80:95]
    s_add_u32 s16, s12, 22528
    s_sub_u32 s17, s12, 6144
    s_min_u32 s16, s16, s17
    s_nop 0
    buffer_load_dwordx4 v[144:147], v2, s[68:71], s16 offen sc1
    s_waitcnt vmcnt(15)
    s_nop 0
    v_mfma_f32_32x32x16_bf16 v[96:111], v[16:19], v[148:151], v[96:111]
    v_mfma_f32_32x32x16_bf16 v[112:127], v[20:23], v[148:151], v[112:127]
    buffer_load_dwordx4 v[148:151], v3, s[68:71], s16 offen sc1
    ds_read_b64_tr_b16 v[16:17], v8 offset:0
    ds_read_b64_tr_b16 v[18:19], v8 offset:1024
    ds_read_b64_tr_b16 v[20:21], v9 offset:0
    ds_read_b64_tr_b16 v[22:23], v9 offset:1024
    s_waitcnt lgkmcnt(4)
    s_waitcnt vmcnt(15)
    v_mfma_f32_32x32x16_bf16 v[64:79], v[24:27], v[152:155], v[64:79]
    v_mfma_f32_32x32x16_bf16 v[80:95], v[28:31], v[152:155], v[80:95]
    s_add_u32 s16, s12, 23552
    s_sub_u32 s17, s12, 5120
    s_min_u32 s16, s16, s17
    s_nop 0
    buffer_load_dwordx4 v[152:155], v2, s[68:71], s16 offen sc1
    s_waitcnt vmcnt(15)
    s_nop 0
    v_mfma_f32_32x32x16_bf16 v[96:111], v[24:27], v[156:159], v[96:111]
    v_mfma_f32_32x32x16_bf16 v[112:127], v[28:31], v[156:159], v[112:127]
    buffer_load_dwordx4 v[156:159], v3, s[68:71], s16 offen sc1
    ds_read_b64_tr_b16 v[24:25], v8 offset:2048
    ds_read_b64_tr_b16 v[26:27], v8 offset:3072
    ds_read_b64_tr_b16 v[28:29], v9 offset:2048
    ds_read_b64_tr_b16 v[30:31], v9 offset:3072
    s_waitcnt lgkmcnt(4)
    s_waitcnt vmcnt(15)
    v_mfma_f32_32x32x16_bf16 v[64:79], v[16:19], v[160:163], v[64:79]
    v_mfma_f32_32x32x16_bf16 v[80:95], v[20:23], v[160:163], v[80:95]
    s_add_u32 s16, s12, 24576
    s_sub_u32 s17, s12, 4096
    s_min_u32 s16, s16, s17
    s_nop 0
    buffer_load_dwordx4 v[160:163], v2, s[68:71], s16 offen sc1
    s_waitcnt vmcnt(15)
    s_nop 0
    v_mfma_f32_32x32x16_bf16 v[96:111], v[16:19], v[164:167], v[96:111]
    v_mfma_f32_32x32x16_bf16 v[112:127], v[20:23], v[164:167], v[112:127]
    buffer_load_dwordx4 v[164:167], v3, s[68:71], s16 offen sc1
    ds_read_b64_tr_b16 v[16:17], v8 offset:4096
    ds_read_b64_tr_b16 v[18:19], v8 offset:5120
    ds_read_b64_tr_b16 v[20:21], v9 offset:4096
    ds_read_b64_tr_b16 v[22:23], v9 offset:5120
    s_waitcnt lgkmcnt(4)
    s_waitcnt vmcnt(15)
    v_mfma_f32_32x32x16_bf16 v[64:79], v[24:27], v[168:171], v[64:79]
    v_mfma_f32_32x32x16_bf16 v[80:95], v[28:31], v[168:171], v[80:95]
    s_add_u32 s16, s12, 25600
    s_sub_u32 s17, s12, 3072
    s_min_u32 s16, s16, s17
    s_nop 0
    buffer_load_dwordx4 v[168:171], v2, s[68:71], s16 offen sc1
    s_waitcnt vmcnt(15)
    s_nop 0
    v_mfma_f32_32x32x16_bf16 v[96:111], v[24:27], v[172:175], v[96:111]
    v_mfma_f32_32x32x16_bf16 v[112:127], v[28:31], v[172:175], v[112:127]
    buffer_load_dwordx4 v[172:175], v3, s[68:71], s16 offen sc1
    ds_read_b64_tr_b16 v[24:25], v8 offset:6144
    ds_read_b64_tr_b16 v[26:27], v8 offset:7168
    ds_read_b64_tr_b16 v[28:29], v9 offset:6144
    ds_read_b64_tr_b16 v[30:31], v9 offset:7168
    s_waitcnt lgkmcnt(4)
    s_waitcnt vmcnt(15)
    v_mfma_f32_32x32x16_bf16 v[64:79], v[16:19], v[176:179], v[64:79]
    v_mfma_f32_32x32x16_bf16 v[80:95], v[20:23], v[176:179], v[80:95]
    s_add_u32 s16, s12, 26624
    s_sub_u32 s17, s12, 2048
    s_min_u32 s16, s16, s17
    s_nop 0
    buffer_load_dwordx4 v[176:179], v2, s[68:71], s16 offen sc1
    s_waitcnt vmcnt(15)
    s_nop 0
    v_mfma_f32_32x32x16_bf16 v[96:111], v[16:19], v[180:183], v[96:111]
    v_mfma_f32_32x32x16_bf16 v[112:127], v[20:23], v[180:183], v[112:127]
    buffer_load_dwordx4 v[180:183], v3, s[68:71], s16 offen sc1
    ds_read_b64_tr_b16 v[16:17], v6 offset:0
    ds_read_b64_tr_b16 v[18:19], v6 offset:1024
    ds_read_b64_tr_b16 v[20:21], v7 offset:0
    ds_read_b64_tr_b16 v[22:23], v7 offset:1024
    s_waitcnt lgkmcnt(4)
    s_waitcnt vmcnt(15)
    v_mfma_f32_32x32x16_bf16 v[64:79], v[24:27], v[184:187], v[64:79]
    v_mfma_f32_32x32x16_bf16 v[80:95], v[28:31], v[184:187], v[80:95]
    s_add_u32 s16, s12, 27648
    s_sub_u32 s17, s12, 1024
    s_min_u32 s16, s16, s17
    s_nop 0
    buffer_load_dwordx4 v[184:187], v2, s[68:71], s16 offen sc1
    s_waitcnt vmcnt(15)
    s_nop 0
    v_mfma_f32_32x32x16_bf16 v[96:111], v[24:27], v[188:191], v[96:111]
    v_mfma_f32_32x32x16_bf16 v[112:127], v[28:31], v[188:191], v[112:127]
    buffer_load_dwordx4 v[188:191], v3, s[68:71], s16 offen sc1
    ds_read_b64_tr_b16 v[24:25], v6 offset:2048
    ds_read_b64_tr_b16 v[26:27], v6 offset:3072
    ds_read_b64_tr_b16 v[28:29], v7 offset:2048
    ds_read_b64_tr_b16 v[30:31], v7 offset:3072
    s_waitcnt lgkmcnt(4)
    s_waitcnt vmcnt(15)
    v_mfma_f32_32x32x16_bf16 v[64:79], v[16:19], v[128:131], v[64:79]
    v_mfma_f32_32x32x16_bf16 v[80:95], v[20:23], v[128:131], v[80:95]
    s_add_u32 s16, s12, 0
    s_nop 0
    s_sub_u32 s17, s12, 28672
    s_min_u32 s16, s16, s17
    s_nop 0
    buffer_load_dwordx4 v[128:131], v2, s[68:71], s16 offen sc1
    s_waitcnt vmcnt(15)
    s_nop 0
    v_mfma_f32_32x32x16_bf16 v[96:111], v[16:19], v[132:135], v[96:111]
    v_mfma_f32_32x32x16_bf16 v[112:127], v[20:23], v[132:135], v[112:127]
    s_add_u32 s16, s12, 1024
    s_sub_u32 s17, s12, 27648
    s_min_u32 s16, s16, s17
    s_nop 0
    buffer_load_dwordx4 v[132:135], v2, s[68:71], s16 offen sc1
    ds_read_b64_tr_b16 v[16:17], v6 offset:4096
    ds_read_b64_tr_b16 v[18:19], v6 offset:5120
    ds_read_b64_tr_b16 v[20:21], v7 offset:4096
    ds_read_b64_tr_b16 v[22:23], v7 offset:5120
    s_waitcnt lgkmcnt(4)
    s_waitcnt vmcnt(15)
    v_mfma_f32_32x32x16_bf16 v[64:79], v[24:27], v[136:139], v[64:79]
    v_mfma_f32_32x32x16_bf16 v[80:95], v[28:31], v[136:139], v[80:95]
    s_add_u32 s16, s12, 2048
    s_sub_u32 s17, s12, 26624
    s_min_u32 s16, s16, s17
    s_nop 0
    buffer_load_dwordx4 v[136:139], v2, s[68:71], s16 offen sc1
    s_waitcnt vmcnt(15)
    s_nop 0
    v_mfma_f32_32x32x16_bf16 v[96:111], v[24:27], v[140:143], v[96:111]
    v_mfma_f32_32x32x16_bf16 v[112:127], v[28:31], v[140:143], v[112:127]
    s_add_u32 s16, s12, 3072
    s_sub_u32 s17, s12, 25600
    s_min_u32 s16, s16, s17
    s_nop 0
    buffer_load_dwordx4 v[140:143], v2, s[68:71], s16 offen sc1
    ds_read_b64_tr_b16 v[24:25], v6 offset:6144
    ds_read_b64_tr_b16 v[26:27], v6 offset:7168
    ds_read_b64_tr_b16 v[28:29], v7 offset:6144
    ds_read_b64_tr_b16 v[30:31], v7 offset:7168
    s_waitcnt lgkmcnt(4)
    s_waitcnt vmcnt(15)
    v_mfma_f32_32x32x16_bf16 v[64:79], v[16:19], v[144:147], v[64:79]
    v_mfma_f32_32x32x16_bf16 v[80:95], v[20:23], v[144:147], v[80:95]
    s_add_u32 s16, s12, 4096
    s_sub_u32 s17, s12, 24576
    s_min_u32 s16, s16, s17
    s_nop 0
    buffer_load_dwordx4 v[144:147], v2, s[68:71], s16 offen sc1
    s_waitcnt vmcnt(15)
    s_nop 0
    v_mfma_f32_32x32x16_bf16 v[96:111], v[16:19], v[148:151], v[96:111]
    v_mfma_f32_32x32x16_bf16 v[112:127], v[20:23], v[148:151], v[112:127]
    s_add_u32 s16, s12, 5120
    s_sub_u32 s17, s12, 23552
    s_min_u32 s16, s16, s17
    s_nop 0
    buffer_load_dwordx4 v[148:151], v2, s[68:71], s16 offen sc1
    ds_read_b64_tr_b16 v[16:17], v8 offset:32768
    ds_read_b64_tr_b16 v[18:19], v8 offset:33792
    ds_read_b64_tr_b16 v[20:21], v9 offset:32768
    ds_read_b64_tr_b16 v[22:23], v9 offset:33792
    s_waitcnt lgkmcnt(4)
    s_waitcnt vmcnt(15)
    v_mfma_f32_32x32x16_bf16 v[64:79], v[24:27], v[152:155], v[64:79]
    v_mfma_f32_32x32x16_bf16 v[80:95], v[28:31], v[152:155], v[80:95]
    s_add_u32 s16, s12, 6144
    s_sub_u32 s17, s12, 22528
    s_min_u32 s16, s16, s17
    s_nop 0
    buffer_load_dwordx4 v[152:155], v2, s[68:71], s16 offen sc1
    s_waitcnt vmcnt(15)
    s_nop 0
    v_mfma_f32_32x32x16_bf16 v[96:111], v[24:27], v[156:159], v[96:111]
    v_mfma_f32_32x32x16_bf16 v[112:127], v[28:31], v[156:159], v[112:127]
    s_add_u32 s16, s12, 7168
    s_sub_u32 s17, s12, 21504
    s_min_u32 s16, s16, s17
    s_nop 0
    buffer_load_dwordx4 v[156:159], v2, s[68:71], s16 offen sc1
    ds_read_b64_tr_b16 v[24:25], v8 offset:34816
    ds_read_b64_tr_b16 v[26:27], v8 offset:35840
    ds_read_b64_tr_b16 v[28:29], v9 offset:34816
    ds_read_b64_tr_b16 v[30:31], v9 offset:35840
    s_waitcnt lgkmcnt(4)
    s_waitcnt vmcnt(15)
    v_mfma_f32_32x32x16_bf16 v[64:79], v[16:19], v[160:163], v[64:79]
    v_mfma_f32_32x32x16_bf16 v[80:95], v[20:23], v[160:163], v[80:95]
    s_add_u32 s16, s12, 8192
    s_sub_u32 s17, s12, 20480
    s_min_u32 s16, s16, s17
    s_nop 0
    buffer_load_dwordx4 v[160:163], v2, s[68:71], s16 offen sc1
    s_waitcnt vmcnt(15)
    s_nop 0
    v_mfma_f32_32x32x16_bf16 v[96:111], v[16:19], v[164:167], v[96:111]
    v_mfma_f32_32x32x16_bf16 v[112:127], v[20:23], v[164:167], v[112:127]
    s_add_u32 s16, s12, 9216
    s_sub_u32 s17, s12, 19456
    s_min_u32 s16, s16, s17
    s_nop 0
    buffer_load_dwordx4 v[164:167], v2, s[68:71], s16 offen sc1
    s_mov_b64 exec, 1
    s_nop 0
    ds_add_u32 v11, v15 offset:52
    s_mov_b64 exec, -1
    s_nop 0
    ds_read_b64_tr_b16 v[16:17], v8 offset:36864
    ds_read_b64_tr_b16 v[18:19], v8 offset:37888
    ds_read_b64_tr_b16 v[20:21], v9 offset:36864
    ds_read_b64_tr_b16 v[22:23], v9 offset:37888
    s_waitcnt lgkmcnt(4)
    s_waitcnt vmcnt(15)
    v_mfma_f32_32x32x16_bf16 v[64:79], v[24:27], v[168:171], v[64:79]
    v_mfma_f32_32x32x16_bf16 v[80:95], v[28:31], v[168:171], v[80:95]
    s_add_u32 s16, s12, 10240
    s_sub_u32 s17, s12, 18432
    s_min_u32 s16, s16, s17
    s_nop 0
    buffer_load_dwordx4 v[168:171], v2, s[68:71], s16 offen sc1
    s_waitcnt vmcnt(15)
    s_nop 0
    v_mfma_f32_32x32x16_bf16 v[96:111], v[24:27], v[172:175], v[96:111]
    v_mfma_f32_32x32x16_bf16 v[112:127], v[28:31], v[172:175], v[112:127]
    s_add_u32 s16, s12, 11264
    s_sub_u32 s17, s12, 17408
    s_min_u32 s16, s16, s17
    s_nop 0
    buffer_load_dwordx4 v[172:175], v2, s[68:71], s16 offen sc1
    ds_read_b64_tr_b16 v[24:25], v8 offset:38912
    ds_read_b64_tr_b16 v[26:27], v8 offset:39936
    ds_read_b64_tr_b16 v[28:29], v9 offset:38912
    ds_read_b64_tr_b16 v[30:31], v9 offset:39936
    s_waitcnt lgkmcnt(4)
    s_waitcnt vmcnt(15)
    v_mfma_f32_32x32x16_bf16 v[64:79], v[16:19], v[176:179], v[64:79]
    v_mfma_f32_32x32x16_bf16 v[80:95], v[20:23], v[176:179], v[80:95]
    s_add_u32 s16, s12, 0
    s_nop 0
    s_sub_u32 s17, s12, 28672
    s_min_u32 s16, s16, s17
    s_nop 0
    buffer_load_dwordx4 v[176:179], v3, s[68:71], s16 offen sc1
    s_waitcnt vmcnt(15)
    s_nop 0
    v_mfma_f32_32x32x16_bf16 v[96:111], v[16:19], v[180:183], v[96:111]
    v_mfma_f32_32x32x16_bf16 v[112:127], v[20:23], v[180:183], v[112:127]
    s_add_u32 s16, s12, 1024
    s_sub_u32 s17, s12, 27648
    s_min_u32 s16, s16, s17
    s_nop 0
    buffer_load_dwordx4 v[180:183], v3, s[68:71], s16 offen sc1
    s_waitcnt lgkmcnt(0)
    s_waitcnt vmcnt(15)
    v_mfma_f32_32x32x16_bf16 v[64:79], v[24:27], v[184:187], v[64:79]
    v_mfma_f32_32x32x16_bf16 v[80:95], v[28:31], v[184:187], v[80:95]
    s_add_u32 s16, s12, 2048
    s_sub_u32 s17, s12, 26624
    s_min_u32 s16, s16, s17
    s_nop 0
    buffer_load_dwordx4 v[184:187], v3, s[68:71], s16 offen sc1
    s_waitcnt vmcnt(15)
    s_nop 0
    v_mfma_f32_32x32x16_bf16 v[96:111], v[24:27], v[188:191], v[96:111]
    v_mfma_f32_32x32x16_bf16 v[112:127], v[28:31], v[188:191], v[112:127]
    s_add_u32 s16, s12, 3072
    s_sub_u32 s17, s12, 25600
    s_min_u32 s16, s16, s17
    s_nop 0
    buffer_load_dwordx4 v[188:191], v3, s[68:71], s16 offen sc1
    s_waitcnt vmcnt(15)
    s_nop 0
    v_mfma_f32_32x32x16_bf16 v[64:79], v[32:35], v[128:131], v[64:79]
    v_mfma_f32_32x32x16_bf16 v[80:95], v[36:39], v[128:131], v[80:95]
    s_add_u32 s16, s12, 4096
    s_sub_u32 s17, s12, 24576
    s_min_u32 s16, s16, s17
    s_nop 0
    buffer_load_dwordx4 v[128:131], v3, s[68:71], s16 offen sc1
    s_waitcnt vmcnt(15)
    s_nop 0
    v_mfma_f32_32x32x16_bf16 v[64:79], v[40:43], v[132:135], v[64:79]
    v_mfma_f32_32x32x16_bf16 v[80:95], v[44:47], v[132:135], v[80:95]
    s_add_u32 s16, s12, 5120
    s_sub_u32 s17, s12, 23552
    s_min_u32 s16, s16, s17
    s_nop 0
    buffer_load_dwordx4 v[132:135], v3, s[68:71], s16 offen sc1
    s_waitcnt vmcnt(15)
    s_nop 0
    v_mfma_f32_32x32x16_bf16 v[64:79], v[48:51], v[136:139], v[64:79]
    v_mfma_f32_32x32x16_bf16 v[80:95], v[52:55], v[136:139], v[80:95]
    s_add_u32 s16, s12, 6144
    s_sub_u32 s17, s12, 22528
    s_min_u32 s16, s16, s17
    s_nop 0
    buffer_load_dwordx4 v[136:139], v3, s[68:71], s16 offen sc1
    s_waitcnt vmcnt(15)
    s_nop 0
    v_mfma_f32_32x32x16_bf16 v[64:79], v[56:59], v[140:143], v[64:79]
    v_mfma_f32_32x32x16_bf16 v[80:95], v[60:63], v[140:143], v[80:95]
    s_add_u32 s16, s12, 7168
    s_sub_u32 s17, s12, 21504
    s_min_u32 s16, s16, s17
    s_nop 0
    buffer_load_dwordx4 v[140:143], v3, s[68:71], s16 offen sc1
    s_waitcnt vmcnt(15)
    s_nop 0
    v_mfma_f32_32x32x16_bf16 v[64:79], v[192:195], v[144:147], v[64:79]
    v_mfma_f32_32x32x16_bf16 v[80:95], v[196:199], v[144:147], v[80:95]
    s_add_u32 s16, s12, 8192
    s_sub_u32 s17, s12, 20480
    s_min_u32 s16, s16, s17
    s_nop 0
    buffer_load_dwordx4 v[144:147], v3, s[68:71], s16 offen sc1
    s_waitcnt vmcnt(15)
    s_nop 0
    v_mfma_f32_32x32x16_bf16 v[64:79], v[200:203], v[148:151], v[64:79]
    v_mfma_f32_32x32x16_bf16 v[80:95], v[204:207], v[148:151], v[80:95]
    s_add_u32 s16, s12, 9216
    s_sub_u32 s17, s12, 19456
    s_min_u32 s16, s16, s17
    s_nop 0
    buffer_load_dwordx4 v[148:151], v3, s[68:71], s16 offen sc1
    s_waitcnt vmcnt(15)
    s_nop 0
    v_mfma_f32_32x32x16_bf16 v[64:79], v[208:211], v[152:155], v[64:79]
    v_mfma_f32_32x32x16_bf16 v[80:95], v[212:215], v[152:155], v[80:95]
    s_add_u32 s16, s12, 10240
    s_sub_u32 s17, s12, 18432
    s_min_u32 s16, s16, s17
    s_nop 0
    buffer_load_dwordx4 v[152:155], v3, s[68:71], s16 offen sc1
    s_waitcnt vmcnt(15)
    s_nop 0
    v_mfma_f32_32x32x16_bf16 v[64:79], v[216:219], v[156:159], v[64:79]
    v_mfma_f32_32x32x16_bf16 v[80:95], v[220:223], v[156:159], v[80:95]
    s_add_u32 s16, s12, 11264
    s_sub_u32 s17, s12, 17408
    s_min_u32 s16, s16, s17
    s_nop 0
    buffer_load_dwordx4 v[156:159], v3, s[68:71], s16 offen sc1
    s_waitcnt vmcnt(15)
    s_nop 0
    v_mfma_f32_32x32x16_bf16 v[64:79], v[224:227], v[160:163], v[64:79]
    v_mfma_f32_32x32x16_bf16 v[80:95], v[228:231], v[160:163], v[80:95]
    s_waitcnt vmcnt(14)
    s_nop 0
    v_mfma_f32_32x32x16_bf16 v[64:79], v[232:235], v[164:167], v[64:79]
    v_mfma_f32_32x32x16_bf16 v[80:95], v[236:239], v[164:167], v[80:95]
    s_waitcnt vmcnt(13)
    s_nop 0
    v_mfma_f32_32x32x16_bf16 v[64:79], v[240:243], v[168:171], v[64:79]
    v_mfma_f32_32x32x16_bf16 v[80:95], v[244:247], v[168:171], v[80:95]
    s_waitcnt vmcnt(12)
    s_nop 0
    v_mfma_f32_32x32x16_bf16 v[64:79], v[248:251], v[172:175], v[64:79]
    v_mfma_f32_32x32x16_bf16 v[80:95], v[252:255], v[172:175], v[80:95]
    s_waitcnt vmcnt(11)
    s_nop 0
    v_mfma_f32_32x32x16_bf16 v[96:111], v[32:35], v[176:179], v[96:111]
    v_mfma_f32_32x32x16_bf16 v[112:127], v[36:39], v[176:179], v[112:127]
    s_nop 7
    s_nop 0
    ds_write_b128 v13, v[64:67] offset:0
    ds_write_b128 v13, v[68:71] offset:2048
    ds_write_b128 v13, v[72:75] offset:4096
    ds_write_b128 v13, v[76:79] offset:6144
    s_waitcnt vmcnt(10)
    s_nop 0
    v_mfma_f32_32x32x16_bf16 v[96:111], v[40:43], v[180:183], v[96:111]
    v_mfma_f32_32x32x16_bf16 v[112:127], v[44:47], v[180:183], v[112:127]
    ds_write_b128 v14, v[80:83] offset:32768
    ds_write_b128 v14, v[84:87] offset:34816
    ds_write_b128 v14, v[88:91] offset:36864
    ds_write_b128 v14, v[92:95] offset:38912
    s_waitcnt vmcnt(9)
    s_nop 0
    v_mfma_f32_32x32x16_bf16 v[96:111], v[48:51], v[184:187], v[96:111]
    v_mfma_f32_32x32x16_bf16 v[112:127], v[52:55], v[184:187], v[112:127]
    s_waitcnt lgkmcnt(0)
    s_mov_b64 exec, 1
    ds_add_u32 v11, v15 offset:56
    s_mov_b64 exec, -1
    s_waitcnt vmcnt(8)
    v_mfma_f32_32x32x16_bf16 v[96:111], v[56:59], v[188:191], v[96:111]
    v_mfma_f32_32x32x16_bf16 v[112:127], v[60:63], v[188:191], v[112:127]
    s_waitcnt vmcnt(7)
    s_nop 0
    v_mfma_f32_32x32x16_bf16 v[96:111], v[192:195], v[128:131], v[96:111]
    v_mfma_f32_32x32x16_bf16 v[112:127], v[196:199], v[128:131], v[112:127]
    s_waitcnt vmcnt(6)
    s_nop 0
    v_mfma_f32_32x32x16_bf16 v[96:111], v[200:203], v[132:135], v[96:111]
    v_mfma_f32_32x32x16_bf16 v[112:127], v[204:207], v[132:135], v[112:127]
    s_waitcnt vmcnt(5)
    s_nop 0
    v_mfma_f32_32x32x16_bf16 v[96:111], v[208:211], v[136:139], v[96:111]
    v_mfma_f32_32x32x16_bf16 v[112:127], v[212:215], v[136:139], v[112:127]
    s_waitcnt vmcnt(4)
    s_nop 0
    v_mfma_f32_32x32x16_bf16 v[96:111], v[216:219], v[140:143], v[96:111]
    v_mfma_f32_32x32x16_bf16 v[112:127], v[220:223], v[140:143], v[112:127]
    s_waitcnt vmcnt(3)
.L_pp3:
    s_cbranch_execz .L_pb3
    v_mfma_f32_32x32x16_bf16 v[96:111], v[224:227], v[144:147], v[96:111]
    v_mfma_f32_32x32x16_bf16 v[112:127], v[228:231], v[144:147], v[112:127]
    s_waitcnt vmcnt(2)
    s_nop 0
    v_mfma_f32_32x32x16_bf16 v[96:111], v[232:235], v[148:151], v[96:111]
    v_mfma_f32_32x32x16_bf16 v[112:127], v[236:239], v[148:151], v[112:127]
    s_waitcnt vmcnt(1)
    s_nop 0
    v_mfma_f32_32x32x16_bf16 v[96:111], v[240:243], v[152:155], v[96:111]
    v_mfma_f32_32x32x16_bf16 v[112:127], v[244:247], v[152:155], v[112:127]
    s_waitcnt vmcnt(0)
    s_nop 0
    v_mfma_f32_32x32x16_bf16 v[96:111], v[248:251], v[156:159], v[96:111]
    v_mfma_f32_32x32x16_bf16 v[112:127], v[252:255], v[156:159], v[112:127]
    s_nop 10
    s_nop 0
    ds_write_b128 v13, v[96:99] offset:512
    ds_write_b128 v13, v[100:103] offset:2560
    ds_write_b128 v13, v[104:107] offset:4608
    ds_write_b128 v13, v[108:111] offset:6656
    ds_write_b128 v14, v[112:115] offset:33280
    ds_write_b128 v14, v[116:119] offset:35328
    ds_write_b128 v14, v[120:123] offset:37376
    ds_write_b128 v14, v[124:127] offset:39424
    s_waitcnt lgkmcnt(0)
    s_barrier
.L_fin:
.L_end:
    s_endpgm
CODE_END:
    s_endpgm
.section .rodata,"a"
.p2align 6
.amdhsa_kernel parallel_sum__ssm_conv_s4__geglu_ffn__prompt_kernel
  .amdhsa_next_free_vgpr 256
  .amdhsa_next_free_sgpr 102
  .amdhsa_accum_offset 256
  .amdhsa_group_segment_fixed_size 0
  .amdhsa_kernarg_size 128
  .amdhsa_user_sgpr_count 2
  .amdhsa_user_sgpr_kernarg_segment_ptr 1
  .amdhsa_system_sgpr_workgroup_id_x 1
.end_amdhsa_kernel
```
